```python
import torch

def _softmax(x, axis=-1):
    return torch.softmax(x, dim=axis)
def _gelu(x):
    return torch.nn.functional.gelu(x, approximate="tanh")
def _silu(x):
    return torch.nn.functional.silu(x)
def _sigmoid(x):
    return torch.sigmoid(x)
def _layernorm(x, axis=-1, eps=1e-5):
    m = x.mean(dim=axis, keepdim=True)
    v = x.var(dim=axis, keepdim=True, unbiased=False)
    return (x - m) / torch.sqrt(v + eps)
def _scatter_add(tgt, idx, src, axis=0):
    return tgt.clone().index_add_(axis, idx, src)
def _segment_sum(src, seg, n):
    out = torch.zeros((n,) + src.shape[1:], dtype=src.dtype)
    return out.index_add_(0, seg, src)
def _pad(x, pw):
    flat = tuple(v for pair in reversed(pw) for v in pair)
    return torch.nn.functional.pad(x, flat)

kernel_name = 'standalone__gqa_block_cached__near_ridge'

def setup_inputs():

    _w = (lambda a: (lambda t: t.to(torch.bfloat16) if t.is_floating_point() else t)(torch.as_tensor(a)))
    B, Sq, D = 16, 144, 512
    Hq, Hkv, Sk, Dh = 32, 32, 512, 128
    assert Hq % Hkv == 0, (Hq, Hkv)
    return {
        "x": _w((lambda *s: torch.randn(*s, dtype=torch.bfloat16) * 0.8)(B, Sq, D)),
        "k_cache": _w((lambda *s: torch.randn(*s, dtype=torch.bfloat16) * 0.8)(B, Hkv, Sk, Dh)),
        "v_cache": _w((lambda *s: torch.randn(*s, dtype=torch.bfloat16) * 0.05)(B, Hkv, Sk, Dh)),
        "wq": _w((lambda *s: torch.randn(*s, dtype=torch.bfloat16) * 0.8)(D, Hq * Dh) * (D ** -0.5)),
        "wo": _w((lambda *s: torch.randn(*s, dtype=torch.bfloat16) * 0.05)(Hq * Dh, D) * ((Hq * Dh) ** -0.5)),
    }

def reference(x, k_cache, v_cache, wq, wo):
    B, Sq, D = x.shape
    Hq, Dh = 32, 128
    Hkv = k_cache.shape[1]
    rep = Hq // Hkv
    q = (lambda x, *d: x.permute(*d))((x @ wq).reshape(B, Sq, Hq, Dh), 0, 2, 1, 3)
    k = (lambda x, n, axis: torch.repeat_interleave(x, n, dim=axis))(k_cache, rep, axis=1)
    v = (lambda x, n, axis: torch.repeat_interleave(x, n, dim=axis))(v_cache, rep, axis=1)
    scores = torch.einsum("bhqd,bhkd->bhqk", q, k) * (Dh ** -0.5)
    p = _softmax(scores, axis=-1)
    o = torch.einsum("bhqk,bhkd->bhqd", p, v)
    return (lambda x, *d: x.permute(*d))(o, 0, 2, 1, 3).reshape(B, Sq, Hq * Dh) @ wo
```

```asm
; @launch grid=(256,1,1) block=(256,1,1) lds=163840
.amdgcn_target "amdgcn-amd-amdhsa--gfx950"
.text
.globl standalone__gqa_block_cached__near_ridge_kernel
.p2align 8
.type standalone__gqa_block_cached__near_ridge_kernel,@function
standalone__gqa_block_cached__near_ridge_kernel:

    s_cmp_ge_u32 s2, 256
    s_cbranch_scc1 L_end

    s_load_dwordx4 s[56:59], s[0:1], 0
    s_load_dwordx4 s[60:63], s[0:1], 16
    s_load_dwordx4 s[64:67], s[0:1], 32
    s_load_dwordx2 s[68:69], s[0:1], 56

    s_getpc_b64 s[4:5]

L_codebase:

    v_lshlrev_b32 v1, 7, v0

    v_min_u32 v3, L_end - L_codebase - 64, v1
    global_load_dword v255, v3, s[4:5]

    v_add_u32 v1, 0x8000, v1

    v_min_u32 v3, L_end - L_codebase - 64, v1
    global_load_dword v255, v3, s[4:5]

    v_lshrrev_b32 v1, 6, v0
    v_and_b32 v2, 63, v0
    v_readfirstlane_b32 s36, v1
    s_and_b32 s3, s2, 7
    s_lshr_b32 s4, s2, 3
    s_and_b32 s38, s3, 3
    s_lshr_b32 s5, s3, 2
    s_lshl_b32 s5, s5, 3
    s_lshr_b32 s6, s4, 2
    s_add_u32 s37, s5, s6
    s_and_b32 s39, s4, 3
    s_lshl_b32 s43, s36, 12
    s_lshl_b32 s44, s36, 10
    s_mov_b32 s54, 0x3e0293ee
    v_and_b32 v3, 15, v2
    v_lshrrev_b32 v4, 4, v2
    v_and_b32 v5, 31, v2
    v_lshrrev_b32 v6, 5, v2
    v_and_b32 v7, 1, v4
    v_lshrrev_b32 v8, 2, v3
    v_and_b32 v9, 3, v2
    v_lshlrev_b32 v244, 4, v2
    v_add_u32 v254, 0x20000, v244

    s_getpc_b64 s[90:91]
L_ibase:
    s_load_dwordx2 s[94:95], s[0:1], 48

    s_lshl_b32 s3, s36, 2
    v_add_u32 v10, s3, v4
    v_lshlrev_b32 v10, 13, v10
    s_lshr_b32 s4, s36, 1
    v_lshlrev_b32 v12, 1, v4
    v_or_b32 v12, s4, v12
    v_lshlrev_b32 v12, 1, v12
    v_xor_b32 v12, v12, v3
    v_lshlrev_b32 v12, 4, v12
    v_add_u32 v230, v10, v12

    v_lshrrev_b32 v10, 3, v2
    s_lshl_b32 s3, s36, 3
    v_add_u32 v10, s3, v10
    v_lshlrev_b32 v10, 10, v10
    s_and_b32 s4, s36, 1
    s_lshl_b32 s5, s4, 2
    v_add_u32 v11, s5, v4
    v_and_b32 v12, 7, v2
    v_xor_b32 v12, v12, v11
    v_lshlrev_b32 v12, 4, v12
    v_add_u32 v231, v10, v12
    s_mul_i32 s48, s37, 147456
    s_lshl_b32 s5, s4, 3
    s_add_u32 s5, s5, 128
    s_sub_u32 s5, s5, s3
    s_lshl_b32 s5, s5, 10
    s_add_u32 s49, s48, s5
    s_lshl_b32 s50, s4, 10

    v_lshlrev_b32 v10, 8, v4
    v_add_u32 v10, s43, v10
    v_add_u32 v12, 0, v4
    v_xor_b32 v12, v12, v3
    v_lshlrev_b32 v12, 4, v12
    v_add_u32 v224, v10, v12
    v_add_u32 v12, 4, v4
    v_xor_b32 v12, v12, v3
    v_lshlrev_b32 v12, 4, v12
    v_add_u32 v225, v10, v12
    v_add_u32 v12, 8, v4
    v_xor_b32 v12, v12, v3
    v_lshlrev_b32 v12, 4, v12
    v_add_u32 v226, v10, v12
    v_add_u32 v12, 12, v4
    v_xor_b32 v12, v12, v3
    v_lshlrev_b32 v12, 4, v12
    v_add_u32 v227, v10, v12
    v_lshlrev_b32 v12, 1, v4
    v_or_b32 v12, 0, v12
    v_lshlrev_b32 v12, 1, v12
    v_xor_b32 v12, v12, v3
    v_lshlrev_b32 v12, 4, v12
    v_add_u32 v228, v10, v12
    v_lshlrev_b32 v12, 1, v4
    v_or_b32 v12, 1, v12
    v_lshlrev_b32 v12, 1, v12
    v_xor_b32 v12, v12, v3
    v_lshlrev_b32 v12, 4, v12
    v_add_u32 v229, v10, v12

    s_lshl_b32 s3, s38, 3
    s_lshl_b32 s4, s39, 1
    s_add_u32 s3, s3, s4
    s_lshl_b32 s5, s37, 5
    s_add_u32 s5, s5, s3
    s_lshl_b32 s42, s5, 17
    s_add_u32 s52, s42, 0x20000
    s_lshl_b32 s47, s3, 8
    s_add_u32 s53, s47, 256

    s_waitcnt lgkmcnt(0)
    s_mov_b32 s8, s56
    s_mov_b32 s9, s57
    s_mov_b32 s10, 2359296
    s_mov_b32 s11, 0x20000
    s_mov_b32 s20, s62
    s_mov_b32 s21, s63
    s_mov_b32 s22, 0x400000
    s_mov_b32 s23, 0x20000
    s_mov_b32 s12, s58
    s_mov_b32 s13, s59
    s_mov_b32 s14, 0x4000000
    s_mov_b32 s15, 0x20000
    s_mov_b32 s16, s60
    s_mov_b32 s17, s61
    s_mov_b32 s18, 0x4000000
    s_mov_b32 s19, 0x20000
    s_mov_b32 s28, s64
    s_mov_b32 s29, s65
    s_mov_b32 s30, 0x400000
    s_mov_b32 s31, 0x20000
    s_mov_b32 s32, s66
    s_mov_b32 s33, s67
    s_mov_b32 s34, 2359296
    s_mov_b32 s35, 0x20000
    s_mov_b32 s24, s68
    s_mov_b32 s25, s69
    s_mov_b32 s26, 0x10000000
    s_mov_b32 s27, 0x20000

    s_mov_b32 s70, s68
    s_mov_b32 s71, s69
    s_add_u32 m0, s44, 49152
    s_add_u32 s55, s47, 0
    buffer_load_dwordx4 v230, s[20:23], s55 offen lds
    s_add_u32 m0, s44, 53248
    s_add_u32 s55, s47, 131072
    buffer_load_dwordx4 v230, s[20:23], s55 offen lds
    s_add_u32 m0, s44, 57344
    s_add_u32 s55, s53, 0
    buffer_load_dwordx4 v230, s[20:23], s55 offen lds
    s_add_u32 m0, s44, 61440
    s_add_u32 s55, s53, 131072
    buffer_load_dwordx4 v230, s[20:23], s55 offen lds
    s_add_u32 m0, s44, 98304
    s_add_u32 s55, s48, 0
    buffer_load_dwordx4 v231, s[8:11], s55 offen lds
    s_add_u32 m0, s44, 102400
    s_add_u32 s55, s48, 32768
    buffer_load_dwordx4 v231, s[8:11], s55 offen lds
    s_add_u32 m0, s44, 106496
    s_add_u32 s55, s48, 65536
    buffer_load_dwordx4 v231, s[8:11], s55 offen lds
    s_add_u32 m0, s44, 110592
    s_add_u32 s55, s48, 98304
    buffer_load_dwordx4 v231, s[8:11], s55 offen lds
    s_add_u32 m0, s50, 114688
    s_add_u32 s55, s49, 0
    buffer_load_dwordx4 v231, s[8:11], s55 offen lds

        v_lshlrev_b32 v13, 2, v8
        v_lshlrev_b32 v14, 1, v6
        v_or_b32 v13, v13, v14
        v_lshlrev_b32 v14, 1, v7
        v_and_b32 v15, 1, v9
        v_add_u32 v14, v14, v15
        v_lshrrev_b32 v16, 1, v9
        v_lshlrev_b32 v16, 3, v16
        v_lshlrev_b32 v18, 2, v8
        v_lshlrev_b32 v19, 1, v7
        v_or_b32 v18, v18, v19
        v_lshrrev_b32 v19, 1, v9
        v_and_b32 v20, 1, v9
        v_lshlrev_b32 v20, 3, v20

        v_lshlrev_b32 v17, 3, v6
        v_add_u32 v17, v17, v8
        v_lshlrev_b32 v17, 8, v17
        v_add_u32 v17, v17, v16
        v_add_u32 v17, 32768, v17

        v_add_u32 v12, 0, v14
        v_xor_b32 v12, v12, v13
        v_lshlrev_b32 v12, 4, v12
        v_add_u32 v246, v17, v12
        v_add_u32 v12, 4, v14
        v_xor_b32 v12, v12, v13
        v_lshlrev_b32 v12, 4, v12
        v_add_u32 v247, v17, v12
        v_add_u32 v12, 8, v14
        v_xor_b32 v12, v12, v13
        v_lshlrev_b32 v12, 4, v12
        v_add_u32 v248, v17, v12
        v_add_u32 v12, 12, v14
        v_xor_b32 v12, v12, v13
        v_lshlrev_b32 v12, 4, v12
        v_add_u32 v249, v17, v12

        v_lshlrev_b32 v21, 3, v4
        v_add_u32 v21, v21, v8
        v_lshlrev_b32 v21, 8, v21
        v_add_u32 v21, v21, v20
        v_add_u32 v21, 32768, v21
        s_lshl_b32 s6, s36, 2

        v_add_u32 v12, 0, v19
        v_add_u32 v12, s6, v12
        v_xor_b32 v12, v12, v18
        v_lshlrev_b32 v12, 4, v12
        v_add_u32 v250, v21, v12
        v_add_u32 v12, 2, v19
        v_add_u32 v12, s6, v12
        v_xor_b32 v12, v12, v18
        v_lshlrev_b32 v12, 4, v12
        v_add_u32 v251, v21, v12

        s_lshl_b32 s6, s36, 5
        v_add_u32 v10, s6, v5
        v_lshlrev_b32 v10, 7, v10
        v_add_u32 v10, 98304, v10
        v_lshrrev_b32 v11, 1, v5
        v_and_b32 v11, 7, v11

        v_add_u32 v12, 0, v6
        v_xor_b32 v12, v12, v11
        v_lshlrev_b32 v12, 4, v12
        v_add_u32 v72, v10, v12
        v_add_u32 v12, 2, v6
        v_xor_b32 v12, v12, v11
        v_lshlrev_b32 v12, 4, v12
        v_add_u32 v73, v10, v12
        v_add_u32 v12, 4, v6
        v_xor_b32 v12, v12, v11
        v_lshlrev_b32 v12, 4, v12
        v_add_u32 v74, v10, v12
        v_add_u32 v12, 6, v6
        v_xor_b32 v12, v12, v11
        v_lshlrev_b32 v12, 4, v12
        v_add_u32 v75, v10, v12

        v_add_u32 v10, 128, v3
        v_lshlrev_b32 v10, 7, v10
        v_add_u32 v10, 98304, v10
        v_lshrrev_b32 v11, 1, v3
        v_and_b32 v11, 7, v11

        v_add_u32 v12, 0, v4
        v_xor_b32 v12, v12, v11
        v_lshlrev_b32 v12, 4, v12
        v_add_u32 v76, v10, v12
        v_add_u32 v12, 4, v4
        v_xor_b32 v12, v12, v11
        v_lshlrev_b32 v12, 4, v12
        v_add_u32 v77, v10, v12
        v_lshlrev_b32 v10, 8, v5
        v_and_b32 v11, 15, v5
        v_add_u32 v12, 0, v6
        v_xor_b32 v12, v12, v11
        v_lshlrev_b32 v12, 4, v12
        v_add_u32 v200, v10, v12
        v_add_u32 v12, 2, v6
        v_xor_b32 v12, v12, v11
        v_lshlrev_b32 v12, 4, v12
        v_add_u32 v201, v10, v12
        v_add_u32 v12, 4, v6
        v_xor_b32 v12, v12, v11
        v_lshlrev_b32 v12, 4, v12
        v_add_u32 v202, v10, v12
        v_add_u32 v12, 6, v6
        v_xor_b32 v12, v12, v11
        v_lshlrev_b32 v12, 4, v12
        v_add_u32 v203, v10, v12
        v_add_u32 v12, 8, v6
        v_xor_b32 v12, v12, v11
        v_lshlrev_b32 v12, 4, v12
        v_add_u32 v204, v10, v12
        v_add_u32 v12, 10, v6
        v_xor_b32 v12, v12, v11
        v_lshlrev_b32 v12, 4, v12
        v_add_u32 v205, v10, v12
        v_add_u32 v12, 12, v6
        v_xor_b32 v12, v12, v11
        v_lshlrev_b32 v12, 4, v12
        v_add_u32 v206, v10, v12
        v_add_u32 v12, 14, v6
        v_xor_b32 v12, v12, v11
        v_lshlrev_b32 v12, 4, v12
        v_add_u32 v207, v10, v12

        v_lshlrev_b32 v17, 2, v6
        v_add_u32 v17, v17, v8
        v_lshlrev_b32 v17, 8, v17
        v_add_u32 v17, v17, v16
        v_add_u32 v17, 65536, v17

        v_add_u32 v12, 0, v14
        v_xor_b32 v12, v12, v13
        v_lshlrev_b32 v12, 4, v12
        v_add_u32 v208, v17, v12
        v_add_u32 v12, 4, v14
        v_xor_b32 v12, v12, v13
        v_lshlrev_b32 v12, 4, v12
        v_add_u32 v209, v17, v12
        v_add_u32 v12, 8, v14
        v_xor_b32 v12, v12, v13
        v_lshlrev_b32 v12, 4, v12
        v_add_u32 v210, v17, v12
        v_add_u32 v12, 12, v14
        v_xor_b32 v12, v12, v13
        v_lshlrev_b32 v12, 4, v12
        v_add_u32 v211, v17, v12

        v_lshlrev_b32 v10, 8, v3
        s_lshl_b32 s6, s36, 13
        v_add_u32 v10, s6, v10

        v_add_u32 v12, 0, v4
        v_xor_b32 v12, v12, v3
        v_lshlrev_b32 v12, 4, v12
        v_add_u32 v212, v10, v12
        v_add_u32 v12, 4, v4
        v_xor_b32 v12, v12, v3
        v_lshlrev_b32 v12, 4, v12
        v_add_u32 v213, v10, v12
        v_add_u32 v12, 8, v4
        v_xor_b32 v12, v12, v3
        v_lshlrev_b32 v12, 4, v12
        v_add_u32 v214, v10, v12
        v_add_u32 v12, 12, v4
        v_xor_b32 v12, v12, v3
        v_lshlrev_b32 v12, 4, v12
        v_add_u32 v215, v10, v12

        v_lshlrev_b32 v21, 2, v4
        v_add_u32 v21, v21, v8
        v_lshlrev_b32 v21, 8, v21
        v_add_u32 v21, v21, v20
        v_add_u32 v21, s6, v21
        v_add_u32 v21, 65536, v21

        s_lshl_b32 s7, s36, 2
        s_add_u32 s7, s7, 0
        s_and_b32 s7, s7, 15
        v_add_u32 v12, s7, v19
        v_xor_b32 v12, v12, v18
        v_lshlrev_b32 v12, 4, v12
        v_add_u32 v216, v21, v12
        s_lshl_b32 s7, s36, 2
        s_add_u32 s7, s7, 2
        s_and_b32 s7, s7, 15
        v_add_u32 v12, s7, v19
        v_xor_b32 v12, v12, v18
        v_lshlrev_b32 v12, 4, v12
        v_add_u32 v217, v21, v12
        s_lshl_b32 s7, s36, 2
        s_add_u32 s7, s7, 4
        s_and_b32 s7, s7, 15
        v_add_u32 v12, s7, v19
        v_xor_b32 v12, v12, v18
        v_lshlrev_b32 v12, 4, v12
        v_add_u32 v218, v21, v12
        s_lshl_b32 s7, s36, 2
        s_add_u32 s7, s7, 6
        s_and_b32 s7, s7, 15
        v_add_u32 v12, s7, v19
        v_xor_b32 v12, v12, v18
        v_lshlrev_b32 v12, 4, v12
        v_add_u32 v219, v21, v12
        s_lshl_b32 s7, s36, 2
        s_add_u32 s7, s7, 8
        s_and_b32 s7, s7, 15
        v_add_u32 v12, s7, v19
        v_xor_b32 v12, v12, v18
        v_lshlrev_b32 v12, 4, v12
        v_add_u32 v220, v21, v12
        s_lshl_b32 s7, s36, 2
        s_add_u32 s7, s7, 10
        s_and_b32 s7, s7, 15
        v_add_u32 v12, s7, v19
        v_xor_b32 v12, v12, v18
        v_lshlrev_b32 v12, 4, v12
        v_add_u32 v221, v21, v12
        s_lshl_b32 s7, s36, 2
        s_add_u32 s7, s7, 12
        s_and_b32 s7, s7, 15
        v_add_u32 v12, s7, v19
        v_xor_b32 v12, v12, v18
        v_lshlrev_b32 v12, 4, v12
        v_add_u32 v222, v21, v12
        s_lshl_b32 s7, s36, 2
        s_add_u32 s7, s7, 14
        s_and_b32 s7, s7, 15
        v_add_u32 v12, s7, v19
        v_xor_b32 v12, v12, v18
        v_lshlrev_b32 v12, 4, v12
        v_add_u32 v223, v21, v12

        v_lshrrev_b32 v12, 1, v4
        v_lshlrev_b32 v12, 4, v12
        v_add_u32 v12, v12, v3
        v_lshlrev_b32 v12, 4, v12
        v_lshlrev_b32 v22, 3, v7
        v_add_u32 v12, v12, v22
        v_add_u32 v245, s44, v12
        s_lshl_b32 s6, s36, 13
        v_add_u32 v252, s6, v244
    s_add_u32 m0, s44, 32768

        s_add_u32 s4, s70, 67174400
        s_addc_u32 s5, s71, 0
        s_load_dword s96, s[4:5], 0
        s_lshl_b32 s6, s37, 2
        s_add_u32 s6, s6, s38
        s_mul_i32 s7, s6, 294912
        s_lshl_b32 s70, s38, 20
        s_lshl_b32 s71, s39, 8
        s_add_u32 s51, s70, s71

        s_add_u32 s3, s39, 0
        s_and_b32 s3, s3, 3
        s_lshl_b32 s3, s3, 1
        s_add_u32 s3, s3, 0
        s_mul_i32 s55, s3, 36864
        s_add_u32 s56, s55, s7
        s_lshl_b32 s3, s3, 17
        s_add_u32 s64, s3, s51

        s_add_u32 s3, s39, 0
        s_and_b32 s3, s3, 3
        s_lshl_b32 s3, s3, 1
        s_add_u32 s3, s3, 1
        s_mul_i32 s55, s3, 36864
        s_add_u32 s57, s55, s7
        s_lshl_b32 s3, s3, 17
        s_add_u32 s65, s3, s51

        s_add_u32 s3, s39, 1
        s_and_b32 s3, s3, 3
        s_lshl_b32 s3, s3, 1
        s_add_u32 s3, s3, 0
        s_mul_i32 s55, s3, 36864
        s_add_u32 s58, s55, s7
        s_lshl_b32 s3, s3, 17
        s_add_u32 s66, s3, s51

        s_add_u32 s3, s39, 2
        s_and_b32 s3, s3, 3
        s_lshl_b32 s3, s3, 1
        s_add_u32 s3, s3, 0
        s_mul_i32 s55, s3, 36864
        s_add_u32 s59, s55, s7
        s_lshl_b32 s3, s3, 17
        s_add_u32 s67, s3, s51

        s_add_u32 s3, s39, 3
        s_and_b32 s3, s3, 3
        s_lshl_b32 s3, s3, 1
        s_add_u32 s3, s3, 0
        s_mul_i32 s55, s3, 36864
        s_add_u32 s60, s55, s7
        s_lshl_b32 s3, s3, 17
        s_add_u32 s68, s3, s51

        s_add_u32 s3, s39, 1
        s_and_b32 s3, s3, 3
        s_lshl_b32 s3, s3, 1
        s_add_u32 s3, s3, 1
        s_mul_i32 s55, s3, 36864
        s_add_u32 s61, s55, s7
        s_lshl_b32 s3, s3, 17
        s_add_u32 s69, s3, s51

        s_add_u32 s3, s39, 2
        s_and_b32 s3, s3, 3
        s_lshl_b32 s3, s3, 1
        s_add_u32 s3, s3, 1
        s_mul_i32 s55, s3, 36864
        s_add_u32 s62, s55, s7
        s_lshl_b32 s3, s3, 17
        s_add_u32 s70, s3, s51

        s_add_u32 s3, s39, 3
        s_and_b32 s3, s3, 3
        s_lshl_b32 s3, s3, 1
        s_add_u32 s3, s3, 1
        s_mul_i32 s55, s3, 36864
        s_add_u32 s63, s55, s7
        s_lshl_b32 s3, s3, 17
        s_add_u32 s71, s3, s51

        s_lshl_b32 s3, s6, 9
        s_add_u32 s3, s3, 67108864
        s_lshl_b32 s5, s37, 2
        s_add_u32 s5, s5, s39
        s_lshl_b32 s4, s5, 9
        s_add_u32 s4, s4, 67141632
        s_mul_i32 s5, s5, 147456
        s_add_u32 s5, s5, 18874368
    s_add_u32 s55, s47, 262144
    buffer_load_dwordx4 v230, s[20:23], s55 offen lds
    s_add_u32 m0, s44, 36864
    s_add_u32 s55, s47, 393216
    buffer_load_dwordx4 v230, s[20:23], s55 offen lds
    s_add_u32 m0, s44, 40960
    s_add_u32 s55, s53, 262144
    buffer_load_dwordx4 v230, s[20:23], s55 offen lds
    s_add_u32 m0, s44, 45056
    s_add_u32 s55, s53, 393216
    buffer_load_dwordx4 v230, s[20:23], s55 offen lds
    s_add_u32 m0, s44, 116736
    s_add_u32 s55, s48, 128
    buffer_load_dwordx4 v231, s[8:11], s55 offen lds
    s_add_u32 m0, s44, 120832
    s_add_u32 s55, s48, 32896
    buffer_load_dwordx4 v231, s[8:11], s55 offen lds
    s_add_u32 m0, s44, 124928
    s_add_u32 s55, s48, 65664
    buffer_load_dwordx4 v231, s[8:11], s55 offen lds
    s_add_u32 m0, s44, 129024
    s_add_u32 s55, s48, 98432
    buffer_load_dwordx4 v231, s[8:11], s55 offen lds
    s_add_u32 m0, s50, 133120
    s_add_u32 s55, s49, 128
    buffer_load_dwordx4 v231, s[8:11], s55 offen lds
    s_waitcnt lgkmcnt(0)
    s_waitcnt vmcnt(9)
    s_barrier
    s_add_u32 m0, s44, 81920
    s_add_u32 s55, s47, 524288
    buffer_load_dwordx4 v230, s[20:23], s55 offen lds
    ds_read_b128 a[32:35], v72 offset:0
    ds_read_b64_tr_b16 a[208:209], v246 offset:16384
    ds_read_b64_tr_b16 a[210:211], v246 offset:17408
    ds_read_b64_tr_b16 a[212:213], v247 offset:16384
    ds_read_b64_tr_b16 a[214:215], v247 offset:17408
    ds_read_b64_tr_b16 a[216:217], v248 offset:16384
    ds_read_b64_tr_b16 a[218:219], v248 offset:17408
    ds_read_b64_tr_b16 a[220:221], v249 offset:16384
    ds_read_b64_tr_b16 a[222:223], v249 offset:17408
    ds_read_b64_tr_b16 a[224:225], v246 offset:24576
    ds_read_b64_tr_b16 a[226:227], v246 offset:25600
    s_waitcnt lgkmcnt(8)
    v_mfma_f32_32x32x16_bf16 v[0:15], a[208:211], a[32:35], 0
    s_waitcnt lgkmcnt(6)
    s_add_u32 m0, s44, 86016
    s_add_u32 s55, s47, 655360
    buffer_load_dwordx4 v230, s[20:23], s55 offen lds
    ds_read_b64_tr_b16 a[228:229], v247 offset:24576
    ds_read_b64_tr_b16 a[230:231], v247 offset:25600
    v_mfma_f32_32x32x16_bf16 v[16:31], a[212:215], a[32:35], 0
    s_waitcnt lgkmcnt(6)
    s_add_u32 m0, s44, 90112
    s_add_u32 s55, s53, 524288
    buffer_load_dwordx4 v230, s[20:23], s55 offen lds
    ds_read_b64_tr_b16 a[232:233], v248 offset:24576
    ds_read_b64_tr_b16 a[234:235], v248 offset:25600
    v_mfma_f32_32x32x16_bf16 v[32:47], a[216:219], a[32:35], 0
    s_waitcnt lgkmcnt(6)
    s_add_u32 m0, s44, 94208
    s_add_u32 s55, s53, 655360
    buffer_load_dwordx4 v230, s[20:23], s55 offen lds
    ds_read_b64_tr_b16 a[236:237], v249 offset:24576
    ds_read_b64_tr_b16 a[238:239], v249 offset:25600
    v_mfma_f32_32x32x16_bf16 v[48:63], a[220:223], a[32:35], 0
    s_waitcnt lgkmcnt(6)
    ds_read_b128 a[36:39], v73 offset:0
    ds_read_b64_tr_b16 a[240:241], v246 offset:20480
    ds_read_b64_tr_b16 a[242:243], v246 offset:21504
    v_mfma_f32_32x32x16_bf16 a[128:143], a[224:227], a[32:35], 0
    s_waitcnt lgkmcnt(7)
    s_add_u32 m0, s44, 135168
    s_add_u32 s55, s48, 256
    buffer_load_dwordx4 v231, s[8:11], s55 offen lds
    ds_read_b64_tr_b16 a[244:245], v247 offset:20480
    ds_read_b64_tr_b16 a[246:247], v247 offset:21504
    ds_read_b64_tr_b16 a[216:217], v248 offset:28672
    ds_read_b64_tr_b16 a[218:219], v248 offset:29696
    v_mfma_f32_32x32x16_bf16 a[144:159], a[228:231], a[32:35], 0
    s_waitcnt lgkmcnt(9)
    s_add_u32 m0, s44, 139264
    s_add_u32 s55, s48, 33024
    buffer_load_dwordx4 v231, s[8:11], s55 offen lds
    ds_read_b64_tr_b16 a[248:249], v248 offset:20480
    ds_read_b64_tr_b16 a[250:251], v248 offset:21504
    ds_read_b64_tr_b16 a[220:221], v249 offset:28672
    ds_read_b64_tr_b16 a[222:223], v249 offset:29696
    v_mfma_f32_32x32x16_bf16 a[160:175], a[232:235], a[32:35], 0
    s_waitcnt lgkmcnt(11)
    s_add_u32 m0, s44, 143360
    s_add_u32 s55, s48, 65792
    buffer_load_dwordx4 v231, s[8:11], s55 offen lds
    ds_read_b64_tr_b16 a[252:253], v249 offset:20480
    ds_read_b64_tr_b16 a[254:255], v249 offset:21504
    ds_read_b128 a[56:59], v76 offset:0
    ds_read_b64_tr_b16 a[224:225], v250 offset:16384
    ds_read_b64_tr_b16 a[226:227], v250 offset:17408
    v_mfma_f32_32x32x16_bf16 a[176:191], a[236:239], a[32:35], 0
    s_waitcnt lgkmcnt(13)
    ds_read_b64_tr_b16 a[208:209], v246 offset:28672
    ds_read_b64_tr_b16 a[210:211], v246 offset:29696
    ds_read_b64_tr_b16 a[228:229], v251 offset:16384
    ds_read_b64_tr_b16 a[230:231], v251 offset:17408
    v_mfma_f32_32x32x16_bf16 v[0:15], a[240:243], a[36:39], v[0:15]
    s_waitcnt lgkmcnt(15)
    ds_read_b64_tr_b16 a[212:213], v247 offset:28672
    ds_read_b64_tr_b16 a[214:215], v247 offset:29696
    ds_read_b64_tr_b16 a[232:233], v250 offset:24576
    ds_read_b64_tr_b16 a[234:235], v250 offset:25600
    v_mfma_f32_32x32x16_bf16 v[16:31], a[244:247], a[36:39], v[16:31]
    s_waitcnt lgkmcnt(15)
    ds_read_b64_tr_b16 a[236:237], v251 offset:24576
    ds_read_b64_tr_b16 a[238:239], v251 offset:25600
    v_mfma_f32_32x32x16_bf16 v[32:47], a[248:251], a[36:39], v[32:47]
    s_waitcnt lgkmcnt(13)
    v_mfma_f32_32x32x16_bf16 v[48:63], a[252:255], a[36:39], v[48:63]
    s_waitcnt lgkmcnt(8)
    v_mfma_f32_32x32x16_bf16 a[128:143], a[208:211], a[36:39], a[128:143]
    s_waitcnt lgkmcnt(4)
    v_mfma_f32_32x32x16_bf16 a[144:159], a[212:215], a[36:39], a[144:159]
    ds_read_b128 a[40:43], v74 offset:0
    s_waitcnt vmcnt(12) lgkmcnt(1)
    s_barrier
    ds_read_b64_tr_b16 a[240:241], v246 offset:0
    ds_read_b64_tr_b16 a[242:243], v246 offset:1024
    v_mfma_f32_32x32x16_bf16 a[160:175], a[216:219], a[36:39], a[160:175]
    ds_read_b64_tr_b16 a[244:245], v247 offset:0
    ds_read_b64_tr_b16 a[246:247], v247 offset:1024
    v_mfma_f32_32x32x16_bf16 a[176:191], a[220:223], a[36:39], a[176:191]
    ds_read_b64_tr_b16 a[248:249], v248 offset:0
    ds_read_b64_tr_b16 a[250:251], v248 offset:1024
    v_mfma_f32_16x16x32_bf16 v[64:67], a[224:227], a[56:59], 0
    ds_read_b64_tr_b16 a[252:253], v249 offset:0
    ds_read_b64_tr_b16 a[254:255], v249 offset:1024
    v_mfma_f32_16x16x32_bf16 v[68:71], a[228:231], a[56:59], 0
    v_mfma_f32_16x16x32_bf16 a[192:195], a[232:235], a[56:59], 0
    ds_read_b64_tr_b16 a[208:209], v246 offset:8192
    ds_read_b64_tr_b16 a[210:211], v246 offset:9216
    v_mfma_f32_16x16x32_bf16 a[196:199], a[236:239], a[56:59], 0
    s_waitcnt lgkmcnt(8)
    v_mfma_f32_32x32x16_bf16 v[0:15], a[240:243], a[40:43], v[0:15]
    s_waitcnt lgkmcnt(6)
    s_add_u32 m0, s44, 49152
    s_add_u32 s55, s47, 786432
    buffer_load_dwordx4 v230, s[20:23], s55 offen lds
    ds_read_b64_tr_b16 a[212:213], v247 offset:8192
    ds_read_b64_tr_b16 a[214:215], v247 offset:9216
    v_mfma_f32_32x32x16_bf16 v[16:31], a[244:247], a[40:43], v[16:31]
    s_waitcnt lgkmcnt(6)
    s_add_u32 m0, s44, 53248
    s_add_u32 s55, s47, 917504
    buffer_load_dwordx4 v230, s[20:23], s55 offen lds
    ds_read_b64_tr_b16 a[216:217], v248 offset:8192
    ds_read_b64_tr_b16 a[218:219], v248 offset:9216
    v_mfma_f32_32x32x16_bf16 v[32:47], a[248:251], a[40:43], v[32:47]
    s_waitcnt lgkmcnt(6)
    s_add_u32 m0, s44, 57344
    s_add_u32 s55, s53, 786432
    buffer_load_dwordx4 v230, s[20:23], s55 offen lds
    ds_read_b64_tr_b16 a[220:221], v249 offset:8192
    ds_read_b64_tr_b16 a[222:223], v249 offset:9216
    v_mfma_f32_32x32x16_bf16 v[48:63], a[252:255], a[40:43], v[48:63]
    s_waitcnt lgkmcnt(6)
    s_add_u32 m0, s44, 61440
    s_add_u32 s55, s53, 917504
    buffer_load_dwordx4 v230, s[20:23], s55 offen lds
    ds_read_b128 a[44:47], v75 offset:0
    ds_read_b64_tr_b16 a[224:225], v246 offset:4096
    ds_read_b64_tr_b16 a[226:227], v246 offset:5120
    v_mfma_f32_32x32x16_bf16 a[128:143], a[208:211], a[40:43], a[128:143]
    s_waitcnt lgkmcnt(7)
    s_add_u32 m0, s44, 147456
    s_add_u32 s55, s48, 98560
    buffer_load_dwordx4 v231, s[8:11], s55 offen lds
    ds_read_b64_tr_b16 a[228:229], v247 offset:4096
    ds_read_b64_tr_b16 a[230:231], v247 offset:5120
    ds_read_b64_tr_b16 a[248:249], v248 offset:12288
    ds_read_b64_tr_b16 a[250:251], v248 offset:13312
    v_mfma_f32_32x32x16_bf16 a[144:159], a[212:215], a[40:43], a[144:159]
    s_waitcnt lgkmcnt(9)
    s_add_u32 m0, s50, 151552
    s_add_u32 s55, s49, 256
    buffer_load_dwordx4 v231, s[8:11], s55 offen lds
    ds_read_b64_tr_b16 a[232:233], v248 offset:4096
    ds_read_b64_tr_b16 a[234:235], v248 offset:5120
    ds_read_b64_tr_b16 a[252:253], v249 offset:12288
    ds_read_b64_tr_b16 a[254:255], v249 offset:13312
    v_mfma_f32_32x32x16_bf16 a[160:175], a[216:219], a[40:43], a[160:175]
    s_waitcnt lgkmcnt(11)
    ds_read_b64_tr_b16 a[236:237], v249 offset:4096
    ds_read_b64_tr_b16 a[238:239], v249 offset:5120
    ds_read_b128 a[60:63], v77 offset:0
    ds_read_b64_tr_b16 a[208:209], v250 offset:0
    ds_read_b64_tr_b16 a[210:211], v250 offset:1024
    v_mfma_f32_32x32x16_bf16 a[176:191], a[220:223], a[40:43], a[176:191]
    s_waitcnt lgkmcnt(13)
    ds_read_b64_tr_b16 a[240:241], v246 offset:12288
    ds_read_b64_tr_b16 a[242:243], v246 offset:13312
    ds_read_b64_tr_b16 a[212:213], v251 offset:0
    ds_read_b64_tr_b16 a[214:215], v251 offset:1024
    v_mfma_f32_32x32x16_bf16 v[0:15], a[224:227], a[44:47], v[0:15]
    s_waitcnt lgkmcnt(15)
    ds_read_b64_tr_b16 a[244:245], v247 offset:12288
    ds_read_b64_tr_b16 a[246:247], v247 offset:13312
    ds_read_b64_tr_b16 a[216:217], v250 offset:8192
    ds_read_b64_tr_b16 a[218:219], v250 offset:9216
    v_mfma_f32_32x32x16_bf16 v[16:31], a[228:231], a[44:47], v[16:31]
    s_waitcnt lgkmcnt(15)
    ds_read_b64_tr_b16 a[220:221], v251 offset:8192
    ds_read_b64_tr_b16 a[222:223], v251 offset:9216
    v_mfma_f32_32x32x16_bf16 v[32:47], a[232:235], a[44:47], v[32:47]
    s_waitcnt lgkmcnt(13)
    v_mfma_f32_32x32x16_bf16 v[48:63], a[236:239], a[44:47], v[48:63]
    s_waitcnt lgkmcnt(8)
    v_mfma_f32_32x32x16_bf16 a[128:143], a[240:243], a[44:47], a[128:143]
    s_waitcnt lgkmcnt(4)
    v_mfma_f32_32x32x16_bf16 a[144:159], a[244:247], a[44:47], a[144:159]
    s_waitcnt vmcnt(9) lgkmcnt(0)
    s_barrier
    ds_read_b128 a[48:51], v72 offset:18432
    ds_read_b64_tr_b16 a[224:225], v246 offset:49152
    ds_read_b64_tr_b16 a[226:227], v246 offset:50176
    v_mfma_f32_32x32x16_bf16 a[160:175], a[248:251], a[44:47], a[160:175]
    ds_read_b64_tr_b16 a[228:229], v247 offset:49152
    ds_read_b64_tr_b16 a[230:231], v247 offset:50176
    v_mfma_f32_32x32x16_bf16 a[176:191], a[252:255], a[44:47], a[176:191]
    ds_read_b64_tr_b16 a[232:233], v248 offset:49152
    ds_read_b64_tr_b16 a[234:235], v248 offset:50176
    v_mfma_f32_16x16x32_bf16 v[64:67], a[208:211], a[60:63], v[64:67]
    ds_read_b64_tr_b16 a[236:237], v249 offset:49152
    ds_read_b64_tr_b16 a[238:239], v249 offset:50176
    v_mfma_f32_16x16x32_bf16 v[68:71], a[212:215], a[60:63], v[68:71]
    v_mfma_f32_16x16x32_bf16 a[192:195], a[216:219], a[60:63], a[192:195]
    ds_read_b64_tr_b16 a[240:241], v246 offset:57344
    ds_read_b64_tr_b16 a[242:243], v246 offset:58368
    v_mfma_f32_16x16x32_bf16 a[196:199], a[220:223], a[60:63], a[196:199]
    s_waitcnt lgkmcnt(8)
    v_mfma_f32_32x32x16_bf16 v[0:15], a[224:227], a[48:51], v[0:15]
    s_waitcnt lgkmcnt(6)
    s_add_u32 m0, s44, 32768
    s_add_u32 s55, s47, 1048576
    buffer_load_dwordx4 v230, s[20:23], s55 offen lds
    ds_read_b64_tr_b16 a[244:245], v247 offset:57344
    ds_read_b64_tr_b16 a[246:247], v247 offset:58368
    v_mfma_f32_32x32x16_bf16 v[16:31], a[228:231], a[48:51], v[16:31]
    s_waitcnt lgkmcnt(6)
    s_add_u32 m0, s44, 36864
    s_add_u32 s55, s47, 1179648
    buffer_load_dwordx4 v230, s[20:23], s55 offen lds
    ds_read_b64_tr_b16 a[248:249], v248 offset:57344
    ds_read_b64_tr_b16 a[250:251], v248 offset:58368
    v_mfma_f32_32x32x16_bf16 v[32:47], a[232:235], a[48:51], v[32:47]
    s_waitcnt lgkmcnt(6)
    s_add_u32 m0, s44, 40960
    s_add_u32 s55, s53, 1048576
    buffer_load_dwordx4 v230, s[20:23], s55 offen lds
    ds_read_b64_tr_b16 a[252:253], v249 offset:57344
    ds_read_b64_tr_b16 a[254:255], v249 offset:58368
    v_mfma_f32_32x32x16_bf16 v[48:63], a[236:239], a[48:51], v[48:63]
    s_waitcnt lgkmcnt(6)
    s_add_u32 m0, s44, 45056
    s_add_u32 s55, s53, 1179648
    buffer_load_dwordx4 v230, s[20:23], s55 offen lds
    ds_read_b128 a[52:55], v73 offset:18432
    ds_read_b64_tr_b16 a[208:209], v246 offset:53248
    ds_read_b64_tr_b16 a[210:211], v246 offset:54272
    v_mfma_f32_32x32x16_bf16 a[128:143], a[240:243], a[48:51], a[128:143]
    s_waitcnt lgkmcnt(7)
    s_add_u32 m0, s44, 98304
    s_add_u32 s55, s48, 384
    buffer_load_dwordx4 v231, s[8:11], s55 offen lds
    ds_read_b64_tr_b16 a[212:213], v247 offset:53248
    ds_read_b64_tr_b16 a[214:215], v247 offset:54272
    ds_read_b64_tr_b16 a[232:233], v248 offset:61440
    ds_read_b64_tr_b16 a[234:235], v248 offset:62464
    v_mfma_f32_32x32x16_bf16 a[144:159], a[244:247], a[48:51], a[144:159]
    s_waitcnt lgkmcnt(9)
    s_add_u32 m0, s44, 102400
    s_add_u32 s55, s48, 33152
    buffer_load_dwordx4 v231, s[8:11], s55 offen lds
    ds_read_b64_tr_b16 a[216:217], v248 offset:53248
    ds_read_b64_tr_b16 a[218:219], v248 offset:54272
    ds_read_b64_tr_b16 a[236:237], v249 offset:61440
    ds_read_b64_tr_b16 a[238:239], v249 offset:62464
    v_mfma_f32_32x32x16_bf16 a[160:175], a[248:251], a[48:51], a[160:175]
    s_waitcnt lgkmcnt(11)
    s_add_u32 m0, s44, 106496
    s_add_u32 s55, s48, 65920
    buffer_load_dwordx4 v231, s[8:11], s55 offen lds
    ds_read_b64_tr_b16 a[220:221], v249 offset:53248
    ds_read_b64_tr_b16 a[222:223], v249 offset:54272
    ds_read_b128 a[56:59], v76 offset:18432
    ds_read_b64_tr_b16 a[240:241], v250 offset:49152
    ds_read_b64_tr_b16 a[242:243], v250 offset:50176
    v_mfma_f32_32x32x16_bf16 a[176:191], a[252:255], a[48:51], a[176:191]
    s_waitcnt lgkmcnt(13)
    ds_read_b64_tr_b16 a[224:225], v246 offset:61440
    ds_read_b64_tr_b16 a[226:227], v246 offset:62464
    ds_read_b64_tr_b16 a[244:245], v251 offset:49152
    ds_read_b64_tr_b16 a[246:247], v251 offset:50176
    v_mfma_f32_32x32x16_bf16 v[0:15], a[208:211], a[52:55], v[0:15]
    s_waitcnt lgkmcnt(15)
    ds_read_b64_tr_b16 a[228:229], v247 offset:61440
    ds_read_b64_tr_b16 a[230:231], v247 offset:62464
    ds_read_b64_tr_b16 a[248:249], v250 offset:57344
    ds_read_b64_tr_b16 a[250:251], v250 offset:58368
    v_mfma_f32_32x32x16_bf16 v[16:31], a[212:215], a[52:55], v[16:31]
    s_waitcnt lgkmcnt(15)
    ds_read_b64_tr_b16 a[252:253], v251 offset:57344
    ds_read_b64_tr_b16 a[254:255], v251 offset:58368
    v_mfma_f32_32x32x16_bf16 v[32:47], a[216:219], a[52:55], v[32:47]
    s_waitcnt lgkmcnt(13)
    v_mfma_f32_32x32x16_bf16 v[48:63], a[220:223], a[52:55], v[48:63]
    s_waitcnt lgkmcnt(8)
    v_mfma_f32_32x32x16_bf16 a[128:143], a[224:227], a[52:55], a[128:143]
    s_waitcnt lgkmcnt(4)
    v_mfma_f32_32x32x16_bf16 a[144:159], a[228:231], a[52:55], a[144:159]
    ds_read_b128 a[32:35], v74 offset:18432
    s_waitcnt vmcnt(9) lgkmcnt(1)
    s_barrier
    ds_read_b64_tr_b16 a[208:209], v246 offset:16384
    ds_read_b64_tr_b16 a[210:211], v246 offset:17408
    v_mfma_f32_32x32x16_bf16 a[160:175], a[232:235], a[52:55], a[160:175]
    ds_read_b64_tr_b16 a[212:213], v247 offset:16384
    ds_read_b64_tr_b16 a[214:215], v247 offset:17408
    v_mfma_f32_32x32x16_bf16 a[176:191], a[236:239], a[52:55], a[176:191]
    ds_read_b64_tr_b16 a[216:217], v248 offset:16384
    ds_read_b64_tr_b16 a[218:219], v248 offset:17408
    v_mfma_f32_16x16x32_bf16 v[64:67], a[240:243], a[56:59], v[64:67]
    ds_read_b64_tr_b16 a[220:221], v249 offset:16384
    ds_read_b64_tr_b16 a[222:223], v249 offset:17408
    v_mfma_f32_16x16x32_bf16 v[68:71], a[244:247], a[56:59], v[68:71]
    v_mfma_f32_16x16x32_bf16 a[192:195], a[248:251], a[56:59], a[192:195]
    ds_read_b64_tr_b16 a[224:225], v246 offset:24576
    ds_read_b64_tr_b16 a[226:227], v246 offset:25600
    v_mfma_f32_16x16x32_bf16 a[196:199], a[252:255], a[56:59], a[196:199]
    s_waitcnt lgkmcnt(8)
    v_mfma_f32_32x32x16_bf16 v[0:15], a[208:211], a[32:35], v[0:15]
    s_waitcnt lgkmcnt(6)
    s_add_u32 m0, s44, 81920
    s_add_u32 s55, s47, 1310720
    buffer_load_dwordx4 v230, s[20:23], s55 offen lds
    ds_read_b64_tr_b16 a[228:229], v247 offset:24576
    ds_read_b64_tr_b16 a[230:231], v247 offset:25600
    v_mfma_f32_32x32x16_bf16 v[16:31], a[212:215], a[32:35], v[16:31]
    s_waitcnt lgkmcnt(6)
    s_add_u32 m0, s44, 86016
    s_add_u32 s55, s47, 1441792
    buffer_load_dwordx4 v230, s[20:23], s55 offen lds
    ds_read_b64_tr_b16 a[232:233], v248 offset:24576
    ds_read_b64_tr_b16 a[234:235], v248 offset:25600
    v_mfma_f32_32x32x16_bf16 v[32:47], a[216:219], a[32:35], v[32:47]
    s_waitcnt lgkmcnt(6)
    s_add_u32 m0, s44, 90112
    s_add_u32 s55, s53, 1310720
    buffer_load_dwordx4 v230, s[20:23], s55 offen lds
    ds_read_b64_tr_b16 a[236:237], v249 offset:24576
    ds_read_b64_tr_b16 a[238:239], v249 offset:25600
    v_mfma_f32_32x32x16_bf16 v[48:63], a[220:223], a[32:35], v[48:63]
    s_waitcnt lgkmcnt(6)
    s_add_u32 m0, s44, 94208
    s_add_u32 s55, s53, 1441792
    buffer_load_dwordx4 v230, s[20:23], s55 offen lds
    ds_read_b128 a[36:39], v75 offset:18432
    ds_read_b64_tr_b16 a[240:241], v246 offset:20480
    ds_read_b64_tr_b16 a[242:243], v246 offset:21504
    v_mfma_f32_32x32x16_bf16 a[128:143], a[224:227], a[32:35], a[128:143]
    s_waitcnt lgkmcnt(7)
    s_add_u32 m0, s44, 110592
    s_add_u32 s55, s48, 98688
    buffer_load_dwordx4 v231, s[8:11], s55 offen lds
    ds_read_b64_tr_b16 a[244:245], v247 offset:20480
    ds_read_b64_tr_b16 a[246:247], v247 offset:21504
    ds_read_b64_tr_b16 a[216:217], v248 offset:28672
    ds_read_b64_tr_b16 a[218:219], v248 offset:29696
    v_mfma_f32_32x32x16_bf16 a[144:159], a[228:231], a[32:35], a[144:159]
    s_waitcnt lgkmcnt(9)
    s_add_u32 m0, s50, 114688
    s_add_u32 s55, s49, 384
    buffer_load_dwordx4 v231, s[8:11], s55 offen lds
    ds_read_b64_tr_b16 a[248:249], v248 offset:20480
    ds_read_b64_tr_b16 a[250:251], v248 offset:21504
    ds_read_b64_tr_b16 a[220:221], v249 offset:28672
    ds_read_b64_tr_b16 a[222:223], v249 offset:29696
    v_mfma_f32_32x32x16_bf16 a[160:175], a[232:235], a[32:35], a[160:175]
    s_waitcnt lgkmcnt(11)
    ds_read_b64_tr_b16 a[252:253], v249 offset:20480
    ds_read_b64_tr_b16 a[254:255], v249 offset:21504
    ds_read_b128 a[60:63], v77 offset:18432
    ds_read_b64_tr_b16 a[224:225], v250 offset:16384
    ds_read_b64_tr_b16 a[226:227], v250 offset:17408
    v_mfma_f32_32x32x16_bf16 a[176:191], a[236:239], a[32:35], a[176:191]
    s_waitcnt lgkmcnt(13)
    ds_read_b64_tr_b16 a[208:209], v246 offset:28672
    ds_read_b64_tr_b16 a[210:211], v246 offset:29696
    ds_read_b64_tr_b16 a[228:229], v251 offset:16384
    ds_read_b64_tr_b16 a[230:231], v251 offset:17408
    v_mfma_f32_32x32x16_bf16 v[0:15], a[240:243], a[36:39], v[0:15]
    s_waitcnt lgkmcnt(15)
    ds_read_b64_tr_b16 a[212:213], v247 offset:28672
    ds_read_b64_tr_b16 a[214:215], v247 offset:29696
    ds_read_b64_tr_b16 a[232:233], v250 offset:24576
    ds_read_b64_tr_b16 a[234:235], v250 offset:25600
    v_mfma_f32_32x32x16_bf16 v[16:31], a[244:247], a[36:39], v[16:31]
    s_waitcnt lgkmcnt(15)
    ds_read_b64_tr_b16 a[236:237], v251 offset:24576
    ds_read_b64_tr_b16 a[238:239], v251 offset:25600
    v_mfma_f32_32x32x16_bf16 v[32:47], a[248:251], a[36:39], v[32:47]
    s_waitcnt lgkmcnt(13)
    v_mfma_f32_32x32x16_bf16 v[48:63], a[252:255], a[36:39], v[48:63]
    s_waitcnt lgkmcnt(8)
    v_mfma_f32_32x32x16_bf16 a[128:143], a[208:211], a[36:39], a[128:143]
    s_waitcnt lgkmcnt(4)
    v_mfma_f32_32x32x16_bf16 a[144:159], a[212:215], a[36:39], a[144:159]
    s_waitcnt vmcnt(9) lgkmcnt(0)
    s_barrier
    ds_read_b128 a[40:43], v72 offset:36864
    ds_read_b64_tr_b16 a[240:241], v246 offset:0
    ds_read_b64_tr_b16 a[242:243], v246 offset:1024
    v_mfma_f32_32x32x16_bf16 a[160:175], a[216:219], a[36:39], a[160:175]
    ds_read_b64_tr_b16 a[244:245], v247 offset:0
    ds_read_b64_tr_b16 a[246:247], v247 offset:1024
    v_mfma_f32_32x32x16_bf16 a[176:191], a[220:223], a[36:39], a[176:191]
    ds_read_b64_tr_b16 a[248:249], v248 offset:0
    ds_read_b64_tr_b16 a[250:251], v248 offset:1024
    v_mfma_f32_16x16x32_bf16 v[64:67], a[224:227], a[60:63], v[64:67]
    ds_read_b64_tr_b16 a[252:253], v249 offset:0
    ds_read_b64_tr_b16 a[254:255], v249 offset:1024
    v_mfma_f32_16x16x32_bf16 v[68:71], a[228:231], a[60:63], v[68:71]
    v_mfma_f32_16x16x32_bf16 a[192:195], a[232:235], a[60:63], a[192:195]
    ds_read_b64_tr_b16 a[208:209], v246 offset:8192
    ds_read_b64_tr_b16 a[210:211], v246 offset:9216
    v_mfma_f32_16x16x32_bf16 a[196:199], a[236:239], a[60:63], a[196:199]
    s_waitcnt lgkmcnt(8)
    v_mfma_f32_32x32x16_bf16 v[0:15], a[240:243], a[40:43], v[0:15]
    s_waitcnt lgkmcnt(6)
    s_add_u32 m0, s44, 49152
    s_add_u32 s55, s47, 1572864
    buffer_load_dwordx4 v230, s[20:23], s55 offen lds
    ds_read_b64_tr_b16 a[212:213], v247 offset:8192
    ds_read_b64_tr_b16 a[214:215], v247 offset:9216
    v_mfma_f32_32x32x16_bf16 v[16:31], a[244:247], a[40:43], v[16:31]
    s_waitcnt lgkmcnt(6)
    s_add_u32 m0, s44, 53248
    s_add_u32 s55, s47, 1703936
    buffer_load_dwordx4 v230, s[20:23], s55 offen lds
    ds_read_b64_tr_b16 a[216:217], v248 offset:8192
    ds_read_b64_tr_b16 a[218:219], v248 offset:9216
    v_mfma_f32_32x32x16_bf16 v[32:47], a[248:251], a[40:43], v[32:47]
    s_waitcnt lgkmcnt(6)
    s_add_u32 m0, s44, 57344
    s_add_u32 s55, s53, 1572864
    buffer_load_dwordx4 v230, s[20:23], s55 offen lds
    ds_read_b64_tr_b16 a[220:221], v249 offset:8192
    ds_read_b64_tr_b16 a[222:223], v249 offset:9216
    v_mfma_f32_32x32x16_bf16 v[48:63], a[252:255], a[40:43], v[48:63]
    s_waitcnt lgkmcnt(6)
    s_add_u32 m0, s44, 61440
    s_add_u32 s55, s53, 1703936
    buffer_load_dwordx4 v230, s[20:23], s55 offen lds
    ds_read_b128 a[44:47], v73 offset:36864
    ds_read_b64_tr_b16 a[224:225], v246 offset:4096
    ds_read_b64_tr_b16 a[226:227], v246 offset:5120
    v_mfma_f32_32x32x16_bf16 a[128:143], a[208:211], a[40:43], a[128:143]
    s_waitcnt lgkmcnt(7)
    s_add_u32 m0, s44, 116736
    s_add_u32 s55, s48, 512
    buffer_load_dwordx4 v231, s[8:11], s55 offen lds
    ds_read_b64_tr_b16 a[228:229], v247 offset:4096
    ds_read_b64_tr_b16 a[230:231], v247 offset:5120
    ds_read_b64_tr_b16 a[248:249], v248 offset:12288
    ds_read_b64_tr_b16 a[250:251], v248 offset:13312
    v_mfma_f32_32x32x16_bf16 a[144:159], a[212:215], a[40:43], a[144:159]
    s_waitcnt lgkmcnt(9)
    s_add_u32 m0, s44, 120832
    s_add_u32 s55, s48, 33280
    buffer_load_dwordx4 v231, s[8:11], s55 offen lds
    ds_read_b64_tr_b16 a[232:233], v248 offset:4096
    ds_read_b64_tr_b16 a[234:235], v248 offset:5120
    ds_read_b64_tr_b16 a[252:253], v249 offset:12288
    ds_read_b64_tr_b16 a[254:255], v249 offset:13312
    v_mfma_f32_32x32x16_bf16 a[160:175], a[216:219], a[40:43], a[160:175]
    s_waitcnt lgkmcnt(11)
    s_add_u32 m0, s44, 124928
    s_add_u32 s55, s48, 66048
    buffer_load_dwordx4 v231, s[8:11], s55 offen lds
    ds_read_b64_tr_b16 a[236:237], v249 offset:4096
    ds_read_b64_tr_b16 a[238:239], v249 offset:5120
    ds_read_b128 a[56:59], v76 offset:36864
    ds_read_b64_tr_b16 a[208:209], v250 offset:0
    ds_read_b64_tr_b16 a[210:211], v250 offset:1024
    v_mfma_f32_32x32x16_bf16 a[176:191], a[220:223], a[40:43], a[176:191]
    s_waitcnt lgkmcnt(13)
    ds_read_b64_tr_b16 a[240:241], v246 offset:12288
    ds_read_b64_tr_b16 a[242:243], v246 offset:13312
    ds_read_b64_tr_b16 a[212:213], v251 offset:0
    ds_read_b64_tr_b16 a[214:215], v251 offset:1024
    v_mfma_f32_32x32x16_bf16 v[0:15], a[224:227], a[44:47], v[0:15]
    s_waitcnt lgkmcnt(15)
    ds_read_b64_tr_b16 a[244:245], v247 offset:12288
    ds_read_b64_tr_b16 a[246:247], v247 offset:13312
    ds_read_b64_tr_b16 a[216:217], v250 offset:8192
    ds_read_b64_tr_b16 a[218:219], v250 offset:9216
    v_mfma_f32_32x32x16_bf16 v[16:31], a[228:231], a[44:47], v[16:31]
    s_waitcnt lgkmcnt(15)
    ds_read_b64_tr_b16 a[220:221], v251 offset:8192
    ds_read_b64_tr_b16 a[222:223], v251 offset:9216
    v_mfma_f32_32x32x16_bf16 v[32:47], a[232:235], a[44:47], v[32:47]
    s_waitcnt lgkmcnt(13)
    v_mfma_f32_32x32x16_bf16 v[48:63], a[236:239], a[44:47], v[48:63]
    s_waitcnt lgkmcnt(8)
    v_mfma_f32_32x32x16_bf16 a[128:143], a[240:243], a[44:47], a[128:143]
    s_waitcnt lgkmcnt(4)
    v_mfma_f32_32x32x16_bf16 a[144:159], a[244:247], a[44:47], a[144:159]
    ds_read_b128 a[48:51], v74 offset:36864
    s_waitcnt vmcnt(9) lgkmcnt(1)
    s_barrier
    ds_read_b64_tr_b16 a[224:225], v246 offset:49152
    ds_read_b64_tr_b16 a[226:227], v246 offset:50176
    v_mfma_f32_32x32x16_bf16 a[160:175], a[248:251], a[44:47], a[160:175]
    ds_read_b64_tr_b16 a[228:229], v247 offset:49152
    ds_read_b64_tr_b16 a[230:231], v247 offset:50176
    v_mfma_f32_32x32x16_bf16 a[176:191], a[252:255], a[44:47], a[176:191]
    ds_read_b64_tr_b16 a[232:233], v248 offset:49152
    ds_read_b64_tr_b16 a[234:235], v248 offset:50176
    v_mfma_f32_16x16x32_bf16 v[64:67], a[208:211], a[56:59], v[64:67]
    ds_read_b64_tr_b16 a[236:237], v249 offset:49152
    ds_read_b64_tr_b16 a[238:239], v249 offset:50176
    v_mfma_f32_16x16x32_bf16 v[68:71], a[212:215], a[56:59], v[68:71]
    v_mfma_f32_16x16x32_bf16 a[192:195], a[216:219], a[56:59], a[192:195]
    ds_read_b64_tr_b16 a[240:241], v246 offset:57344
    ds_read_b64_tr_b16 a[242:243], v246 offset:58368
    v_mfma_f32_16x16x32_bf16 a[196:199], a[220:223], a[56:59], a[196:199]
    s_waitcnt lgkmcnt(8)
    v_mfma_f32_32x32x16_bf16 v[0:15], a[224:227], a[48:51], v[0:15]
    s_waitcnt lgkmcnt(6)
    s_add_u32 m0, s44, 32768
    s_add_u32 s55, s47, 1835008
    buffer_load_dwordx4 v230, s[20:23], s55 offen lds
    ds_read_b64_tr_b16 a[244:245], v247 offset:57344
    ds_read_b64_tr_b16 a[246:247], v247 offset:58368
    v_mfma_f32_32x32x16_bf16 v[16:31], a[228:231], a[48:51], v[16:31]
    s_waitcnt lgkmcnt(6)
    s_add_u32 m0, s44, 36864
    s_add_u32 s55, s47, 1966080
    buffer_load_dwordx4 v230, s[20:23], s55 offen lds
    ds_read_b64_tr_b16 a[248:249], v248 offset:57344
    ds_read_b64_tr_b16 a[250:251], v248 offset:58368
    s_lshr_b32 s7, s2, 3
    v_mfma_f32_32x32x16_bf16 v[32:47], a[232:235], a[48:51], v[32:47]
    s_waitcnt lgkmcnt(6)
    s_add_u32 m0, s44, 40960
    s_add_u32 s55, s53, 1835008
    buffer_load_dwordx4 v230, s[20:23], s55 offen lds
    ds_read_b64_tr_b16 a[252:253], v249 offset:57344
    ds_read_b64_tr_b16 a[254:255], v249 offset:58368
    s_lshl_b32 s7, s7, 5
    v_mfma_f32_32x32x16_bf16 v[48:63], a[236:239], a[48:51], v[48:63]
    s_waitcnt lgkmcnt(6)
    s_add_u32 m0, s44, 45056
    s_add_u32 s55, s53, 1966080
    buffer_load_dwordx4 v230, s[20:23], s55 offen lds
    ds_read_b128 a[52:55], v75 offset:36864
    ds_read_b64_tr_b16 a[208:209], v246 offset:53248
    ds_read_b64_tr_b16 a[210:211], v246 offset:54272
    v_mfma_f32_32x32x16_bf16 a[128:143], a[240:243], a[48:51], a[128:143]
    s_waitcnt lgkmcnt(7)
    s_add_u32 m0, s44, 129024
    s_add_u32 s55, s48, 98816
    buffer_load_dwordx4 v231, s[8:11], s55 offen lds
    ds_read_b64_tr_b16 a[212:213], v247 offset:53248
    ds_read_b64_tr_b16 a[214:215], v247 offset:54272
    ds_read_b64_tr_b16 a[232:233], v248 offset:61440
    ds_read_b64_tr_b16 a[234:235], v248 offset:62464
    v_mfma_f32_32x32x16_bf16 a[144:159], a[244:247], a[48:51], a[144:159]
    s_waitcnt lgkmcnt(9)
    s_add_u32 m0, s50, 133120
    s_add_u32 s55, s49, 512
    buffer_load_dwordx4 v231, s[8:11], s55 offen lds
    ds_read_b64_tr_b16 a[216:217], v248 offset:53248
    ds_read_b64_tr_b16 a[218:219], v248 offset:54272
    ds_read_b64_tr_b16 a[236:237], v249 offset:61440
    ds_read_b64_tr_b16 a[238:239], v249 offset:62464
    v_mfma_f32_32x32x16_bf16 a[160:175], a[248:251], a[48:51], a[160:175]
    s_waitcnt lgkmcnt(11)
    ds_read_b64_tr_b16 a[220:221], v249 offset:53248
    ds_read_b64_tr_b16 a[222:223], v249 offset:54272
    ds_read_b128 a[60:63], v77 offset:36864
    ds_read_b64_tr_b16 a[240:241], v250 offset:49152
    ds_read_b64_tr_b16 a[242:243], v250 offset:50176
    s_lshl_b32 s6, s36, 3
    v_mfma_f32_32x32x16_bf16 a[176:191], a[252:255], a[48:51], a[176:191]
    s_waitcnt lgkmcnt(13)
    ds_read_b64_tr_b16 a[224:225], v246 offset:61440
    ds_read_b64_tr_b16 a[226:227], v246 offset:62464
    ds_read_b64_tr_b16 a[244:245], v251 offset:49152
    ds_read_b64_tr_b16 a[246:247], v251 offset:50176
    s_add_u32 s7, s7, s6
    v_and_b32 v242, 112, v244
    v_mfma_f32_32x32x16_bf16 v[0:15], a[208:211], a[52:55], v[0:15]
    s_waitcnt lgkmcnt(15)
    ds_read_b64_tr_b16 a[228:229], v247 offset:61440
    ds_read_b64_tr_b16 a[230:231], v247 offset:62464
    ds_read_b64_tr_b16 a[248:249], v250 offset:57344
    ds_read_b64_tr_b16 a[250:251], v250 offset:58368
    v_lshlrev_b32 v242, 3, v242
    v_mfma_f32_32x32x16_bf16 v[16:31], a[212:215], a[52:55], v[16:31]
    s_waitcnt lgkmcnt(15)
    ds_read_b64_tr_b16 a[252:253], v251 offset:57344
    ds_read_b64_tr_b16 a[254:255], v251 offset:58368
    v_mfma_f32_32x32x16_bf16 v[32:47], a[216:219], a[52:55], v[32:47]
    s_waitcnt lgkmcnt(13)
    v_mfma_f32_32x32x16_bf16 v[48:63], a[220:223], a[52:55], v[48:63]
    s_waitcnt lgkmcnt(8)
    v_mfma_f32_32x32x16_bf16 a[128:143], a[224:227], a[52:55], a[128:143]
    s_waitcnt lgkmcnt(4)
    v_mfma_f32_32x32x16_bf16 a[144:159], a[228:231], a[52:55], a[144:159]
    s_waitcnt vmcnt(9) lgkmcnt(0)
    s_barrier
    ds_read_b128 a[32:35], v72 offset:0
    ds_read_b64_tr_b16 a[208:209], v246 offset:16384
    ds_read_b64_tr_b16 a[210:211], v246 offset:17408
    v_lshrrev_b32 v241, 7, v244
    v_add_u32 v241, s7, v241
    v_mfma_f32_32x32x16_bf16 a[160:175], a[232:235], a[52:55], a[160:175]
    s_lshl_b32 s7, s38, 20
    ds_read_b64_tr_b16 a[212:213], v247 offset:16384
    ds_read_b64_tr_b16 a[214:215], v247 offset:17408
    v_lshlrev_b32 v241, 10, v241
    v_add_u32 v241, v241, v242
    v_mfma_f32_32x32x16_bf16 a[176:191], a[236:239], a[52:55], a[176:191]
    ds_read_b64_tr_b16 a[216:217], v248 offset:16384
    ds_read_b64_tr_b16 a[218:219], v248 offset:17408
    v_mfma_f32_16x16x32_bf16 v[64:67], a[240:243], a[60:63], v[64:67]
    ds_read_b64_tr_b16 a[220:221], v249 offset:16384
    ds_read_b64_tr_b16 a[222:223], v249 offset:17408
    v_mfma_f32_16x16x32_bf16 v[68:71], a[244:247], a[60:63], v[68:71]
    v_mfma_f32_16x16x32_bf16 a[192:195], a[248:251], a[60:63], a[192:195]
    ds_read_b64_tr_b16 a[224:225], v246 offset:24576
    ds_read_b64_tr_b16 a[226:227], v246 offset:25600
    v_mfma_f32_16x16x32_bf16 a[196:199], a[252:255], a[60:63], a[196:199]
    s_waitcnt lgkmcnt(8)
    v_mfma_f32_32x32x16_bf16 v[0:15], a[208:211], a[32:35], v[0:15]
    s_waitcnt lgkmcnt(6)
    s_add_u32 m0, s44, 81920
    s_add_u32 s55, s47, 2097152
    buffer_load_dwordx4 v230, s[20:23], s55 offen lds
    ds_read_b64_tr_b16 a[228:229], v247 offset:24576
    ds_read_b64_tr_b16 a[230:231], v247 offset:25600
    v_mfma_f32_32x32x16_bf16 v[16:31], a[212:215], a[32:35], v[16:31]
    s_waitcnt lgkmcnt(6)
    s_add_u32 m0, s44, 86016
    s_add_u32 s55, s47, 2228224
    buffer_load_dwordx4 v230, s[20:23], s55 offen lds
    ds_read_b64_tr_b16 a[232:233], v248 offset:24576
    ds_read_b64_tr_b16 a[234:235], v248 offset:25600
    v_mfma_f32_32x32x16_bf16 v[32:47], a[216:219], a[32:35], v[32:47]
    s_waitcnt lgkmcnt(6)
    s_add_u32 m0, s44, 90112
    s_add_u32 s55, s53, 2097152
    buffer_load_dwordx4 v230, s[20:23], s55 offen lds
    ds_read_b64_tr_b16 a[236:237], v249 offset:24576
    ds_read_b64_tr_b16 a[238:239], v249 offset:25600
    v_mfma_f32_32x32x16_bf16 v[48:63], a[220:223], a[32:35], v[48:63]
    s_waitcnt lgkmcnt(6)
    s_add_u32 m0, s44, 94208
    s_add_u32 s55, s53, 2228224
    buffer_load_dwordx4 v230, s[20:23], s55 offen lds
    ds_read_b128 a[36:39], v73 offset:0
    ds_read_b64_tr_b16 a[240:241], v246 offset:20480
    ds_read_b64_tr_b16 a[242:243], v246 offset:21504
    v_mfma_f32_32x32x16_bf16 a[128:143], a[224:227], a[32:35], a[128:143]
    s_waitcnt lgkmcnt(7)
    s_add_u32 m0, s44, 135168
    s_add_u32 s55, s48, 640
    buffer_load_dwordx4 v231, s[8:11], s55 offen lds
    ds_read_b64_tr_b16 a[244:245], v247 offset:20480
    ds_read_b64_tr_b16 a[246:247], v247 offset:21504
    ds_read_b64_tr_b16 a[216:217], v248 offset:28672
    ds_read_b64_tr_b16 a[218:219], v248 offset:29696
    v_mfma_f32_32x32x16_bf16 a[144:159], a[228:231], a[32:35], a[144:159]
    s_waitcnt lgkmcnt(9)
    s_add_u32 m0, s44, 139264
    s_add_u32 s55, s48, 33408
    buffer_load_dwordx4 v231, s[8:11], s55 offen lds
    ds_read_b64_tr_b16 a[248:249], v248 offset:20480
    ds_read_b64_tr_b16 a[250:251], v248 offset:21504
    ds_read_b64_tr_b16 a[220:221], v249 offset:28672
    ds_read_b64_tr_b16 a[222:223], v249 offset:29696
    v_mfma_f32_32x32x16_bf16 a[160:175], a[232:235], a[32:35], a[160:175]
    s_waitcnt lgkmcnt(11)
    s_add_u32 m0, s44, 143360
    s_add_u32 s55, s48, 66176
    buffer_load_dwordx4 v231, s[8:11], s55 offen lds
    ds_read_b64_tr_b16 a[252:253], v249 offset:20480
    ds_read_b64_tr_b16 a[254:255], v249 offset:21504
    ds_read_b128 a[56:59], v76 offset:0
    ds_read_b64_tr_b16 a[224:225], v250 offset:16384
    ds_read_b64_tr_b16 a[226:227], v250 offset:17408
    v_mfma_f32_32x32x16_bf16 a[176:191], a[236:239], a[32:35], a[176:191]
    s_waitcnt lgkmcnt(13)
    ds_read_b64_tr_b16 a[208:209], v246 offset:28672
    ds_read_b64_tr_b16 a[210:211], v246 offset:29696
    ds_read_b64_tr_b16 a[228:229], v251 offset:16384
    ds_read_b64_tr_b16 a[230:231], v251 offset:17408
    v_mfma_f32_32x32x16_bf16 v[0:15], a[240:243], a[36:39], v[0:15]
    s_waitcnt lgkmcnt(15)
    buffer_load_dword a65, v241, s[28:31], s7 offen
    ds_read_b64_tr_b16 a[212:213], v247 offset:28672
    ds_read_b64_tr_b16 a[214:215], v247 offset:29696
    ds_read_b64_tr_b16 a[232:233], v250 offset:24576
    ds_read_b64_tr_b16 a[234:235], v250 offset:25600
    v_mfma_f32_32x32x16_bf16 v[16:31], a[244:247], a[36:39], v[16:31]
    s_waitcnt lgkmcnt(15)
    ds_read_b64_tr_b16 a[236:237], v251 offset:24576
    ds_read_b64_tr_b16 a[238:239], v251 offset:25600
    v_mfma_f32_32x32x16_bf16 v[32:47], a[248:251], a[36:39], v[32:47]
    s_waitcnt lgkmcnt(13)
    v_mfma_f32_32x32x16_bf16 v[48:63], a[252:255], a[36:39], v[48:63]
    s_waitcnt lgkmcnt(8)
    v_mfma_f32_32x32x16_bf16 a[128:143], a[208:211], a[36:39], a[128:143]
    s_waitcnt lgkmcnt(4)
    v_mfma_f32_32x32x16_bf16 a[144:159], a[212:215], a[36:39], a[144:159]
    ds_read_b128 a[40:43], v74 offset:0
    s_waitcnt vmcnt(10) lgkmcnt(1)
    s_barrier
    ds_read_b64_tr_b16 a[240:241], v246 offset:0
    ds_read_b64_tr_b16 a[242:243], v246 offset:1024
    v_mfma_f32_32x32x16_bf16 a[160:175], a[216:219], a[36:39], a[160:175]
    ds_read_b64_tr_b16 a[244:245], v247 offset:0
    ds_read_b64_tr_b16 a[246:247], v247 offset:1024
    v_mfma_f32_32x32x16_bf16 a[176:191], a[220:223], a[36:39], a[176:191]
    ds_read_b64_tr_b16 a[248:249], v248 offset:0
    ds_read_b64_tr_b16 a[250:251], v248 offset:1024
    v_mfma_f32_16x16x32_bf16 v[64:67], a[224:227], a[56:59], v[64:67]
    ds_read_b64_tr_b16 a[252:253], v249 offset:0
    ds_read_b64_tr_b16 a[254:255], v249 offset:1024
    v_mfma_f32_16x16x32_bf16 v[68:71], a[228:231], a[56:59], v[68:71]
    v_mfma_f32_16x16x32_bf16 a[192:195], a[232:235], a[56:59], a[192:195]
    ds_read_b64_tr_b16 a[208:209], v246 offset:8192
    ds_read_b64_tr_b16 a[210:211], v246 offset:9216
    v_mfma_f32_16x16x32_bf16 a[196:199], a[236:239], a[56:59], a[196:199]
    s_waitcnt lgkmcnt(8)
    v_mfma_f32_32x32x16_bf16 v[0:15], a[240:243], a[40:43], v[0:15]
    s_waitcnt lgkmcnt(6)
    s_add_u32 m0, s44, 49152
    s_add_u32 s55, s47, 2359296
    buffer_load_dwordx4 v230, s[20:23], s55 offen lds
    ds_read_b64_tr_b16 a[212:213], v247 offset:8192
    ds_read_b64_tr_b16 a[214:215], v247 offset:9216
    v_mfma_f32_32x32x16_bf16 v[16:31], a[244:247], a[40:43], v[16:31]
    s_waitcnt lgkmcnt(6)
    s_add_u32 m0, s44, 53248
    s_add_u32 s55, s47, 2490368
    buffer_load_dwordx4 v230, s[20:23], s55 offen lds
    ds_read_b64_tr_b16 a[216:217], v248 offset:8192
    ds_read_b64_tr_b16 a[218:219], v248 offset:9216
    v_mfma_f32_32x32x16_bf16 v[32:47], a[248:251], a[40:43], v[32:47]
    s_waitcnt lgkmcnt(6)
    s_add_u32 m0, s44, 57344
    s_add_u32 s55, s53, 2359296
    buffer_load_dwordx4 v230, s[20:23], s55 offen lds
    ds_read_b64_tr_b16 a[220:221], v249 offset:8192
    ds_read_b64_tr_b16 a[222:223], v249 offset:9216
    v_mfma_f32_32x32x16_bf16 v[48:63], a[252:255], a[40:43], v[48:63]
    s_waitcnt lgkmcnt(6)
    s_add_u32 m0, s44, 61440
    s_add_u32 s55, s53, 2490368
    buffer_load_dwordx4 v230, s[20:23], s55 offen lds
    ds_read_b128 a[44:47], v75 offset:0
    ds_read_b64_tr_b16 a[224:225], v246 offset:4096
    ds_read_b64_tr_b16 a[226:227], v246 offset:5120
    v_mfma_f32_32x32x16_bf16 a[128:143], a[208:211], a[40:43], a[128:143]
    s_waitcnt lgkmcnt(7)
    s_add_u32 m0, s44, 147456
    s_add_u32 s55, s48, 98944
    buffer_load_dwordx4 v231, s[8:11], s55 offen lds
    ds_read_b64_tr_b16 a[228:229], v247 offset:4096
    ds_read_b64_tr_b16 a[230:231], v247 offset:5120
    ds_read_b64_tr_b16 a[248:249], v248 offset:12288
    ds_read_b64_tr_b16 a[250:251], v248 offset:13312
    v_mfma_f32_32x32x16_bf16 a[144:159], a[212:215], a[40:43], a[144:159]
    s_waitcnt lgkmcnt(9)
    s_add_u32 m0, s50, 151552
    s_add_u32 s55, s49, 640
    buffer_load_dwordx4 v231, s[8:11], s55 offen lds
    ds_read_b64_tr_b16 a[232:233], v248 offset:4096
    ds_read_b64_tr_b16 a[234:235], v248 offset:5120
    ds_read_b64_tr_b16 a[252:253], v249 offset:12288
    ds_read_b64_tr_b16 a[254:255], v249 offset:13312
    v_mfma_f32_32x32x16_bf16 a[160:175], a[216:219], a[40:43], a[160:175]
    s_waitcnt lgkmcnt(11)
    ds_read_b64_tr_b16 a[236:237], v249 offset:4096
    ds_read_b64_tr_b16 a[238:239], v249 offset:5120
    ds_read_b128 a[60:63], v77 offset:0
    ds_read_b64_tr_b16 a[208:209], v250 offset:0
    ds_read_b64_tr_b16 a[210:211], v250 offset:1024
    v_mfma_f32_32x32x16_bf16 a[176:191], a[220:223], a[40:43], a[176:191]
    s_waitcnt lgkmcnt(13)
    ds_read_b64_tr_b16 a[240:241], v246 offset:12288
    ds_read_b64_tr_b16 a[242:243], v246 offset:13312
    ds_read_b64_tr_b16 a[212:213], v251 offset:0
    ds_read_b64_tr_b16 a[214:215], v251 offset:1024
    v_mfma_f32_32x32x16_bf16 v[0:15], a[224:227], a[44:47], v[0:15]
    s_waitcnt lgkmcnt(15)
    ds_read_b64_tr_b16 a[244:245], v247 offset:12288
    ds_read_b64_tr_b16 a[246:247], v247 offset:13312
    ds_read_b64_tr_b16 a[216:217], v250 offset:8192
    ds_read_b64_tr_b16 a[218:219], v250 offset:9216
    v_mfma_f32_32x32x16_bf16 v[16:31], a[228:231], a[44:47], v[16:31]
    s_waitcnt lgkmcnt(15)
    ds_read_b64_tr_b16 a[220:221], v251 offset:8192
    ds_read_b64_tr_b16 a[222:223], v251 offset:9216
    v_mfma_f32_32x32x16_bf16 v[32:47], a[232:235], a[44:47], v[32:47]
    s_waitcnt lgkmcnt(13)
    v_mfma_f32_32x32x16_bf16 v[48:63], a[236:239], a[44:47], v[48:63]
    s_waitcnt lgkmcnt(8)
    v_mfma_f32_32x32x16_bf16 a[128:143], a[240:243], a[44:47], a[128:143]
    s_waitcnt lgkmcnt(4)
    v_mfma_f32_32x32x16_bf16 a[144:159], a[244:247], a[44:47], a[144:159]
    s_waitcnt vmcnt(10) lgkmcnt(0)
    s_barrier
    ds_read_b128 a[48:51], v72 offset:18432
    ds_read_b64_tr_b16 a[224:225], v246 offset:49152
    ds_read_b64_tr_b16 a[226:227], v246 offset:50176
    v_mfma_f32_32x32x16_bf16 a[160:175], a[248:251], a[44:47], a[160:175]
    ds_read_b64_tr_b16 a[228:229], v247 offset:49152
    ds_read_b64_tr_b16 a[230:231], v247 offset:50176
    v_mfma_f32_32x32x16_bf16 a[176:191], a[252:255], a[44:47], a[176:191]
    ds_read_b64_tr_b16 a[232:233], v248 offset:49152
    ds_read_b64_tr_b16 a[234:235], v248 offset:50176
    v_mfma_f32_16x16x32_bf16 v[64:67], a[208:211], a[60:63], v[64:67]
    ds_read_b64_tr_b16 a[236:237], v249 offset:49152
    ds_read_b64_tr_b16 a[238:239], v249 offset:50176
    v_mfma_f32_16x16x32_bf16 v[68:71], a[212:215], a[60:63], v[68:71]
    v_mfma_f32_16x16x32_bf16 a[192:195], a[216:219], a[60:63], a[192:195]
    ds_read_b64_tr_b16 a[240:241], v246 offset:57344
    ds_read_b64_tr_b16 a[242:243], v246 offset:58368
    v_mfma_f32_16x16x32_bf16 a[196:199], a[220:223], a[60:63], a[196:199]
    s_waitcnt lgkmcnt(8)
    v_mfma_f32_32x32x16_bf16 v[0:15], a[224:227], a[48:51], v[0:15]
    s_waitcnt lgkmcnt(6)
    s_add_u32 m0, s44, 32768
    s_add_u32 s55, s47, 2621440
    buffer_load_dwordx4 v230, s[20:23], s55 offen lds
    ds_read_b64_tr_b16 a[244:245], v247 offset:57344
    ds_read_b64_tr_b16 a[246:247], v247 offset:58368
    v_mfma_f32_32x32x16_bf16 v[16:31], a[228:231], a[48:51], v[16:31]
    s_waitcnt lgkmcnt(6)
    s_add_u32 m0, s44, 36864
    s_add_u32 s55, s47, 2752512
    buffer_load_dwordx4 v230, s[20:23], s55 offen lds
    ds_read_b64_tr_b16 a[248:249], v248 offset:57344
    ds_read_b64_tr_b16 a[250:251], v248 offset:58368
    v_mfma_f32_32x32x16_bf16 v[32:47], a[232:235], a[48:51], v[32:47]
    s_waitcnt lgkmcnt(6)
    s_add_u32 m0, s44, 40960
    s_add_u32 s55, s53, 2621440
    buffer_load_dwordx4 v230, s[20:23], s55 offen lds
    ds_read_b64_tr_b16 a[252:253], v249 offset:57344
    ds_read_b64_tr_b16 a[254:255], v249 offset:58368
    v_mfma_f32_32x32x16_bf16 v[48:63], a[236:239], a[48:51], v[48:63]
    s_waitcnt lgkmcnt(6)
    s_add_u32 m0, s44, 45056
    s_add_u32 s55, s53, 2752512
    buffer_load_dwordx4 v230, s[20:23], s55 offen lds
    ds_read_b128 a[52:55], v73 offset:18432
    ds_read_b64_tr_b16 a[208:209], v246 offset:53248
    ds_read_b64_tr_b16 a[210:211], v246 offset:54272
    v_mfma_f32_32x32x16_bf16 a[128:143], a[240:243], a[48:51], a[128:143]
    s_waitcnt lgkmcnt(7)
    s_add_u32 m0, s44, 98304
    s_add_u32 s55, s48, 768
    buffer_load_dwordx4 v231, s[8:11], s55 offen lds
    ds_read_b64_tr_b16 a[212:213], v247 offset:53248
    ds_read_b64_tr_b16 a[214:215], v247 offset:54272
    ds_read_b64_tr_b16 a[232:233], v248 offset:61440
    ds_read_b64_tr_b16 a[234:235], v248 offset:62464
    v_mfma_f32_32x32x16_bf16 a[144:159], a[244:247], a[48:51], a[144:159]
    s_waitcnt lgkmcnt(9)
    s_add_u32 m0, s44, 102400
    s_add_u32 s55, s48, 33536
    buffer_load_dwordx4 v231, s[8:11], s55 offen lds
    ds_read_b64_tr_b16 a[216:217], v248 offset:53248
    ds_read_b64_tr_b16 a[218:219], v248 offset:54272
    ds_read_b64_tr_b16 a[236:237], v249 offset:61440
    ds_read_b64_tr_b16 a[238:239], v249 offset:62464
    v_mfma_f32_32x32x16_bf16 a[160:175], a[248:251], a[48:51], a[160:175]
    s_waitcnt lgkmcnt(11)
    s_add_u32 m0, s44, 106496
    s_add_u32 s55, s48, 66304
    buffer_load_dwordx4 v231, s[8:11], s55 offen lds
    ds_read_b64_tr_b16 a[220:221], v249 offset:53248
    ds_read_b64_tr_b16 a[222:223], v249 offset:54272
    ds_read_b128 a[56:59], v76 offset:18432
    ds_read_b64_tr_b16 a[240:241], v250 offset:49152
    ds_read_b64_tr_b16 a[242:243], v250 offset:50176
    v_mfma_f32_32x32x16_bf16 a[176:191], a[252:255], a[48:51], a[176:191]
    s_waitcnt lgkmcnt(13)
    ds_read_b64_tr_b16 a[224:225], v246 offset:61440
    ds_read_b64_tr_b16 a[226:227], v246 offset:62464
    ds_read_b64_tr_b16 a[244:245], v251 offset:49152
    ds_read_b64_tr_b16 a[246:247], v251 offset:50176
    v_mfma_f32_32x32x16_bf16 v[0:15], a[208:211], a[52:55], v[0:15]
    s_waitcnt lgkmcnt(15)
    s_add_u32 m0, s43, 0
    s_add_u32 s45, s42, 0
    ds_read_b64_tr_b16 a[228:229], v247 offset:61440
    ds_read_b64_tr_b16 a[230:231], v247 offset:62464
    ds_read_b64_tr_b16 a[248:249], v250 offset:57344
    ds_read_b64_tr_b16 a[250:251], v250 offset:58368
    v_mfma_f32_32x32x16_bf16 v[16:31], a[212:215], a[52:55], v[16:31]
    s_waitcnt lgkmcnt(15)
    buffer_load_dwordx4 v224, s[12:15], s45 offen nt lds
    buffer_load_dwordx4 v225, s[12:15], s45 offen offset:1024 nt lds
    ds_read_b64_tr_b16 a[252:253], v251 offset:57344
    ds_read_b64_tr_b16 a[254:255], v251 offset:58368
    v_mfma_f32_32x32x16_bf16 v[32:47], a[216:219], a[52:55], v[32:47]
    s_waitcnt lgkmcnt(13)
    v_mfma_f32_32x32x16_bf16 v[48:63], a[220:223], a[52:55], v[48:63]
    s_waitcnt lgkmcnt(8)
    v_mfma_f32_32x32x16_bf16 a[128:143], a[224:227], a[52:55], a[128:143]
    s_waitcnt lgkmcnt(4)
    v_mfma_f32_32x32x16_bf16 a[144:159], a[228:231], a[52:55], a[144:159]
    ds_read_b128 a[32:35], v74 offset:18432
    s_waitcnt vmcnt(11) lgkmcnt(1)
    s_barrier
    ds_read_b64_tr_b16 a[208:209], v246 offset:16384
    ds_read_b64_tr_b16 a[210:211], v246 offset:17408
    v_mfma_f32_32x32x16_bf16 a[160:175], a[232:235], a[52:55], a[160:175]
    ds_read_b64_tr_b16 a[212:213], v247 offset:16384
    ds_read_b64_tr_b16 a[214:215], v247 offset:17408
    v_mfma_f32_32x32x16_bf16 a[176:191], a[236:239], a[52:55], a[176:191]
    ds_read_b64_tr_b16 a[216:217], v248 offset:16384
    ds_read_b64_tr_b16 a[218:219], v248 offset:17408
    v_mfma_f32_16x16x32_bf16 v[64:67], a[240:243], a[56:59], v[64:67]
    ds_read_b64_tr_b16 a[220:221], v249 offset:16384
    ds_read_b64_tr_b16 a[222:223], v249 offset:17408
    v_mfma_f32_16x16x32_bf16 v[68:71], a[244:247], a[56:59], v[68:71]
    v_mfma_f32_16x16x32_bf16 a[192:195], a[248:251], a[56:59], a[192:195]
    ds_read_b64_tr_b16 a[224:225], v246 offset:24576
    ds_read_b64_tr_b16 a[226:227], v246 offset:25600
    v_mfma_f32_16x16x32_bf16 a[196:199], a[252:255], a[56:59], a[196:199]
    s_waitcnt lgkmcnt(8)
    v_mfma_f32_32x32x16_bf16 v[0:15], a[208:211], a[32:35], v[0:15]
    s_waitcnt lgkmcnt(6)
    s_add_u32 m0, s44, 81920
    s_add_u32 s55, s47, 2883584
    buffer_load_dwordx4 v230, s[20:23], s55 offen lds
    ds_read_b64_tr_b16 a[228:229], v247 offset:24576
    ds_read_b64_tr_b16 a[230:231], v247 offset:25600
    v_mfma_f32_32x32x16_bf16 v[16:31], a[212:215], a[32:35], v[16:31]
    s_waitcnt lgkmcnt(6)
    s_add_u32 m0, s44, 86016
    s_add_u32 s55, s47, 3014656
    buffer_load_dwordx4 v230, s[20:23], s55 offen lds
    ds_read_b64_tr_b16 a[232:233], v248 offset:24576
    ds_read_b64_tr_b16 a[234:235], v248 offset:25600
    v_mfma_f32_32x32x16_bf16 v[32:47], a[216:219], a[32:35], v[32:47]
    s_waitcnt lgkmcnt(6)
    s_add_u32 m0, s44, 90112
    s_add_u32 s55, s53, 2883584
    buffer_load_dwordx4 v230, s[20:23], s55 offen lds
    ds_read_b64_tr_b16 a[236:237], v249 offset:24576
    ds_read_b64_tr_b16 a[238:239], v249 offset:25600
    v_mfma_f32_32x32x16_bf16 v[48:63], a[220:223], a[32:35], v[48:63]
    s_waitcnt lgkmcnt(6)
    s_add_u32 m0, s44, 94208
    s_add_u32 s55, s53, 3014656
    buffer_load_dwordx4 v230, s[20:23], s55 offen lds
    ds_read_b128 a[36:39], v75 offset:18432
    ds_read_b64_tr_b16 a[240:241], v246 offset:20480
    ds_read_b64_tr_b16 a[242:243], v246 offset:21504
    v_mfma_f32_32x32x16_bf16 a[128:143], a[224:227], a[32:35], a[128:143]
    s_waitcnt lgkmcnt(7)
    s_add_u32 m0, s44, 110592
    s_add_u32 s55, s48, 99072
    buffer_load_dwordx4 v231, s[8:11], s55 offen lds
    ds_read_b64_tr_b16 a[244:245], v247 offset:20480
    ds_read_b64_tr_b16 a[246:247], v247 offset:21504
    ds_read_b64_tr_b16 a[216:217], v248 offset:28672
    ds_read_b64_tr_b16 a[218:219], v248 offset:29696
    v_mfma_f32_32x32x16_bf16 a[144:159], a[228:231], a[32:35], a[144:159]
    s_waitcnt lgkmcnt(9)
    s_add_u32 m0, s50, 114688
    s_add_u32 s55, s49, 768
    buffer_load_dwordx4 v231, s[8:11], s55 offen lds
    ds_read_b64_tr_b16 a[248:249], v248 offset:20480
    ds_read_b64_tr_b16 a[250:251], v248 offset:21504
    ds_read_b64_tr_b16 a[220:221], v249 offset:28672
    ds_read_b64_tr_b16 a[222:223], v249 offset:29696
    v_mfma_f32_32x32x16_bf16 a[160:175], a[232:235], a[32:35], a[160:175]
    s_waitcnt lgkmcnt(11)
    ds_read_b64_tr_b16 a[252:253], v249 offset:20480
    ds_read_b64_tr_b16 a[254:255], v249 offset:21504
    ds_read_b128 a[60:63], v77 offset:18432
    ds_read_b64_tr_b16 a[224:225], v250 offset:16384
    ds_read_b64_tr_b16 a[226:227], v250 offset:17408
    v_mfma_f32_32x32x16_bf16 a[176:191], a[236:239], a[32:35], a[176:191]
    s_waitcnt lgkmcnt(13)
    ds_read_b64_tr_b16 a[208:209], v246 offset:28672
    ds_read_b64_tr_b16 a[210:211], v246 offset:29696
    ds_read_b64_tr_b16 a[228:229], v251 offset:16384
    ds_read_b64_tr_b16 a[230:231], v251 offset:17408
    v_mfma_f32_32x32x16_bf16 v[0:15], a[240:243], a[36:39], v[0:15]
    s_waitcnt lgkmcnt(15)
    s_add_u32 m0, s43, 0
    s_add_u32 s45, s42, 0
    ds_read_b64_tr_b16 a[212:213], v247 offset:28672
    ds_read_b64_tr_b16 a[214:215], v247 offset:29696
    ds_read_b64_tr_b16 a[232:233], v250 offset:24576
    ds_read_b64_tr_b16 a[234:235], v250 offset:25600
    v_mfma_f32_32x32x16_bf16 v[16:31], a[244:247], a[36:39], v[16:31]
    s_waitcnt lgkmcnt(15)
    buffer_load_dwordx4 v226, s[12:15], s45 offen offset:2048 nt lds
    buffer_load_dwordx4 v227, s[12:15], s45 offen offset:3072 nt lds
    ds_read_b64_tr_b16 a[236:237], v251 offset:24576
    ds_read_b64_tr_b16 a[238:239], v251 offset:25600
    v_mfma_f32_32x32x16_bf16 v[32:47], a[248:251], a[36:39], v[32:47]
    s_waitcnt lgkmcnt(13)
    v_mfma_f32_32x32x16_bf16 v[48:63], a[252:255], a[36:39], v[48:63]
    s_waitcnt lgkmcnt(8)
    v_mfma_f32_32x32x16_bf16 a[128:143], a[208:211], a[36:39], a[128:143]
    s_waitcnt lgkmcnt(4)
    v_mfma_f32_32x32x16_bf16 a[144:159], a[212:215], a[36:39], a[144:159]
    s_waitcnt vmcnt(13) lgkmcnt(0)
    s_barrier
    ds_read_b128 a[40:43], v72 offset:36864
    ds_read_b64_tr_b16 a[240:241], v246 offset:0
    ds_read_b64_tr_b16 a[242:243], v246 offset:1024
    v_mfma_f32_32x32x16_bf16 a[160:175], a[216:219], a[36:39], a[160:175]
    ds_read_b64_tr_b16 a[244:245], v247 offset:0
    ds_read_b64_tr_b16 a[246:247], v247 offset:1024
    v_mfma_f32_32x32x16_bf16 a[176:191], a[220:223], a[36:39], a[176:191]
    ds_read_b64_tr_b16 a[248:249], v248 offset:0
    ds_read_b64_tr_b16 a[250:251], v248 offset:1024
    v_mfma_f32_16x16x32_bf16 v[64:67], a[224:227], a[60:63], v[64:67]
    ds_read_b64_tr_b16 a[252:253], v249 offset:0
    ds_read_b64_tr_b16 a[254:255], v249 offset:1024
    v_mfma_f32_16x16x32_bf16 v[68:71], a[228:231], a[60:63], v[68:71]
    v_mfma_f32_16x16x32_bf16 a[192:195], a[232:235], a[60:63], a[192:195]
    ds_read_b64_tr_b16 a[208:209], v246 offset:8192
    ds_read_b64_tr_b16 a[210:211], v246 offset:9216
    v_mfma_f32_16x16x32_bf16 a[196:199], a[236:239], a[60:63], a[196:199]
    s_waitcnt lgkmcnt(8)
    v_mfma_f32_32x32x16_bf16 v[0:15], a[240:243], a[40:43], v[0:15]
    s_waitcnt lgkmcnt(6)
    s_add_u32 m0, s44, 49152
    s_add_u32 s55, s47, 3145728
    buffer_load_dwordx4 v230, s[20:23], s55 offen lds
    ds_read_b64_tr_b16 a[212:213], v247 offset:8192
    ds_read_b64_tr_b16 a[214:215], v247 offset:9216
    v_mfma_f32_32x32x16_bf16 v[16:31], a[244:247], a[40:43], v[16:31]
    s_waitcnt lgkmcnt(6)
    s_add_u32 m0, s44, 53248
    s_add_u32 s55, s47, 3276800
    buffer_load_dwordx4 v230, s[20:23], s55 offen lds
    ds_read_b64_tr_b16 a[216:217], v248 offset:8192
    ds_read_b64_tr_b16 a[218:219], v248 offset:9216
    v_mfma_f32_32x32x16_bf16 v[32:47], a[248:251], a[40:43], v[32:47]
    s_waitcnt lgkmcnt(6)
    s_add_u32 m0, s44, 57344
    s_add_u32 s55, s53, 3145728
    buffer_load_dwordx4 v230, s[20:23], s55 offen lds
    ds_read_b64_tr_b16 a[220:221], v249 offset:8192
    ds_read_b64_tr_b16 a[222:223], v249 offset:9216
    v_mfma_f32_32x32x16_bf16 v[48:63], a[252:255], a[40:43], v[48:63]
    s_waitcnt lgkmcnt(6)
    s_add_u32 m0, s44, 61440
    s_add_u32 s55, s53, 3276800
    buffer_load_dwordx4 v230, s[20:23], s55 offen lds
    ds_read_b128 a[44:47], v73 offset:36864
    ds_read_b64_tr_b16 a[224:225], v246 offset:4096
    ds_read_b64_tr_b16 a[226:227], v246 offset:5120
    v_mfma_f32_32x32x16_bf16 a[128:143], a[208:211], a[40:43], a[128:143]
    s_waitcnt lgkmcnt(7)
    s_add_u32 m0, s44, 116736
    s_add_u32 s55, s48, 896
    buffer_load_dwordx4 v231, s[8:11], s55 offen lds
    ds_read_b64_tr_b16 a[228:229], v247 offset:4096
    ds_read_b64_tr_b16 a[230:231], v247 offset:5120
    ds_read_b64_tr_b16 a[248:249], v248 offset:12288
    ds_read_b64_tr_b16 a[250:251], v248 offset:13312
    v_and_b32 v238, 112, v244
    v_lshl_add_u32 v238, v238, 3, s44
    v_mfma_f32_32x32x16_bf16 a[144:159], a[212:215], a[40:43], a[144:159]
    s_waitcnt lgkmcnt(9)
    s_add_u32 m0, s44, 120832
    s_add_u32 s55, s48, 33664
    buffer_load_dwordx4 v231, s[8:11], s55 offen lds
    ds_read_b64_tr_b16 a[232:233], v248 offset:4096
    ds_read_b64_tr_b16 a[234:235], v248 offset:5120
    ds_read_b64_tr_b16 a[252:253], v249 offset:12288
    ds_read_b64_tr_b16 a[254:255], v249 offset:13312
    v_add_u32 v238, L_ih0 - L_ibase, v238
    v_min_u32 v238, L_end - L_ibase - 64, v238
    v_mfma_f32_32x32x16_bf16 a[160:175], a[216:219], a[40:43], a[160:175]
    s_waitcnt lgkmcnt(11)
    s_add_u32 m0, s44, 124928
    s_add_u32 s55, s48, 66432
    buffer_load_dwordx4 v231, s[8:11], s55 offen lds
    ds_read_b64_tr_b16 a[236:237], v249 offset:4096
    ds_read_b64_tr_b16 a[238:239], v249 offset:5120
    ds_read_b128 a[56:59], v76 offset:36864
    ds_read_b64_tr_b16 a[208:209], v250 offset:0
    ds_read_b64_tr_b16 a[210:211], v250 offset:1024
    v_mfma_f32_32x32x16_bf16 a[176:191], a[220:223], a[40:43], a[176:191]
    s_waitcnt lgkmcnt(13)
    global_load_dword a64, v238, s[90:91]
    ds_read_b64_tr_b16 a[240:241], v246 offset:12288
    ds_read_b64_tr_b16 a[242:243], v246 offset:13312
    ds_read_b64_tr_b16 a[212:213], v251 offset:0
    ds_read_b64_tr_b16 a[214:215], v251 offset:1024
    v_mfma_f32_32x32x16_bf16 v[0:15], a[224:227], a[44:47], v[0:15]
    s_waitcnt lgkmcnt(15)
    s_add_u32 m0, s43, 16384
    s_add_u32 s45, s42, 16384
    ds_read_b64_tr_b16 a[244:245], v247 offset:12288
    ds_read_b64_tr_b16 a[246:247], v247 offset:13312
    ds_read_b64_tr_b16 a[216:217], v250 offset:8192
    ds_read_b64_tr_b16 a[218:219], v250 offset:9216
    v_mfma_f32_32x32x16_bf16 v[16:31], a[228:231], a[44:47], v[16:31]
    s_waitcnt lgkmcnt(15)
    buffer_load_dwordx4 v224, s[12:15], s45 offen nt lds
    buffer_load_dwordx4 v225, s[12:15], s45 offen offset:1024 nt lds
    ds_read_b64_tr_b16 a[220:221], v251 offset:8192
    ds_read_b64_tr_b16 a[222:223], v251 offset:9216
    v_mfma_f32_32x32x16_bf16 v[32:47], a[232:235], a[44:47], v[32:47]
    s_waitcnt lgkmcnt(13)
    v_mfma_f32_32x32x16_bf16 v[48:63], a[236:239], a[44:47], v[48:63]
    s_waitcnt lgkmcnt(8)
    v_mfma_f32_32x32x16_bf16 a[128:143], a[240:243], a[44:47], a[128:143]
    s_waitcnt lgkmcnt(4)
    v_mfma_f32_32x32x16_bf16 a[144:159], a[244:247], a[44:47], a[144:159]
    ds_read_b128 a[48:51], v74 offset:36864
    s_waitcnt vmcnt(14) lgkmcnt(1)
    s_barrier
    ds_read_b64_tr_b16 a[224:225], v246 offset:49152
    ds_read_b64_tr_b16 a[226:227], v246 offset:50176
    v_mfma_f32_32x32x16_bf16 a[160:175], a[248:251], a[44:47], a[160:175]
    ds_read_b64_tr_b16 a[228:229], v247 offset:49152
    ds_read_b64_tr_b16 a[230:231], v247 offset:50176
    v_mfma_f32_32x32x16_bf16 a[176:191], a[252:255], a[44:47], a[176:191]
    ds_read_b64_tr_b16 a[232:233], v248 offset:49152
    ds_read_b64_tr_b16 a[234:235], v248 offset:50176
    v_mfma_f32_16x16x32_bf16 v[64:67], a[208:211], a[56:59], v[64:67]
    ds_read_b64_tr_b16 a[236:237], v249 offset:49152
    ds_read_b64_tr_b16 a[238:239], v249 offset:50176
    v_mfma_f32_16x16x32_bf16 v[68:71], a[212:215], a[56:59], v[68:71]
    v_mfma_f32_16x16x32_bf16 a[192:195], a[216:219], a[56:59], a[192:195]
    ds_read_b64_tr_b16 a[240:241], v246 offset:57344
    ds_read_b64_tr_b16 a[242:243], v246 offset:58368
    v_mfma_f32_16x16x32_bf16 a[196:199], a[220:223], a[56:59], a[196:199]
    s_waitcnt lgkmcnt(8)
    v_mfma_f32_32x32x16_bf16 v[0:15], a[224:227], a[48:51], v[0:15]
    s_waitcnt lgkmcnt(6)
    s_add_u32 m0, s44, 32768
    s_add_u32 s55, s47, 3407872
    buffer_load_dwordx4 v230, s[20:23], s55 offen lds
    ds_read_b64_tr_b16 a[244:245], v247 offset:57344
    ds_read_b64_tr_b16 a[246:247], v247 offset:58368
    v_mfma_f32_32x32x16_bf16 v[16:31], a[228:231], a[48:51], v[16:31]
    s_waitcnt lgkmcnt(6)
    s_add_u32 m0, s44, 36864
    s_add_u32 s55, s47, 3538944
    buffer_load_dwordx4 v230, s[20:23], s55 offen lds
    ds_read_b64_tr_b16 a[248:249], v248 offset:57344
    ds_read_b64_tr_b16 a[250:251], v248 offset:58368
    v_mfma_f32_32x32x16_bf16 v[32:47], a[232:235], a[48:51], v[32:47]
    s_waitcnt lgkmcnt(6)
    s_add_u32 m0, s44, 40960
    s_add_u32 s55, s53, 3407872
    buffer_load_dwordx4 v230, s[20:23], s55 offen lds
    ds_read_b64_tr_b16 a[252:253], v249 offset:57344
    ds_read_b64_tr_b16 a[254:255], v249 offset:58368
    v_mfma_f32_32x32x16_bf16 v[48:63], a[236:239], a[48:51], v[48:63]
    s_waitcnt lgkmcnt(6)
    s_add_u32 m0, s44, 45056
    s_add_u32 s55, s53, 3538944
    buffer_load_dwordx4 v230, s[20:23], s55 offen lds
    ds_read_b128 a[52:55], v75 offset:36864
    ds_read_b64_tr_b16 a[208:209], v246 offset:53248
    ds_read_b64_tr_b16 a[210:211], v246 offset:54272
    v_mfma_f32_32x32x16_bf16 a[128:143], a[240:243], a[48:51], a[128:143]
    s_waitcnt lgkmcnt(7)
    s_add_u32 m0, s44, 129024
    s_add_u32 s55, s48, 99200
    buffer_load_dwordx4 v231, s[8:11], s55 offen lds
    ds_read_b64_tr_b16 a[212:213], v247 offset:53248
    ds_read_b64_tr_b16 a[214:215], v247 offset:54272
    ds_read_b64_tr_b16 a[232:233], v248 offset:61440
    ds_read_b64_tr_b16 a[234:235], v248 offset:62464
    v_mfma_f32_32x32x16_bf16 a[144:159], a[244:247], a[48:51], a[144:159]
    s_waitcnt lgkmcnt(9)
    s_add_u32 m0, s50, 133120
    s_add_u32 s55, s49, 896
    buffer_load_dwordx4 v231, s[8:11], s55 offen lds
    ds_read_b64_tr_b16 a[216:217], v248 offset:53248
    ds_read_b64_tr_b16 a[218:219], v248 offset:54272
    ds_read_b64_tr_b16 a[236:237], v249 offset:61440
    ds_read_b64_tr_b16 a[238:239], v249 offset:62464
    v_mfma_f32_32x32x16_bf16 a[160:175], a[248:251], a[48:51], a[160:175]
    s_waitcnt lgkmcnt(11)
    ds_read_b64_tr_b16 a[220:221], v249 offset:53248
    ds_read_b64_tr_b16 a[222:223], v249 offset:54272
    ds_read_b128 a[60:63], v77 offset:36864
    ds_read_b64_tr_b16 a[240:241], v250 offset:49152
    ds_read_b64_tr_b16 a[242:243], v250 offset:50176
    v_mfma_f32_32x32x16_bf16 a[176:191], a[252:255], a[48:51], a[176:191]
    s_waitcnt lgkmcnt(13)
    ds_read_b64_tr_b16 a[224:225], v246 offset:61440
    ds_read_b64_tr_b16 a[226:227], v246 offset:62464
    ds_read_b64_tr_b16 a[244:245], v251 offset:49152
    ds_read_b64_tr_b16 a[246:247], v251 offset:50176
    v_mfma_f32_32x32x16_bf16 v[0:15], a[208:211], a[52:55], v[0:15]
    s_waitcnt lgkmcnt(15)
    s_add_u32 m0, s43, 16384
    s_add_u32 s45, s42, 16384
    ds_read_b64_tr_b16 a[228:229], v247 offset:61440
    ds_read_b64_tr_b16 a[230:231], v247 offset:62464
    ds_read_b64_tr_b16 a[248:249], v250 offset:57344
    ds_read_b64_tr_b16 a[250:251], v250 offset:58368
    v_mfma_f32_32x32x16_bf16 v[16:31], a[212:215], a[52:55], v[16:31]
    s_waitcnt lgkmcnt(15)
    buffer_load_dwordx4 v226, s[12:15], s45 offen offset:2048 nt lds
    buffer_load_dwordx4 v227, s[12:15], s45 offen offset:3072 nt lds
    ds_read_b64_tr_b16 a[252:253], v251 offset:57344
    ds_read_b64_tr_b16 a[254:255], v251 offset:58368
    v_mfma_f32_32x32x16_bf16 v[32:47], a[216:219], a[52:55], v[32:47]
    s_waitcnt lgkmcnt(13)
    v_mfma_f32_32x32x16_bf16 v[48:63], a[220:223], a[52:55], v[48:63]
    s_waitcnt lgkmcnt(8)
    v_mfma_f32_32x32x16_bf16 a[128:143], a[224:227], a[52:55], a[128:143]
    s_waitcnt lgkmcnt(4)
    v_mfma_f32_32x32x16_bf16 a[144:159], a[228:231], a[52:55], a[144:159]
    s_waitcnt vmcnt(14) lgkmcnt(0)
    s_barrier
    ds_read_b128 a[32:35], v72 offset:0
    ds_read_b64_tr_b16 a[208:209], v246 offset:16384
    ds_read_b64_tr_b16 a[210:211], v246 offset:17408
    v_mfma_f32_32x32x16_bf16 a[160:175], a[232:235], a[52:55], a[160:175]
    ds_read_b64_tr_b16 a[212:213], v247 offset:16384
    ds_read_b64_tr_b16 a[214:215], v247 offset:17408
    v_mfma_f32_32x32x16_bf16 a[176:191], a[236:239], a[52:55], a[176:191]
    ds_read_b64_tr_b16 a[216:217], v248 offset:16384
    ds_read_b64_tr_b16 a[218:219], v248 offset:17408
    v_mfma_f32_16x16x32_bf16 v[64:67], a[240:243], a[60:63], v[64:67]
    ds_read_b64_tr_b16 a[220:221], v249 offset:16384
    ds_read_b64_tr_b16 a[222:223], v249 offset:17408
    v_mfma_f32_16x16x32_bf16 v[68:71], a[244:247], a[60:63], v[68:71]
    v_mfma_f32_16x16x32_bf16 a[192:195], a[248:251], a[60:63], a[192:195]
    ds_read_b64_tr_b16 a[224:225], v246 offset:24576
    ds_read_b64_tr_b16 a[226:227], v246 offset:25600
    v_mfma_f32_16x16x32_bf16 a[196:199], a[252:255], a[60:63], a[196:199]
    s_waitcnt lgkmcnt(8)
    v_mfma_f32_32x32x16_bf16 v[0:15], a[208:211], a[32:35], v[0:15]
    s_waitcnt lgkmcnt(6)
    s_add_u32 m0, s44, 81920
    s_add_u32 s55, s47, 3670016
    buffer_load_dwordx4 v230, s[20:23], s55 offen lds
    ds_read_b64_tr_b16 a[228:229], v247 offset:24576
    ds_read_b64_tr_b16 a[230:231], v247 offset:25600
    v_mfma_f32_32x32x16_bf16 v[16:31], a[212:215], a[32:35], v[16:31]
    s_waitcnt lgkmcnt(6)
    s_add_u32 m0, s44, 86016
    s_add_u32 s55, s47, 3801088
    buffer_load_dwordx4 v230, s[20:23], s55 offen lds
    ds_read_b64_tr_b16 a[232:233], v248 offset:24576
    ds_read_b64_tr_b16 a[234:235], v248 offset:25600
    v_mfma_f32_32x32x16_bf16 v[32:47], a[216:219], a[32:35], v[32:47]
    s_waitcnt lgkmcnt(6)
    s_add_u32 m0, s44, 90112
    s_add_u32 s55, s53, 3670016
    buffer_load_dwordx4 v230, s[20:23], s55 offen lds
    ds_read_b64_tr_b16 a[236:237], v249 offset:24576
    ds_read_b64_tr_b16 a[238:239], v249 offset:25600
    v_mfma_f32_32x32x16_bf16 v[48:63], a[220:223], a[32:35], v[48:63]
    s_waitcnt lgkmcnt(6)
    s_add_u32 m0, s44, 94208
    s_add_u32 s55, s53, 3801088
    buffer_load_dwordx4 v230, s[20:23], s55 offen lds
    ds_read_b128 a[36:39], v73 offset:0
    ds_read_b64_tr_b16 a[240:241], v246 offset:20480
    ds_read_b64_tr_b16 a[242:243], v246 offset:21504
    v_mfma_f32_32x32x16_bf16 a[128:143], a[224:227], a[32:35], a[128:143]
    s_waitcnt lgkmcnt(7)
    ds_read_b64_tr_b16 a[244:245], v247 offset:20480
    ds_read_b64_tr_b16 a[246:247], v247 offset:21504
    ds_read_b64_tr_b16 a[216:217], v248 offset:28672
    ds_read_b64_tr_b16 a[218:219], v248 offset:29696
    v_mfma_f32_32x32x16_bf16 a[144:159], a[228:231], a[32:35], a[144:159]
    s_waitcnt lgkmcnt(9)
    ds_read_b64_tr_b16 a[248:249], v248 offset:20480
    ds_read_b64_tr_b16 a[250:251], v248 offset:21504
    ds_read_b64_tr_b16 a[220:221], v249 offset:28672
    ds_read_b64_tr_b16 a[222:223], v249 offset:29696
    v_mfma_f32_32x32x16_bf16 a[160:175], a[232:235], a[32:35], a[160:175]
    s_waitcnt lgkmcnt(11)
    ds_read_b64_tr_b16 a[252:253], v249 offset:20480
    ds_read_b64_tr_b16 a[254:255], v249 offset:21504
    ds_read_b128 a[56:59], v76 offset:0
    ds_read_b64_tr_b16 a[224:225], v250 offset:16384
    ds_read_b64_tr_b16 a[226:227], v250 offset:17408
    v_mfma_f32_32x32x16_bf16 a[176:191], a[236:239], a[32:35], a[176:191]
    s_waitcnt lgkmcnt(13)
    ds_read_b64_tr_b16 a[208:209], v246 offset:28672
    ds_read_b64_tr_b16 a[210:211], v246 offset:29696
    ds_read_b64_tr_b16 a[228:229], v251 offset:16384
    ds_read_b64_tr_b16 a[230:231], v251 offset:17408
    v_mfma_f32_32x32x16_bf16 v[0:15], a[240:243], a[36:39], v[0:15]
    s_waitcnt lgkmcnt(15)
    s_add_u32 m0, s43, 65536
    s_add_u32 s46, s42, 0
    ds_read_b64_tr_b16 a[212:213], v247 offset:28672
    ds_read_b64_tr_b16 a[214:215], v247 offset:29696
    ds_read_b64_tr_b16 a[232:233], v250 offset:24576
    ds_read_b64_tr_b16 a[234:235], v250 offset:25600
    v_mfma_f32_32x32x16_bf16 v[16:31], a[244:247], a[36:39], v[16:31]
    s_waitcnt lgkmcnt(15)
    buffer_load_dwordx4 v228, s[16:19], s46 offen nt lds
    buffer_load_dwordx4 v229, s[16:19], s46 offen offset:1024 nt lds
    ds_read_b64_tr_b16 a[236:237], v251 offset:24576
    ds_read_b64_tr_b16 a[238:239], v251 offset:25600
    v_mfma_f32_32x32x16_bf16 v[32:47], a[248:251], a[36:39], v[32:47]
    s_waitcnt lgkmcnt(13)
    v_mfma_f32_32x32x16_bf16 v[48:63], a[252:255], a[36:39], v[48:63]
    s_waitcnt lgkmcnt(8)
    v_mfma_f32_32x32x16_bf16 a[128:143], a[208:211], a[36:39], a[128:143]
    s_waitcnt lgkmcnt(4)
    v_mfma_f32_32x32x16_bf16 a[144:159], a[212:215], a[36:39], a[144:159]
    ds_read_b128 a[40:43], v74 offset:0
    s_waitcnt vmcnt(10) lgkmcnt(1)
    s_barrier
    ds_read_b64_tr_b16 a[240:241], v246 offset:0
    ds_read_b64_tr_b16 a[242:243], v246 offset:1024
    v_mfma_f32_32x32x16_bf16 a[160:175], a[216:219], a[36:39], a[160:175]
    ds_read_b64_tr_b16 a[244:245], v247 offset:0
    ds_read_b64_tr_b16 a[246:247], v247 offset:1024
    v_mfma_f32_32x32x16_bf16 a[176:191], a[220:223], a[36:39], a[176:191]
    ds_read_b64_tr_b16 a[248:249], v248 offset:0
    ds_read_b64_tr_b16 a[250:251], v248 offset:1024
    v_mfma_f32_16x16x32_bf16 v[64:67], a[224:227], a[56:59], v[64:67]
    ds_read_b64_tr_b16 a[252:253], v249 offset:0
    ds_read_b64_tr_b16 a[254:255], v249 offset:1024
    v_mfma_f32_16x16x32_bf16 v[68:71], a[228:231], a[56:59], v[68:71]
    v_mfma_f32_16x16x32_bf16 a[192:195], a[232:235], a[56:59], a[192:195]
    ds_read_b64_tr_b16 a[208:209], v246 offset:8192
    ds_read_b64_tr_b16 a[210:211], v246 offset:9216
    v_mfma_f32_16x16x32_bf16 a[196:199], a[236:239], a[56:59], a[196:199]
    s_waitcnt lgkmcnt(8)
    v_mfma_f32_32x32x16_bf16 v[0:15], a[240:243], a[40:43], v[0:15]
    s_waitcnt lgkmcnt(6)
    s_add_u32 m0, s44, 49152
    s_add_u32 s55, s47, 3932160
    buffer_load_dwordx4 v230, s[20:23], s55 offen lds
    ds_read_b64_tr_b16 a[212:213], v247 offset:8192
    ds_read_b64_tr_b16 a[214:215], v247 offset:9216
    v_mfma_f32_32x32x16_bf16 v[16:31], a[244:247], a[40:43], v[16:31]
    s_waitcnt lgkmcnt(6)
    s_add_u32 m0, s44, 53248
    s_add_u32 s55, s47, 4063232
    buffer_load_dwordx4 v230, s[20:23], s55 offen lds
    ds_read_b64_tr_b16 a[216:217], v248 offset:8192
    ds_read_b64_tr_b16 a[218:219], v248 offset:9216
    v_mfma_f32_32x32x16_bf16 v[32:47], a[248:251], a[40:43], v[32:47]
    s_waitcnt lgkmcnt(6)
    s_add_u32 m0, s44, 57344
    s_add_u32 s55, s53, 3932160
    buffer_load_dwordx4 v230, s[20:23], s55 offen lds
    ds_read_b64_tr_b16 a[220:221], v249 offset:8192
    ds_read_b64_tr_b16 a[222:223], v249 offset:9216
    v_mfma_f32_32x32x16_bf16 v[48:63], a[252:255], a[40:43], v[48:63]
    s_waitcnt lgkmcnt(6)
    s_add_u32 m0, s44, 61440
    s_add_u32 s55, s53, 4063232
    buffer_load_dwordx4 v230, s[20:23], s55 offen lds
    ds_read_b128 a[44:47], v75 offset:0
    ds_read_b64_tr_b16 a[224:225], v246 offset:4096
    ds_read_b64_tr_b16 a[226:227], v246 offset:5120
    v_mfma_f32_32x32x16_bf16 a[128:143], a[208:211], a[40:43], a[128:143]
    s_waitcnt lgkmcnt(7)
    ds_read_b64_tr_b16 a[228:229], v247 offset:4096
    ds_read_b64_tr_b16 a[230:231], v247 offset:5120
    ds_read_b64_tr_b16 a[248:249], v248 offset:12288
    ds_read_b64_tr_b16 a[250:251], v248 offset:13312
    v_and_b32 v238, 112, v244
    v_lshl_add_u32 v238, v238, 3, s44
    v_mfma_f32_32x32x16_bf16 a[144:159], a[212:215], a[40:43], a[144:159]
    s_waitcnt lgkmcnt(9)
    ds_read_b64_tr_b16 a[232:233], v248 offset:4096
    ds_read_b64_tr_b16 a[234:235], v248 offset:5120
    ds_read_b64_tr_b16 a[252:253], v249 offset:12288
    ds_read_b64_tr_b16 a[254:255], v249 offset:13312
    v_add_u32 v238, L_ih1 - L_ibase, v238
    v_min_u32 v238, L_end - L_ibase - 64, v238
    v_mfma_f32_32x32x16_bf16 a[160:175], a[216:219], a[40:43], a[160:175]
    s_waitcnt lgkmcnt(11)
    ds_read_b64_tr_b16 a[236:237], v249 offset:4096
    ds_read_b64_tr_b16 a[238:239], v249 offset:5120
    ds_read_b128 a[60:63], v77 offset:0
    ds_read_b64_tr_b16 a[208:209], v250 offset:0
    ds_read_b64_tr_b16 a[210:211], v250 offset:1024
    v_mfma_f32_32x32x16_bf16 a[176:191], a[220:223], a[40:43], a[176:191]
    s_waitcnt lgkmcnt(13)
    global_load_dword a64, v238, s[90:91]
    ds_read_b64_tr_b16 a[240:241], v246 offset:12288
    ds_read_b64_tr_b16 a[242:243], v246 offset:13312
    ds_read_b64_tr_b16 a[212:213], v251 offset:0
    ds_read_b64_tr_b16 a[214:215], v251 offset:1024
    v_mfma_f32_32x32x16_bf16 v[0:15], a[224:227], a[44:47], v[0:15]
    s_waitcnt lgkmcnt(15)
    s_add_u32 m0, s43, 65536
    s_add_u32 s46, s42, 0
    ds_read_b64_tr_b16 a[244:245], v247 offset:12288
    ds_read_b64_tr_b16 a[246:247], v247 offset:13312
    ds_read_b64_tr_b16 a[216:217], v250 offset:8192
    ds_read_b64_tr_b16 a[218:219], v250 offset:9216
    v_mfma_f32_32x32x16_bf16 v[16:31], a[228:231], a[44:47], v[16:31]
    s_waitcnt lgkmcnt(15)
    buffer_load_dwordx4 v228, s[16:19], s46 offen offset:2048 nt lds
    buffer_load_dwordx4 v229, s[16:19], s46 offen offset:3072 nt lds
    ds_read_b64_tr_b16 a[220:221], v251 offset:8192
    ds_read_b64_tr_b16 a[222:223], v251 offset:9216
    v_mfma_f32_32x32x16_bf16 v[32:47], a[232:235], a[44:47], v[32:47]
    s_waitcnt lgkmcnt(13)
    v_mfma_f32_32x32x16_bf16 v[48:63], a[236:239], a[44:47], v[48:63]
    s_waitcnt lgkmcnt(8)
    v_mfma_f32_32x32x16_bf16 a[128:143], a[240:243], a[44:47], a[128:143]
    s_waitcnt lgkmcnt(4)
    v_mfma_f32_32x32x16_bf16 a[144:159], a[244:247], a[44:47], a[144:159]
    s_waitcnt vmcnt(9) lgkmcnt(0)
    s_barrier
    ds_read_b128 a[48:51], v72 offset:18432
    ds_read_b64_tr_b16 a[224:225], v246 offset:49152
    ds_read_b64_tr_b16 a[226:227], v246 offset:50176
    v_mfma_f32_32x32x16_bf16 a[160:175], a[248:251], a[44:47], a[160:175]
    ds_read_b64_tr_b16 a[228:229], v247 offset:49152
    ds_read_b64_tr_b16 a[230:231], v247 offset:50176
    v_mfma_f32_32x32x16_bf16 a[176:191], a[252:255], a[44:47], a[176:191]
    ds_read_b64_tr_b16 a[232:233], v248 offset:49152
    ds_read_b64_tr_b16 a[234:235], v248 offset:50176
    v_mfma_f32_16x16x32_bf16 v[64:67], a[208:211], a[60:63], v[64:67]
    ds_read_b64_tr_b16 a[236:237], v249 offset:49152
    ds_read_b64_tr_b16 a[238:239], v249 offset:50176
    v_mfma_f32_16x16x32_bf16 v[68:71], a[212:215], a[60:63], v[68:71]
    v_mfma_f32_16x16x32_bf16 a[192:195], a[216:219], a[60:63], a[192:195]
    ds_read_b64_tr_b16 a[240:241], v246 offset:57344
    ds_read_b64_tr_b16 a[242:243], v246 offset:58368
    v_mfma_f32_16x16x32_bf16 a[196:199], a[220:223], a[60:63], a[196:199]
    s_waitcnt lgkmcnt(8)
    v_mfma_f32_32x32x16_bf16 v[0:15], a[224:227], a[48:51], v[0:15]
    s_waitcnt lgkmcnt(6)
    s_add_u32 m0, s43, 32768
    s_add_u32 s45, s42, 32768
    buffer_load_dwordx4 v224, s[12:15], s45 offen nt lds
    ds_read_b64_tr_b16 a[244:245], v247 offset:57344
    ds_read_b64_tr_b16 a[246:247], v247 offset:58368
    v_mfma_f32_32x32x16_bf16 v[16:31], a[228:231], a[48:51], v[16:31]
    s_waitcnt lgkmcnt(6)
    buffer_load_dwordx4 v225, s[12:15], s45 offen offset:1024 nt lds
    ds_read_b64_tr_b16 a[248:249], v248 offset:57344
    ds_read_b64_tr_b16 a[250:251], v248 offset:58368
    v_mfma_f32_32x32x16_bf16 v[32:47], a[232:235], a[48:51], v[32:47]
    s_waitcnt lgkmcnt(6)
    buffer_load_dwordx4 v226, s[12:15], s45 offen offset:2048 nt lds
    ds_read_b64_tr_b16 a[252:253], v249 offset:57344
    ds_read_b64_tr_b16 a[254:255], v249 offset:58368
    v_mfma_f32_32x32x16_bf16 v[48:63], a[236:239], a[48:51], v[48:63]
    s_waitcnt lgkmcnt(6)
    buffer_load_dwordx4 v227, s[12:15], s45 offen offset:3072 nt lds
    ds_read_b128 a[52:55], v73 offset:18432
    ds_read_b64_tr_b16 a[208:209], v246 offset:53248
    ds_read_b64_tr_b16 a[210:211], v246 offset:54272
    v_mfma_f32_32x32x16_bf16 a[128:143], a[240:243], a[48:51], a[128:143]
    s_waitcnt lgkmcnt(7)
    ds_read_b64_tr_b16 a[212:213], v247 offset:53248
    ds_read_b64_tr_b16 a[214:215], v247 offset:54272
    ds_read_b64_tr_b16 a[232:233], v248 offset:61440
    ds_read_b64_tr_b16 a[234:235], v248 offset:62464
    v_mfma_f32_32x32x16_bf16 a[144:159], a[244:247], a[48:51], a[144:159]
    s_waitcnt lgkmcnt(9)
    ds_read_b64_tr_b16 a[216:217], v248 offset:53248
    ds_read_b64_tr_b16 a[218:219], v248 offset:54272
    ds_read_b64_tr_b16 a[236:237], v249 offset:61440
    ds_read_b64_tr_b16 a[238:239], v249 offset:62464
    v_mfma_f32_32x32x16_bf16 a[160:175], a[248:251], a[48:51], a[160:175]
    s_waitcnt lgkmcnt(11)
    ds_read_b64_tr_b16 a[220:221], v249 offset:53248
    ds_read_b64_tr_b16 a[222:223], v249 offset:54272
    ds_read_b128 a[56:59], v76 offset:18432
    ds_read_b64_tr_b16 a[240:241], v250 offset:49152
    ds_read_b64_tr_b16 a[242:243], v250 offset:50176
    v_mfma_f32_32x32x16_bf16 a[176:191], a[252:255], a[48:51], a[176:191]
    s_waitcnt lgkmcnt(13)
    ds_read_b64_tr_b16 a[224:225], v246 offset:61440
    ds_read_b64_tr_b16 a[226:227], v246 offset:62464
    ds_read_b64_tr_b16 a[244:245], v251 offset:49152
    ds_read_b64_tr_b16 a[246:247], v251 offset:50176
    v_mfma_f32_32x32x16_bf16 v[0:15], a[208:211], a[52:55], v[0:15]
    s_waitcnt lgkmcnt(15)
    ds_read_b64_tr_b16 a[228:229], v247 offset:61440
    ds_read_b64_tr_b16 a[230:231], v247 offset:62464
    ds_read_b64_tr_b16 a[248:249], v250 offset:57344
    ds_read_b64_tr_b16 a[250:251], v250 offset:58368
    v_mfma_f32_32x32x16_bf16 v[16:31], a[212:215], a[52:55], v[16:31]
    s_waitcnt lgkmcnt(15)
    ds_read_b64_tr_b16 a[252:253], v251 offset:57344
    ds_read_b64_tr_b16 a[254:255], v251 offset:58368
    v_mfma_f32_32x32x16_bf16 v[32:47], a[216:219], a[52:55], v[32:47]
    s_waitcnt lgkmcnt(13)
    v_mfma_f32_32x32x16_bf16 v[48:63], a[220:223], a[52:55], v[48:63]
    s_waitcnt lgkmcnt(8)
    v_mfma_f32_32x32x16_bf16 a[128:143], a[224:227], a[52:55], a[128:143]
    s_waitcnt lgkmcnt(4)
    v_mfma_f32_32x32x16_bf16 a[144:159], a[228:231], a[52:55], a[144:159]
    ds_read_b128 a[32:35], v74 offset:18432
    s_waitcnt vmcnt(7) lgkmcnt(1)
    s_barrier
    ds_read_b64_tr_b16 a[208:209], v246 offset:24576
    ds_read_b64_tr_b16 a[210:211], v246 offset:25600
    v_mfma_f32_32x32x16_bf16 a[160:175], a[232:235], a[52:55], a[160:175]
    ds_read_b64_tr_b16 a[212:213], v247 offset:24576
    ds_read_b64_tr_b16 a[214:215], v247 offset:25600
    v_mfma_f32_32x32x16_bf16 a[176:191], a[236:239], a[52:55], a[176:191]
    ds_read_b64_tr_b16 a[216:217], v248 offset:24576
    ds_read_b64_tr_b16 a[218:219], v248 offset:25600
    v_mfma_f32_16x16x32_bf16 v[64:67], a[240:243], a[56:59], v[64:67]
    ds_read_b64_tr_b16 a[220:221], v249 offset:24576
    ds_read_b64_tr_b16 a[222:223], v249 offset:25600
    v_mfma_f32_16x16x32_bf16 v[68:71], a[244:247], a[56:59], v[68:71]
    v_mfma_f32_16x16x32_bf16 a[192:195], a[248:251], a[56:59], a[192:195]
    ds_read_b64_tr_b16 a[224:225], v246 offset:16384
    ds_read_b64_tr_b16 a[226:227], v246 offset:17408
    v_mfma_f32_16x16x32_bf16 a[196:199], a[252:255], a[56:59], a[196:199]
    s_waitcnt lgkmcnt(8)
    v_mfma_f32_32x32x16_bf16 a[128:143], a[208:211], a[32:35], a[128:143]
    s_waitcnt lgkmcnt(6)
    s_add_u32 m0, s43, 81920
    s_add_u32 s46, s42, 16384
    buffer_load_dwordx4 v228, s[16:19], s46 offen nt lds
    ds_read_b64_tr_b16 a[228:229], v247 offset:16384
    ds_read_b64_tr_b16 a[230:231], v247 offset:17408
    v_add_u32 v236, 153600, v245
    v_mfma_f32_32x32x16_bf16 a[144:159], a[212:215], a[32:35], a[144:159]
    s_waitcnt lgkmcnt(6)
    buffer_load_dwordx4 v229, s[16:19], s46 offen offset:1024 nt lds
    ds_read_b64_tr_b16 a[232:233], v248 offset:16384
    ds_read_b64_tr_b16 a[234:235], v248 offset:17408
    s_add_u32 s7, s38, 1
    s_and_b32 s7, s7, 3
    v_subrev_u32 v240, 32768, v246
    v_mfma_f32_32x32x16_bf16 a[160:175], a[216:219], a[32:35], a[160:175]
    s_waitcnt lgkmcnt(6)
    buffer_load_dwordx4 v228, s[16:19], s46 offen offset:2048 nt lds
    ds_read_b64_tr_b16 a[236:237], v249 offset:16384
    ds_read_b64_tr_b16 a[238:239], v249 offset:17408
    s_lshl_b32 s7, s7, 6
    v_mfma_f32_32x32x16_bf16 a[176:191], a[220:223], a[32:35], a[176:191]
    s_waitcnt lgkmcnt(6)
    buffer_load_dwordx4 v229, s[16:19], s46 offen offset:3072 nt lds
    ds_read_b128 a[36:39], v75 offset:18432
    ds_read_b64_tr_b16 a[240:241], v246 offset:28672
    ds_read_b64_tr_b16 a[242:243], v246 offset:29696
    v_mfma_f32_32x32x16_bf16 v[0:15], a[224:227], a[32:35], v[0:15]
    s_waitcnt lgkmcnt(7)
    ds_read_b64_tr_b16 a[244:245], v247 offset:28672
    ds_read_b64_tr_b16 a[246:247], v247 offset:29696
    v_mfma_f32_32x32x16_bf16 v[16:31], a[228:231], a[32:35], v[16:31]
    s_waitcnt lgkmcnt(7)
    ds_read_b64_tr_b16 a[248:249], v248 offset:28672
    ds_read_b64_tr_b16 a[250:251], v248 offset:29696
    v_mfma_f32_32x32x16_bf16 v[32:47], a[232:235], a[32:35], v[32:47]
    s_waitcnt lgkmcnt(7)
    ds_read_b64_tr_b16 a[252:253], v249 offset:28672
    ds_read_b64_tr_b16 a[254:255], v249 offset:29696
    v_mfma_f32_32x32x16_bf16 v[48:63], a[236:239], a[32:35], v[48:63]
    s_waitcnt lgkmcnt(6)
    ds_read_b64_tr_b16 a[208:209], v246 offset:20480
    ds_read_b64_tr_b16 a[210:211], v246 offset:21504
    v_xor_b32 v246, s7, v240
    v_mfma_f32_32x32x16_bf16 a[128:143], a[240:243], a[36:39], a[128:143]
    s_waitcnt lgkmcnt(6)
    ds_read_b64_tr_b16 a[212:213], v247 offset:20480
    ds_read_b64_tr_b16 a[214:215], v247 offset:21504
    s_add_u32 s7, s38, 2
    s_and_b32 s7, s7, 3
    s_lshl_b32 s7, s7, 6
    v_mov_b32 v232, 0
    v_mfma_f32_32x32x16_bf16 a[144:159], a[244:247], a[36:39], a[144:159]
    s_waitcnt lgkmcnt(6)
    ds_read_b64_tr_b16 a[216:217], v248 offset:20480
    ds_read_b64_tr_b16 a[218:219], v248 offset:21504
    v_xor_b32 v247, s7, v240
    v_mfma_f32_32x32x16_bf16 a[160:175], a[248:251], a[36:39], a[160:175]
    s_waitcnt lgkmcnt(6)
    ds_read_b64_tr_b16 a[220:221], v249 offset:20480
    ds_read_b64_tr_b16 a[222:223], v249 offset:21504
    s_add_u32 s7, s38, 3
    s_and_b32 s7, s7, 3
    s_lshl_b32 s7, s7, 6
    v_xor_b32 v248, s7, v240
    v_mfma_f32_32x32x16_bf16 a[176:191], a[252:255], a[36:39], a[176:191]
    s_waitcnt lgkmcnt(6)
    ds_read_b128 a[60:63], v77 offset:18432
    ds_read_b64_tr_b16 a[224:225], v250 offset:24576
    ds_read_b64_tr_b16 a[226:227], v250 offset:25600
    ds_read_b64_tr_b16 a[228:229], v251 offset:24576
    ds_read_b64_tr_b16 a[230:231], v251 offset:25600
    s_add_u32 s7, s38, 4
    v_mfma_f32_32x32x16_bf16 v[0:15], a[208:211], a[36:39], v[0:15]
    s_waitcnt lgkmcnt(9)
    ds_read_b64_tr_b16 a[232:233], v250 offset:16384
    ds_read_b64_tr_b16 a[234:235], v250 offset:17408
    ds_read_b64_tr_b16 a[236:237], v251 offset:16384
    ds_read_b64_tr_b16 a[238:239], v251 offset:17408
    s_and_b32 s7, s7, 3
    s_lshl_b32 s7, s7, 6
    v_mfma_f32_32x32x16_bf16 v[16:31], a[212:215], a[36:39], v[16:31]
    s_waitcnt lgkmcnt(11)
    v_xor_b32 v249, s7, v240
    v_subrev_u32 v250, 32768, v250
    v_subrev_u32 v251, 32768, v251
    v_lshrrev_b32 v240, 13, v230
    v_and_b32 v230, 255, v230
    v_lshl_add_u32 v230, v240, 10, v230
    v_mfma_f32_32x32x16_bf16 v[32:47], a[216:219], a[36:39], v[32:47]
    s_waitcnt lgkmcnt(9)
    ds_read_b128 a[216:219], v200 offset:0
    v_mul_f32 v0, s54, v0
    v_mul_f32 v1, s54, v1
    v_cvt_pk_bf16_f32 v168, v0, v1
    v_mul_f32 v2, s54, v2
    v_mul_f32 v3, s54, v3
    v_mfma_f32_32x32x16_bf16 v[48:63], a[220:223], a[36:39], v[48:63]
    s_waitcnt lgkmcnt(7)
    ds_read_b128 a[220:223], v201 offset:0
    v_cvt_pk_bf16_f32 v169, v2, v3
    v_mul_f32 v4, s54, v4
    v_mul_f32 v5, s54, v5
    v_cvt_pk_bf16_f32 v170, v4, v5
    v_mul_f32 v6, s54, v6
    v_mfma_f32_16x16x32_bf16 a[192:195], a[224:227], a[60:63], a[192:195]
    s_waitcnt lgkmcnt(6)
    ds_read_b128 a[224:227], v202 offset:0
    v_mul_f32 v7, s54, v7
    v_mfma_f32_16x16x32_bf16 a[196:199], a[228:231], a[60:63], a[196:199]
    s_waitcnt lgkmcnt(5)
    ds_read_b128 a[228:231], v203 offset:0
    v_cvt_pk_bf16_f32 v171, v6, v7
    v_mfma_f32_16x16x32_bf16 v[64:67], a[232:235], a[60:63], v[64:67]
    s_waitcnt lgkmcnt(4)
    ds_read_b128 a[232:235], v204 offset:0
    v_mul_f32 v8, s54, v8
    v_mfma_f32_16x16x32_bf16 v[68:71], a[236:239], a[60:63], v[68:71]
    s_waitcnt lgkmcnt(4)
    v_mul_f32 v9, s54, v9
    v_cvt_pk_bf16_f32 v172, v8, v9
    v_mfma_f32_32x32x16_bf16 v[96:111], a[216:219], v[168:171], 0
    s_waitcnt lgkmcnt(3)
    ds_read_b128 a[236:239], v205 offset:0
    v_mul_f32 v10, s54, v10
    v_mul_f32 v11, s54, v11
    v_cvt_pk_bf16_f32 v173, v10, v11
    v_mul_f32 v12, s54, v12
    v_mul_f32 v13, s54, v13
    v_cvt_pk_bf16_f32 v174, v12, v13
    v_mul_f32 v14, s54, v14
    v_mul_f32 v15, s54, v15
    v_cvt_pk_bf16_f32 v175, v14, v15
    s_nop 1
    v_mfma_f32_32x32x16_bf16 v[96:111], a[220:223], v[172:175], v[96:111]
    s_waitcnt lgkmcnt(3)
    ds_read_b128 a[240:243], v206 offset:0
    v_mul_f32 v16, s54, v16
    v_mul_f32 v17, s54, v17
    v_cvt_pk_bf16_f32 v176, v16, v17
    v_mul_f32 v18, s54, v18
    v_mul_f32 v19, s54, v19
    v_cvt_pk_bf16_f32 v177, v18, v19
    v_mul_f32 v20, s54, v20
    v_mul_f32 v21, s54, v21
    v_cvt_pk_bf16_f32 v178, v20, v21
    v_mul_f32 v22, s54, v22
    v_mul_f32 v23, s54, v23
    v_cvt_pk_bf16_f32 v179, v22, v23
    s_nop 1
    v_mfma_f32_32x32x16_bf16 v[96:111], a[224:227], v[176:179], v[96:111]
    s_waitcnt lgkmcnt(3)
    ds_read_b128 a[244:247], v207 offset:0
    v_mul_f32 v24, s54, v24
    v_mul_f32 v25, s54, v25
    v_cvt_pk_bf16_f32 v180, v24, v25
    v_mul_f32 v26, s54, v26
    v_mul_f32 v27, s54, v27
    v_cvt_pk_bf16_f32 v181, v26, v27
    v_mul_f32 v28, s54, v28
    v_mul_f32 v29, s54, v29
    v_cvt_pk_bf16_f32 v182, v28, v29
    v_mul_f32 v30, s54, v30
    v_mul_f32 v31, s54, v31
    v_cvt_pk_bf16_f32 v183, v30, v31
    s_nop 1
    v_mfma_f32_32x32x16_bf16 v[96:111], a[228:231], v[180:183], v[96:111]
    s_waitcnt lgkmcnt(3)
    ds_read_b128 a[248:251], v200 offset:8192
    v_mul_f32 v32, s54, v32
    v_mul_f32 v33, s54, v33
    v_cvt_pk_bf16_f32 v184, v32, v33
    v_mul_f32 v34, s54, v34
    v_mul_f32 v35, s54, v35
    v_cvt_pk_bf16_f32 v185, v34, v35
    v_mul_f32 v36, s54, v36
    v_mul_f32 v37, s54, v37
    v_cvt_pk_bf16_f32 v186, v36, v37
    v_mul_f32 v38, s54, v38
    v_mul_f32 v39, s54, v39
    v_cvt_pk_bf16_f32 v187, v38, v39
    s_nop 1
    v_mfma_f32_32x32x16_bf16 v[96:111], a[232:235], v[184:187], v[96:111]
    s_waitcnt lgkmcnt(3)
    ds_read_b128 a[252:255], v201 offset:8192
    v_mul_f32 v40, s54, v40
    v_mul_f32 v41, s54, v41
    v_cvt_pk_bf16_f32 v188, v40, v41
    v_mul_f32 v42, s54, v42
    v_mul_f32 v43, s54, v43
    v_cvt_pk_bf16_f32 v189, v42, v43
    v_mul_f32 v44, s54, v44
    v_mul_f32 v45, s54, v45
    v_cvt_pk_bf16_f32 v190, v44, v45
    v_mul_f32 v46, s54, v46
    v_mul_f32 v47, s54, v47
    v_cvt_pk_bf16_f32 v191, v46, v47
    s_nop 1
    v_mfma_f32_32x32x16_bf16 v[96:111], a[236:239], v[188:191], v[96:111]
    s_waitcnt lgkmcnt(3)
    ds_read_b128 a[216:219], v202 offset:8192
    v_mul_f32 v48, s54, v48
    v_mul_f32 v49, s54, v49
    v_cvt_pk_bf16_f32 v192, v48, v49
    v_mul_f32 v50, s54, v50
    v_mul_f32 v51, s54, v51
    v_cvt_pk_bf16_f32 v193, v50, v51
    v_mul_f32 v52, s54, v52
    v_mul_f32 v53, s54, v53
    v_cvt_pk_bf16_f32 v194, v52, v53
    v_mul_f32 v54, s54, v54
    v_mul_f32 v55, s54, v55
    v_cvt_pk_bf16_f32 v195, v54, v55
    s_nop 1
    v_mfma_f32_32x32x16_bf16 v[96:111], a[240:243], v[192:195], v[96:111]
    s_waitcnt lgkmcnt(3)
    ds_read_b128 a[220:223], v203 offset:8192
    v_mul_f32 v56, s54, v56
    v_mul_f32 v57, s54, v57
    v_cvt_pk_bf16_f32 v196, v56, v57
    v_mul_f32 v58, s54, v58
    v_mul_f32 v59, s54, v59
    v_cvt_pk_bf16_f32 v197, v58, v59
    v_mul_f32 v60, s54, v60
    v_mul_f32 v61, s54, v61
    v_cvt_pk_bf16_f32 v198, v60, v61
    v_mul_f32 v62, s54, v62
    v_mul_f32 v63, s54, v63
    v_cvt_pk_bf16_f32 v199, v62, v63
    s_nop 1
    v_mfma_f32_32x32x16_bf16 v[96:111], a[244:247], v[196:199], v[96:111]
    s_waitcnt lgkmcnt(3)
    ds_read_b128 a[224:227], v204 offset:8192
    v_mul_f32 v64, s54, v64
    v_mul_f32 v65, s54, v65
    v_mul_f32 v66, s54, v66
    v_mul_f32 v67, s54, v67
    v_cvt_pk_bf16_f32 v64, v64, v65
    v_mfma_f32_32x32x16_bf16 v[112:127], a[248:251], v[168:171], 0
    s_waitcnt lgkmcnt(3)
    ds_read_b128 a[228:231], v205 offset:8192
    v_cvt_pk_bf16_f32 v65, v66, v67
    v_mul_f32 v68, s54, v68
    v_mul_f32 v69, s54, v69
    v_mul_f32 v70, s54, v70
    v_mul_f32 v71, s54, v71
    v_cvt_pk_bf16_f32 v68, v68, v69
    v_cvt_pk_bf16_f32 v69, v70, v71
    v_mfma_f32_32x32x16_bf16 v[112:127], a[252:255], v[172:175], v[112:127]
    s_waitcnt lgkmcnt(3)
    ds_write_b64 v236, v[64:65] offset:0
    ds_write_b64 v236, v[68:69] offset:512
    ds_read_b128 a[232:235], v206 offset:8192
    v_max3_f32 v234, v96, v97, v98
    v_max3_f32 v234, v234, v99, v100
    v_max3_f32 v234, v234, v101, v102
    s_waitcnt vmcnt(8) lgkmcnt(1)
    s_barrier
L_ih0:
    s_add_u32 m0, s43, 49152
    s_add_u32 s45, s42, 49152
    v_mfma_f32_32x32x16_bf16 v[112:127], a[216:219], v[176:179], v[112:127]
    ds_read_b128 a[236:239], v207 offset:8192
    buffer_load_dwordx4 v224, s[12:15], s45 offen nt lds
    v_max3_f32 v234, v234, v103, v104
    v_max3_f32 v234, v234, v105, v106
    v_and_b32 v238, 112, v244
    v_lshl_add_u32 v238, v238, 3, s44
    v_mfma_f32_32x32x16_bf16 v[112:127], a[220:223], v[180:183], v[112:127]
    ds_read_b64_tr_b16 a[240:241], v208 offset:0
    ds_read_b64_tr_b16 a[242:243], v208 offset:2048
    v_max3_f32 v234, v234, v107, v108
    v_max3_f32 v234, v234, v109, v110
    v_add_u32 v238, L_ih2 - L_ibase, v238
    v_min_u32 v238, L_end - L_ibase - 64, v238
    v_mfma_f32_32x32x16_bf16 v[112:127], a[224:227], v[184:187], v[112:127]
    ds_read_b64_tr_b16 a[244:245], v209 offset:0
    ds_read_b64_tr_b16 a[246:247], v209 offset:2048
    buffer_load_dwordx4 v225, s[12:15], s45 offen offset:1024 nt lds
    v_max_f32 v234, v234, v111
    v_mov_b32 v236, v234
    v_mfma_f32_32x32x16_bf16 v[112:127], a[228:231], v[188:191], v[112:127]
    s_waitcnt lgkmcnt(5)
    global_load_dword a64, v238, s[90:91]
    ds_read_b64_tr_b16 a[248:249], v210 offset:0
    ds_read_b64_tr_b16 a[250:251], v210 offset:2048
    v_permlane32_swap_b32 v236, v234
    v_max_f32 v234, v236, v234
    v_sub_f32 v96, v96, v234
    v_exp_f32 v96, v96
    v_mfma_f32_32x32x16_bf16 v[112:127], a[232:235], v[192:195], v[112:127]
    s_waitcnt lgkmcnt(6)
    ds_read_b64_tr_b16 a[252:253], v211 offset:0
    ds_read_b64_tr_b16 a[254:255], v211 offset:2048
    buffer_load_dwordx4 v226, s[12:15], s45 offen offset:2048 nt lds
    v_add_f32 v232, v232, v96
    v_sub_f32 v97, v97, v234
    v_exp_f32 v97, v97
    v_sub_f32 v98, v98, v234
    v_exp_f32 v98, v98
    v_sub_f32 v99, v99, v234
    v_exp_f32 v99, v99
    v_sub_f32 v100, v100, v234
    v_exp_f32 v100, v100
    v_sub_f32 v101, v101, v234
    v_exp_f32 v101, v101
    v_sub_f32 v102, v102, v234
    v_exp_f32 v102, v102
    v_sub_f32 v103, v103, v234
    v_exp_f32 v103, v103
    v_mfma_f32_32x32x16_bf16 v[112:127], a[236:239], v[196:199], v[112:127]
    s_waitcnt lgkmcnt(6)
    ds_read_b64_tr_b16 a[216:217], v208 offset:4096
    ds_read_b64_tr_b16 a[218:219], v208 offset:6144
    v_cvt_pk_bf16_f32 v144, v96, v97
    v_cvt_pk_bf16_f32 v145, v98, v99
    v_cvt_pk_bf16_f32 v146, v100, v101
    v_cvt_pk_bf16_f32 v147, v102, v103
    v_add_f32 v232, v232, v97
    v_add_f32 v232, v232, v98
    v_add_f32 v232, v232, v99
    v_add_f32 v232, v232, v100
    v_add_f32 v232, v232, v101
    v_mfma_f32_32x32x16_bf16 v[0:15], a[240:243], v[144:147], 0
    s_waitcnt lgkmcnt(6)
    ds_read_b64_tr_b16 a[220:221], v209 offset:4096
    ds_read_b64_tr_b16 a[222:223], v209 offset:6144
    buffer_load_dwordx4 v227, s[12:15], s45 offen offset:3072 nt lds
    v_add_f32 v232, v232, v102
    v_sub_f32 v104, v104, v234
    v_exp_f32 v104, v104
    v_mfma_f32_32x32x16_bf16 v[16:31], a[244:247], v[144:147], 0
    s_waitcnt lgkmcnt(6)
    ds_read_b64_tr_b16 a[224:225], v210 offset:4096
    ds_read_b64_tr_b16 a[226:227], v210 offset:6144
    v_sub_f32 v112, v112, v234
    v_sub_f32 v113, v113, v234
    v_sub_f32 v114, v114, v234
    v_sub_f32 v115, v115, v234
    v_add_f32 v232, v232, v103
    v_mfma_f32_32x32x16_bf16 v[32:47], a[248:251], v[144:147], 0
    s_waitcnt lgkmcnt(6)
    ds_read_b64_tr_b16 a[228:229], v211 offset:4096
    ds_read_b64_tr_b16 a[230:231], v211 offset:6144
    v_sub_f32 v116, v116, v234
    v_sub_f32 v117, v117, v234
    v_sub_f32 v118, v118, v234
    v_sub_f32 v119, v119, v234
    v_add_f32 v232, v232, v104
    v_sub_f32 v105, v105, v234
    v_exp_f32 v105, v105
    v_sub_f32 v106, v106, v234
    v_exp_f32 v106, v106
    v_sub_f32 v107, v107, v234
    v_exp_f32 v107, v107
    v_sub_f32 v108, v108, v234
    v_exp_f32 v108, v108
    v_sub_f32 v109, v109, v234
    v_exp_f32 v109, v109
    v_sub_f32 v110, v110, v234
    v_exp_f32 v110, v110
    v_sub_f32 v111, v111, v234
    v_exp_f32 v111, v111
    v_mfma_f32_32x32x16_bf16 v[48:63], a[252:255], v[144:147], 0
    s_waitcnt lgkmcnt(6)
    ds_read_b128 a[232:235], v200 offset:16384
    v_cvt_pk_bf16_f32 v148, v104, v105
    v_cvt_pk_bf16_f32 v149, v106, v107
    v_cvt_pk_bf16_f32 v150, v108, v109
    v_cvt_pk_bf16_f32 v151, v110, v111
    v_sub_f32 v120, v120, v234
    v_sub_f32 v121, v121, v234
    v_sub_f32 v122, v122, v234
    v_sub_f32 v123, v123, v234
    v_add_f32 v232, v232, v105
    v_add_f32 v232, v232, v106
    v_mfma_f32_32x32x16_bf16 v[0:15], a[216:219], v[148:151], v[0:15]
    s_waitcnt lgkmcnt(5)
    ds_read_b128 a[236:239], v201 offset:16384
    v_sub_f32 v124, v124, v234
    v_sub_f32 v125, v125, v234
    v_sub_f32 v126, v126, v234
    v_sub_f32 v127, v127, v234
    v_add_f32 v232, v232, v107
    v_add_f32 v232, v232, v108
    v_mfma_f32_32x32x16_bf16 v[16:31], a[220:223], v[148:151], v[16:31]
    s_waitcnt lgkmcnt(4)
    ds_read_b128 a[240:243], v202 offset:16384
    v_add_f32 v232, v232, v109
    v_add_f32 v232, v232, v110
    v_sub_f32 v128, 0, v234
    v_sub_f32 v129, 0, v234
    v_sub_f32 v130, 0, v234
    v_mfma_f32_32x32x16_bf16 v[32:47], a[224:227], v[148:151], v[32:47]
    s_waitcnt lgkmcnt(3)
    ds_read_b128 a[244:247], v203 offset:16384
    v_add_f32 v232, v232, v111
    v_sub_f32 v131, 0, v234
    v_sub_f32 v132, 0, v234
    v_sub_f32 v133, 0, v234
    v_sub_f32 v134, 0, v234
    v_mfma_f32_32x32x16_bf16 v[48:63], a[228:231], v[148:151], v[48:63]
    s_waitcnt lgkmcnt(3)
    ds_read_b128 a[248:251], v204 offset:16384
    v_sub_f32 v135, 0, v234
    v_sub_f32 v136, 0, v234
    v_sub_f32 v137, 0, v234
    v_sub_f32 v138, 0, v234
    v_sub_f32 v139, 0, v234
    v_sub_f32 v140, 0, v234
    v_sub_f32 v141, 0, v234
    v_sub_f32 v142, 0, v234
    v_sub_f32 v143, 0, v234
    v_max3_f32 v234, v112, v113, v114
    v_max3_f32 v234, v234, v115, v116
    v_max3_f32 v234, v234, v117, v118
    v_max3_f32 v234, v234, v119, v120
    v_max3_f32 v234, v234, v121, v122
    v_max3_f32 v234, v234, v123, v124
    v_max3_f32 v234, v234, v125, v126
    v_max_f32 v234, v234, v127
    v_cmp_lt_f32 vcc, 0x41000000, v234
    s_nop 1
    s_cbranch_vccnz L_rare1
L_back1:
    v_exp_f32 v112, v112
    v_exp_f32 v113, v113
    v_mfma_f32_32x32x16_bf16 v[96:111], a[232:235], v[168:171], v[128:143]
    s_waitcnt lgkmcnt(3)
    ds_read_b128 a[252:255], v205 offset:16384
    v_cvt_pk_bf16_f32 v144, v112, v113
    v_exp_f32 v114, v114
    v_exp_f32 v115, v115
    v_mfma_f32_32x32x16_bf16 v[96:111], a[236:239], v[172:175], v[96:111]
    s_waitcnt lgkmcnt(3)
    ds_read_b128 a[216:219], v206 offset:16384
    s_add_u32 m0, s43, 98304
    s_add_u32 s46, s42, 32768
    v_cvt_pk_bf16_f32 v145, v114, v115
    v_exp_f32 v116, v116
    v_exp_f32 v117, v117
    v_mfma_f32_32x32x16_bf16 v[96:111], a[240:243], v[176:179], v[96:111]
    s_waitcnt lgkmcnt(3)
    ds_read_b128 a[220:223], v207 offset:16384
    buffer_load_dwordx4 v228, s[16:19], s46 offen nt lds
    v_cvt_pk_bf16_f32 v146, v116, v117
    v_exp_f32 v118, v118
    v_exp_f32 v119, v119
    v_mfma_f32_32x32x16_bf16 v[96:111], a[244:247], v[180:183], v[96:111]
    s_waitcnt lgkmcnt(3)
    ds_read_b64_tr_b16 a[224:225], v208 offset:8192
    ds_read_b64_tr_b16 a[226:227], v208 offset:10240
    v_cvt_pk_bf16_f32 v147, v118, v119
    v_exp_f32 v120, v120
    v_add_f32 v232, v232, v112
    v_mfma_f32_32x32x16_bf16 v[96:111], a[248:251], v[184:187], v[96:111]
    s_waitcnt lgkmcnt(4)
    ds_read_b64_tr_b16 a[228:229], v209 offset:8192
    ds_read_b64_tr_b16 a[230:231], v209 offset:10240
    buffer_load_dwordx4 v229, s[16:19], s46 offen offset:1024 nt lds
    v_exp_f32 v121, v121
    v_add_f32 v232, v232, v113
    v_mfma_f32_32x32x16_bf16 v[96:111], a[252:255], v[188:191], v[96:111]
    s_waitcnt lgkmcnt(5)
    ds_read_b64_tr_b16 a[232:233], v210 offset:8192
    ds_read_b64_tr_b16 a[234:235], v210 offset:10240
    v_cvt_pk_bf16_f32 v148, v120, v121
    v_exp_f32 v122, v122
    v_add_f32 v232, v232, v114
    v_mfma_f32_32x32x16_bf16 v[96:111], a[216:219], v[192:195], v[96:111]
    s_waitcnt lgkmcnt(6)
    ds_read_b64_tr_b16 a[236:237], v211 offset:8192
    ds_read_b64_tr_b16 a[238:239], v211 offset:10240
    buffer_load_dwordx4 v228, s[16:19], s46 offen offset:2048 nt lds
    v_exp_f32 v123, v123
    v_add_f32 v232, v232, v115
    v_add_f32 v232, v232, v116
    v_mfma_f32_32x32x16_bf16 v[96:111], a[220:223], v[196:199], v[96:111]
    s_waitcnt lgkmcnt(6)
    ds_read_b64_tr_b16 a[240:241], v208 offset:12288
    ds_read_b64_tr_b16 a[242:243], v208 offset:14336
    v_cvt_pk_bf16_f32 v149, v122, v123
    v_exp_f32 v124, v124
    v_add_f32 v232, v232, v117
    v_mfma_f32_32x32x16_bf16 v[0:15], a[224:227], v[144:147], v[0:15]
    s_waitcnt lgkmcnt(6)
    ds_read_b64_tr_b16 a[244:245], v209 offset:12288
    ds_read_b64_tr_b16 a[246:247], v209 offset:14336
    buffer_load_dwordx4 v229, s[16:19], s46 offen offset:3072 nt lds
    v_exp_f32 v125, v125
    v_add_f32 v232, v232, v118
    v_mfma_f32_32x32x16_bf16 v[16:31], a[228:231], v[144:147], v[16:31]
    s_waitcnt lgkmcnt(6)
    ds_read_b64_tr_b16 a[248:249], v210 offset:12288
    ds_read_b64_tr_b16 a[250:251], v210 offset:14336
    v_cvt_pk_bf16_f32 v150, v124, v125
    v_exp_f32 v126, v126
    v_add_f32 v232, v232, v119
    v_mfma_f32_32x32x16_bf16 v[32:47], a[232:235], v[144:147], v[32:47]
    s_waitcnt lgkmcnt(6)
    ds_read_b64_tr_b16 a[252:253], v211 offset:12288
    ds_read_b64_tr_b16 a[254:255], v211 offset:14336
    s_mov_b32 s8, s94
    s_mov_b32 s9, s95
    s_mov_b32 s10, 256
    s_mov_b32 s11, 131072
    s_add_u32 s96, s96, 1
    s_max_u32 s96, s96, 1
    s_or_b32 s6, s2, s36
    s_mov_b32 s7, 67174400
    v_exp_f32 v127, v127
    v_add_f32 v232, v232, v120
    v_max3_f32 v234, v96, v97, v98
    v_mov_b32 v240, s96
    v_lshrrev_b32 v241, 4, v244
    v_or_b32 v241, s6, v241
    v_cmp_eq_u32 s[0:1], 0, v241
    v_mov_b32 v242, 2147483647
    s_nop 0
    v_cndmask_b32 v241, v242, 0, s[0:1]
    v_mfma_f32_32x32x16_bf16 v[48:63], a[236:239], v[144:147], v[48:63]
    s_waitcnt lgkmcnt(6)
    ds_read_b128 a[200:203], v254 offset:22528
    buffer_store_dword v240, v241, s[24:27], s7 offen sc1
    ds_read_b128 a[216:219], v212 offset:0
    ds_read_b128 a[220:223], v213 offset:0
    v_cvt_pk_bf16_f32 v151, v126, v127
    v_add_f32 v232, v232, v121
    v_add_f32 v232, v232, v122
    v_max3_f32 v234, v234, v99, v100
    v_max3_f32 v234, v234, v101, v102
    v_mfma_f32_32x32x16_bf16 v[0:15], a[240:243], v[148:151], v[0:15]
    s_waitcnt lgkmcnt(7)
    ds_read_b128 a[204:207], v254 offset:23552
    ds_read_b128 a[208:211], v254 offset:24576
    buffer_store_dword v240, v241, s[8:11], 0 offen sc1
    ds_read_b128 a[224:227], v214 offset:0
    ds_read_b128 a[228:231], v215 offset:0
    v_add_f32 v232, v232, v123
    v_add_f32 v232, v232, v124
    v_max3_f32 v234, v234, v103, v104
    v_max3_f32 v234, v234, v105, v106
    v_mfma_f32_32x32x16_bf16 v[16:31], a[244:247], v[148:151], v[16:31]
    s_waitcnt lgkmcnt(9)
    ds_read_b128 a[212:215], v254 offset:25600
    ds_read_b128 a[232:235], v212 offset:4096
    ds_read_b128 a[236:239], v213 offset:4096
    v_add_f32 v232, v232, v125
    v_add_f32 v232, v232, v126
    v_max3_f32 v234, v234, v107, v108
    v_max3_f32 v234, v234, v109, v110
    v_mfma_f32_32x32x16_bf16 v[32:47], a[248:251], v[148:151], v[32:47]
    s_waitcnt lgkmcnt(10)
    ds_read_b128 a[240:243], v214 offset:4096
    ds_read_b128 a[244:247], v215 offset:4096
    v_add_f32 v232, v232, v127
    v_max_f32 v234, v234, v111
    v_cmp_lt_f32 vcc, 0x41000000, v234
    v_mov_b32 v233, 0
    v_mfma_f32_32x32x16_bf16 v[48:63], a[252:255], v[148:151], v[48:63]
    s_waitcnt lgkmcnt(10)
    ds_read_b128 a[248:251], v200 offset:24576
    s_cbranch_vccnz L_rare2
L_back2:
    v_mfma_f32_16x16x32_bf16 v[152:155], a[216:219], a[200:203], 0
    s_waitcnt lgkmcnt(9)
    ds_read_b128 a[252:255], v201 offset:24576
    v_mfma_f32_16x16x32_bf16 v[152:155], a[220:223], a[204:207], v[152:155]
    s_waitcnt lgkmcnt(8)
    v_mfma_f32_16x16x32_bf16 v[152:155], a[224:227], a[208:211], v[152:155]
    s_waitcnt lgkmcnt(6)
    ds_read_b128 a[216:219], v202 offset:24576
    v_mfma_f32_16x16x32_bf16 v[152:155], a[228:231], a[212:215], v[152:155]
    s_waitcnt lgkmcnt(6)
    v_mfma_f32_16x16x32_bf16 v[156:159], a[232:235], a[200:203], 0
    s_waitcnt lgkmcnt(5)
    ds_read_b128 a[220:223], v203 offset:24576
    v_mfma_f32_16x16x32_bf16 v[156:159], a[236:239], a[204:207], v[156:159]
    s_waitcnt lgkmcnt(5)
    v_mfma_f32_16x16x32_bf16 v[156:159], a[240:243], a[208:211], v[156:159]
    s_waitcnt lgkmcnt(4)
    ds_read_b128 a[224:227], v204 offset:24576
    v_mfma_f32_16x16x32_bf16 v[156:159], a[244:247], a[212:215], v[156:159]
    s_waitcnt lgkmcnt(4)
    v_exp_f32 v96, v96
    v_exp_f32 v97, v97
    v_mfma_f32_32x32x16_bf16 v[112:127], a[248:251], v[168:171], v[128:143]
    s_waitcnt lgkmcnt(3)
    ds_read_b128 a[228:231], v205 offset:24576
    v_cvt_pk_bf16_f32 v144, v96, v97
    v_exp_f32 v98, v98
    v_exp_f32 v99, v99
    v_accvgpr_read_b32 v240, a128
    v_accvgpr_read_b32 v241, a129
    v_mul_f32 v240, s54, v240
    v_mfma_f32_32x32x16_bf16 v[112:127], a[252:255], v[172:175], v[112:127]
    s_waitcnt lgkmcnt(3)
    ds_read_b128 a[232:235], v206 offset:24576
    v_cvt_pk_bf16_f32 v145, v98, v99
    v_exp_f32 v100, v100
    v_exp_f32 v101, v101
    v_mul_f32 v241, s54, v241
    v_cvt_pk_bf16_f32 v240, v240, v241
    v_accvgpr_write_b32 a96, v240
    s_waitcnt vmcnt(11)
    s_barrier
L_ih1:
    s_add_u32 m0, s43, 0
    s_add_u32 s45, s42, 65536
    v_mfma_f32_32x32x16_bf16 v[112:127], a[216:219], v[176:179], v[112:127]
    s_waitcnt lgkmcnt(3)
    ds_read_b128 a[236:239], v207 offset:24576
    buffer_load_dwordx4 v224, s[12:15], s45 offen nt lds
    v_cvt_pk_bf16_f32 v146, v100, v101
    v_exp_f32 v102, v102
    v_exp_f32 v103, v103
    v_and_b32 v238, 112, v244
    v_lshl_add_u32 v238, v238, 3, s44
    v_accvgpr_read_b32 v242, a130
    v_accvgpr_read_b32 v243, a131
    v_mul_f32 v242, s54, v242
    v_mfma_f32_32x32x16_bf16 v[112:127], a[220:223], v[180:183], v[112:127]
    s_waitcnt lgkmcnt(3)
    ds_read_b64_tr_b16 a[240:241], v208 offset:16384
    ds_read_b64_tr_b16 a[242:243], v208 offset:18432
    v_cvt_pk_bf16_f32 v147, v102, v103
    v_exp_f32 v104, v104
    v_add_f32 v232, v232, v96
    v_add_u32 v238, L_ih3 - L_ibase, v238
    v_min_u32 v238, L_end - L_ibase - 64, v238
    v_mul_f32 v243, s54, v243
    v_cvt_pk_bf16_f32 v242, v242, v243
    v_accvgpr_write_b32 a97, v242
    v_mfma_f32_32x32x16_bf16 v[112:127], a[224:227], v[184:187], v[112:127]
    s_waitcnt lgkmcnt(4)
    ds_read_b64_tr_b16 a[244:245], v209 offset:16384
    ds_read_b64_tr_b16 a[246:247], v209 offset:18432
    buffer_load_dwordx4 v225, s[12:15], s45 offen offset:1024 nt lds
    v_exp_f32 v105, v105
    v_add_f32 v232, v232, v97
    v_accvgpr_read_b32 v240, a132
    v_accvgpr_read_b32 v241, a133
    v_mul_f32 v240, s54, v240
    v_mfma_f32_32x32x16_bf16 v[112:127], a[228:231], v[188:191], v[112:127]
    s_waitcnt lgkmcnt(5)
    global_load_dword a64, v238, s[90:91]
    ds_read_b64_tr_b16 a[248:249], v210 offset:16384
    ds_read_b64_tr_b16 a[250:251], v210 offset:18432
    v_cvt_pk_bf16_f32 v148, v104, v105
    v_exp_f32 v106, v106
    v_add_f32 v232, v232, v98
    v_mul_f32 v241, s54, v241
    v_cvt_pk_bf16_f32 v240, v240, v241
    v_accvgpr_write_b32 a98, v240
    v_mfma_f32_32x32x16_bf16 v[112:127], a[232:235], v[192:195], v[112:127]
    s_waitcnt lgkmcnt(6)
    ds_read_b64_tr_b16 a[252:253], v211 offset:16384
    ds_read_b64_tr_b16 a[254:255], v211 offset:18432
    buffer_load_dwordx4 v226, s[12:15], s45 offen offset:2048 nt lds
    v_exp_f32 v107, v107
    v_add_f32 v232, v232, v99
    v_add_f32 v232, v232, v100
    v_accvgpr_read_b32 v242, a134
    v_accvgpr_read_b32 v243, a135
    v_mul_f32 v242, s54, v242
    v_mfma_f32_32x32x16_bf16 v[112:127], a[236:239], v[196:199], v[112:127]
    s_waitcnt lgkmcnt(6)
    ds_read_b64_tr_b16 a[216:217], v208 offset:20480
    ds_read_b64_tr_b16 a[218:219], v208 offset:22528
    v_cvt_pk_bf16_f32 v149, v106, v107
    v_exp_f32 v108, v108
    v_add_f32 v232, v232, v101
    v_mul_f32 v243, s54, v243
    v_cvt_pk_bf16_f32 v242, v242, v243
    v_accvgpr_write_b32 a99, v242
    v_mfma_f32_32x32x16_bf16 v[0:15], a[240:243], v[144:147], v[0:15]
    s_waitcnt lgkmcnt(6)
    ds_read_b64_tr_b16 a[220:221], v209 offset:20480
    ds_read_b64_tr_b16 a[222:223], v209 offset:22528
    buffer_load_dwordx4 v227, s[12:15], s45 offen offset:3072 nt lds
    v_exp_f32 v109, v109
    v_add_f32 v232, v232, v102
    v_accvgpr_read_b32 v240, a136
    v_accvgpr_read_b32 v241, a137
    v_mul_f32 v240, s54, v240
    v_mfma_f32_32x32x16_bf16 v[16:31], a[244:247], v[144:147], v[16:31]
    s_waitcnt lgkmcnt(6)
    ds_read_b64_tr_b16 a[224:225], v210 offset:20480
    ds_read_b64_tr_b16 a[226:227], v210 offset:22528
    v_cvt_pk_bf16_f32 v150, v108, v109
    v_exp_f32 v110, v110
    v_add_f32 v232, v232, v103
    v_mul_f32 v241, s54, v241
    v_cvt_pk_bf16_f32 v240, v240, v241
    v_accvgpr_write_b32 a100, v240
    v_mfma_f32_32x32x16_bf16 v[32:47], a[248:251], v[144:147], v[32:47]
    s_waitcnt lgkmcnt(6)
    ds_read_b64_tr_b16 a[228:229], v211 offset:20480
    ds_read_b64_tr_b16 a[230:231], v211 offset:22528
    v_exp_f32 v111, v111
    v_add_f32 v232, v232, v104
    v_max3_f32 v234, v112, v113, v114
    v_accvgpr_read_b32 v242, a138
    v_accvgpr_read_b32 v243, a139
    v_mul_f32 v242, s54, v242
    v_mfma_f32_32x32x16_bf16 v[48:63], a[252:255], v[144:147], v[48:63]
    s_waitcnt lgkmcnt(6)
    ds_read_b128 a[232:235], v200 offset:32768
    v_cvt_pk_bf16_f32 v151, v110, v111
    v_add_f32 v232, v232, v105
    v_add_f32 v232, v232, v106
    v_max3_f32 v234, v234, v115, v116
    v_max3_f32 v234, v234, v117, v118
    v_mul_f32 v243, s54, v243
    v_cvt_pk_bf16_f32 v242, v242, v243
    v_accvgpr_write_b32 a101, v242
    v_mfma_f32_32x32x16_bf16 v[0:15], a[216:219], v[148:151], v[0:15]
    s_waitcnt lgkmcnt(5)
    ds_read_b128 a[236:239], v201 offset:32768
    v_add_f32 v232, v232, v107
    v_add_f32 v232, v232, v108
    v_max3_f32 v234, v234, v119, v120
    v_max3_f32 v234, v234, v121, v122
    v_accvgpr_read_b32 v240, a140
    v_accvgpr_read_b32 v241, a141
    v_mul_f32 v240, s54, v240
    v_mfma_f32_32x32x16_bf16 v[16:31], a[220:223], v[148:151], v[16:31]
    s_waitcnt lgkmcnt(4)
    ds_read_b128 a[240:243], v202 offset:32768
    v_add_f32 v232, v232, v109
    v_add_f32 v232, v232, v110
    v_max3_f32 v234, v234, v123, v124
    v_max3_f32 v234, v234, v125, v126
    v_mul_f32 v241, s54, v241
    v_cvt_pk_bf16_f32 v240, v240, v241
    v_accvgpr_write_b32 a102, v240
    v_mfma_f32_32x32x16_bf16 v[32:47], a[224:227], v[148:151], v[32:47]
    s_waitcnt lgkmcnt(3)
    ds_read_b128 a[244:247], v203 offset:32768
    v_add_f32 v232, v232, v111
    v_max_f32 v234, v234, v127
    v_cmp_lt_f32 vcc, 0x41000000, v234
    v_accvgpr_read_b32 v242, a142
    v_accvgpr_read_b32 v243, a143
    v_mul_f32 v242, s54, v242
    v_mfma_f32_32x32x16_bf16 v[48:63], a[228:231], v[148:151], v[48:63]
    s_waitcnt lgkmcnt(3)
    ds_read_b128 a[248:251], v204 offset:32768
    v_max3_f32 v235, v152, v153, v154
    v_max3_f32 v235, v235, v155, v156
    v_mul_f32 v243, s54, v243
    v_cvt_pk_bf16_f32 v242, v242, v243
    v_accvgpr_write_b32 a103, v242
    s_cbranch_vccnz L_rare3
L_back3:
    v_exp_f32 v112, v112
    v_exp_f32 v113, v113
    v_mfma_f32_32x32x16_bf16 v[96:111], a[232:235], v[168:171], v[128:143]
    s_waitcnt lgkmcnt(3)
    ds_read_b128 a[252:255], v205 offset:32768
    v_cvt_pk_bf16_f32 v144, v112, v113
    v_exp_f32 v114, v114
    v_exp_f32 v115, v115
    v_accvgpr_read_b32 v240, a144
    v_accvgpr_read_b32 v241, a145
    v_mul_f32 v240, s54, v240
    v_mfma_f32_32x32x16_bf16 v[96:111], a[236:239], v[172:175], v[96:111]
    s_waitcnt lgkmcnt(3)
    ds_read_b128 a[216:219], v206 offset:32768
    s_add_u32 m0, s43, 114688
    s_add_u32 s46, s42, 49152
    v_cvt_pk_bf16_f32 v145, v114, v115
    v_exp_f32 v116, v116
    v_exp_f32 v117, v117
    v_mul_f32 v241, s54, v241
    v_cvt_pk_bf16_f32 v240, v240, v241
    v_accvgpr_write_b32 a104, v240
    v_mfma_f32_32x32x16_bf16 v[96:111], a[240:243], v[176:179], v[96:111]
    s_waitcnt lgkmcnt(3)
    ds_read_b128 a[220:223], v207 offset:32768
    buffer_load_dwordx4 v228, s[16:19], s46 offen nt lds
    v_cvt_pk_bf16_f32 v146, v116, v117
    v_exp_f32 v118, v118
    v_exp_f32 v119, v119
    v_accvgpr_read_b32 v242, a146
    v_accvgpr_read_b32 v243, a147
    v_mul_f32 v242, s54, v242
    v_mfma_f32_32x32x16_bf16 v[96:111], a[244:247], v[180:183], v[96:111]
    s_waitcnt lgkmcnt(3)
    ds_read_b64_tr_b16 a[224:225], v216 offset:0
    ds_read_b64_tr_b16 a[226:227], v216 offset:4096
    ds_read_b64_tr_b16 a[228:229], v217 offset:0
    ds_read_b64_tr_b16 a[230:231], v217 offset:4096
    v_cvt_pk_bf16_f32 v147, v118, v119
    v_exp_f32 v120, v120
    v_add_f32 v232, v232, v112
    v_mul_f32 v243, s54, v243
    v_cvt_pk_bf16_f32 v242, v242, v243
    v_accvgpr_write_b32 a105, v242
    v_mfma_f32_32x32x16_bf16 v[96:111], a[248:251], v[184:187], v[96:111]
    s_waitcnt lgkmcnt(6)
    ds_read_b64_tr_b16 a[232:233], v218 offset:0
    ds_read_b64_tr_b16 a[234:235], v218 offset:4096
    ds_read_b64_tr_b16 a[236:237], v219 offset:0
    ds_read_b64_tr_b16 a[238:239], v219 offset:4096
    buffer_load_dwordx4 v229, s[16:19], s46 offen offset:1024 nt lds
    v_exp_f32 v121, v121
    v_add_f32 v232, v232, v113
    v_max3_f32 v235, v235, v157, v158
    v_max_f32 v235, v235, v159
    v_mov_b32 v238, v235
    v_accvgpr_read_b32 v240, a148
    v_accvgpr_read_b32 v241, a149
    v_mul_f32 v240, s54, v240
    v_mfma_f32_32x32x16_bf16 v[96:111], a[252:255], v[188:191], v[96:111]
    s_waitcnt lgkmcnt(9)
    ds_read_b64_tr_b16 a[240:241], v220 offset:0
    ds_read_b64_tr_b16 a[242:243], v220 offset:4096
    ds_read_b64_tr_b16 a[244:245], v221 offset:0
    ds_read_b64_tr_b16 a[246:247], v221 offset:4096
    v_cvt_pk_bf16_f32 v148, v120, v121
    v_exp_f32 v122, v122
    v_add_f32 v232, v232, v114
    v_permlane16_swap_b32 v238, v235
    v_max_f32 v235, v238, v235
    v_mov_b32 v238, v235
    v_mul_f32 v241, s54, v241
    v_cvt_pk_bf16_f32 v240, v240, v241
    v_accvgpr_write_b32 a106, v240
    v_mfma_f32_32x32x16_bf16 v[96:111], a[216:219], v[192:195], v[96:111]
    s_waitcnt lgkmcnt(12)
    ds_read_b64_tr_b16 a[248:249], v222 offset:0
    ds_read_b64_tr_b16 a[250:251], v222 offset:4096
    ds_read_b64_tr_b16 a[252:253], v223 offset:0
    ds_read_b64_tr_b16 a[254:255], v223 offset:4096
    buffer_load_dwordx4 v228, s[16:19], s46 offen offset:2048 nt lds
    v_exp_f32 v123, v123
    v_add_f32 v232, v232, v115
    v_add_f32 v232, v232, v116
    v_permlane32_swap_b32 v238, v235
    v_max_f32 v235, v238, v235
    v_sub_f32 v152, v152, v235
    v_sub_f32 v153, v153, v235
    v_sub_f32 v154, v154, v235
    v_sub_f32 v155, v155, v235
    v_sub_f32 v156, v156, v235
    v_sub_f32 v157, v157, v235
    v_sub_f32 v158, v158, v235
    v_sub_f32 v159, v159, v235
    v_exp_f32 v152, v152
    v_exp_f32 v153, v153
    v_exp_f32 v154, v154
    v_exp_f32 v155, v155
    v_exp_f32 v156, v156
    v_exp_f32 v157, v157
    v_exp_f32 v158, v158
    v_exp_f32 v159, v159
    v_accvgpr_read_b32 v242, a150
    v_accvgpr_read_b32 v243, a151
    v_mul_f32 v242, s54, v242
    v_mfma_f32_32x32x16_bf16 v[96:111], a[220:223], v[196:199], v[96:111]
    s_waitcnt lgkmcnt(14)
    ds_read_b64_tr_b16 a[216:217], v208 offset:24576
    ds_read_b64_tr_b16 a[218:219], v208 offset:26624
    v_cvt_pk_bf16_f32 v149, v122, v123
    v_exp_f32 v124, v124
    v_add_f32 v232, v232, v117
    v_cvt_pk_bf16_f32 v164, v152, v153
    v_cvt_pk_bf16_f32 v165, v154, v155
    v_cvt_pk_bf16_f32 v166, v156, v157
    v_cvt_pk_bf16_f32 v167, v158, v159
    v_mul_f32 v243, s54, v243
    v_cvt_pk_bf16_f32 v242, v242, v243
    v_accvgpr_write_b32 a107, v242
    v_mfma_f32_16x16x32_bf16 v[64:67], a[224:227], v[164:167], 0
    s_waitcnt lgkmcnt(14)
    ds_read_b64_tr_b16 a[220:221], v209 offset:24576
    ds_read_b64_tr_b16 a[222:223], v209 offset:26624
    v_mfma_f32_16x16x32_bf16 v[68:71], a[228:231], v[164:167], 0
    s_waitcnt lgkmcnt(14)
    v_add_f32 v233, v233, v152
    v_add_f32 v233, v233, v153
    v_mfma_f32_16x16x32_bf16 v[72:75], a[232:235], v[164:167], 0
    s_waitcnt lgkmcnt(12)
    ds_read_b64_tr_b16 a[224:225], v210 offset:24576
    ds_read_b64_tr_b16 a[226:227], v210 offset:26624
    v_mfma_f32_16x16x32_bf16 v[76:79], a[236:239], v[164:167], 0
    s_waitcnt lgkmcnt(12)
    v_add_f32 v233, v233, v154
    v_add_f32 v233, v233, v155
    v_mfma_f32_16x16x32_bf16 v[80:83], a[240:243], v[164:167], 0
    s_waitcnt lgkmcnt(10)
    ds_read_b64_tr_b16 a[228:229], v211 offset:24576
    ds_read_b64_tr_b16 a[230:231], v211 offset:26624
    v_mfma_f32_16x16x32_bf16 v[84:87], a[244:247], v[164:167], 0
    s_waitcnt lgkmcnt(10)
    v_add_f32 v233, v233, v156
    v_add_f32 v233, v233, v157
    v_mfma_f32_16x16x32_bf16 v[88:91], a[248:251], v[164:167], 0
    s_waitcnt lgkmcnt(8)
    ds_read_b64_tr_b16 a[232:233], v208 offset:28672
    ds_read_b64_tr_b16 a[234:235], v208 offset:30720
    v_mfma_f32_16x16x32_bf16 v[92:95], a[252:255], v[164:167], 0
    s_waitcnt lgkmcnt(8)
    v_add_f32 v233, v233, v158
    v_add_f32 v233, v233, v159
    v_mfma_f32_32x32x16_bf16 v[0:15], a[216:219], v[144:147], v[0:15]
    s_waitcnt lgkmcnt(6)
    ds_read_b64_tr_b16 a[236:237], v209 offset:28672
    ds_read_b64_tr_b16 a[238:239], v209 offset:30720
    buffer_load_dwordx4 v229, s[16:19], s46 offen offset:3072 nt lds
    v_exp_f32 v125, v125
    v_add_f32 v232, v232, v118
    v_accvgpr_read_b32 v240, a152
    v_accvgpr_read_b32 v241, a153
    v_mul_f32 v240, s54, v240
    v_mfma_f32_32x32x16_bf16 v[16:31], a[220:223], v[144:147], v[16:31]
    s_waitcnt lgkmcnt(6)
    ds_read_b64_tr_b16 a[240:241], v210 offset:28672
    ds_read_b64_tr_b16 a[242:243], v210 offset:30720
    v_cvt_pk_bf16_f32 v150, v124, v125
    v_exp_f32 v126, v126
    v_add_f32 v232, v232, v119
    v_mul_f32 v241, s54, v241
    v_cvt_pk_bf16_f32 v240, v240, v241
    v_accvgpr_write_b32 a108, v240
    v_mfma_f32_32x32x16_bf16 v[32:47], a[224:227], v[144:147], v[32:47]
    s_waitcnt lgkmcnt(6)
    ds_read_b64_tr_b16 a[244:245], v211 offset:28672
    ds_read_b64_tr_b16 a[246:247], v211 offset:30720
    v_exp_f32 v127, v127
    v_add_f32 v232, v232, v120
    v_max3_f32 v234, v96, v97, v98
    v_accvgpr_read_b32 v242, a154
    v_accvgpr_read_b32 v243, a155
    v_mul_f32 v242, s54, v242
    v_mfma_f32_32x32x16_bf16 v[48:63], a[228:231], v[144:147], v[48:63]
    s_waitcnt lgkmcnt(6)
    ds_read_b128 a[248:251], v200 offset:40960
    v_cvt_pk_bf16_f32 v151, v126, v127
    v_add_f32 v232, v232, v121
    v_add_f32 v232, v232, v122
    v_max3_f32 v234, v234, v99, v100
    v_max3_f32 v234, v234, v101, v102
    v_mul_f32 v243, s54, v243
    v_cvt_pk_bf16_f32 v242, v242, v243
    v_accvgpr_write_b32 a109, v242
    v_mfma_f32_32x32x16_bf16 v[0:15], a[232:235], v[148:151], v[0:15]
    s_waitcnt lgkmcnt(5)
    ds_read_b128 a[252:255], v201 offset:40960
    v_add_f32 v232, v232, v123
    v_add_f32 v232, v232, v124
    v_max3_f32 v234, v234, v103, v104
    v_max3_f32 v234, v234, v105, v106
    v_accvgpr_read_b32 v240, a156
    v_accvgpr_read_b32 v241, a157
    v_mul_f32 v240, s54, v240
    v_mfma_f32_32x32x16_bf16 v[16:31], a[236:239], v[148:151], v[16:31]
    s_waitcnt lgkmcnt(4)
    ds_read_b128 a[216:219], v202 offset:40960
    v_add_f32 v232, v232, v125
    v_add_f32 v232, v232, v126
    v_max3_f32 v234, v234, v107, v108
    v_max3_f32 v234, v234, v109, v110
    v_mul_f32 v241, s54, v241
    v_cvt_pk_bf16_f32 v240, v240, v241
    v_accvgpr_write_b32 a110, v240
    v_mfma_f32_32x32x16_bf16 v[32:47], a[240:243], v[148:151], v[32:47]
    s_waitcnt lgkmcnt(3)
    ds_read_b128 a[220:223], v203 offset:40960
    v_add_f32 v232, v232, v127
    v_max_f32 v234, v234, v111
    v_cmp_lt_f32 vcc, 0x41000000, v234
    v_accvgpr_read_b32 v242, a158
    v_accvgpr_read_b32 v243, a159
    v_mul_f32 v242, s54, v242
    v_mfma_f32_32x32x16_bf16 v[48:63], a[244:247], v[148:151], v[48:63]
    s_waitcnt lgkmcnt(3)
    ds_read_b128 a[224:227], v204 offset:40960
    v_sub_f32 v160, 0, v235
    v_sub_f32 v161, 0, v235
    v_mul_f32 v243, s54, v243
    v_cvt_pk_bf16_f32 v242, v242, v243
    v_accvgpr_write_b32 a111, v242
    s_cbranch_vccnz L_rare4
L_back4:
    v_exp_f32 v96, v96
    v_exp_f32 v97, v97
    v_mfma_f32_32x32x16_bf16 v[112:127], a[248:251], v[168:171], v[128:143]
    s_waitcnt lgkmcnt(3)
    ds_read_b128 a[228:231], v205 offset:40960
    v_cvt_pk_bf16_f32 v144, v96, v97
    v_exp_f32 v98, v98
    v_exp_f32 v99, v99
    v_accvgpr_read_b32 v240, a160
    v_accvgpr_read_b32 v241, a161
    v_mul_f32 v240, s54, v240
    v_mfma_f32_32x32x16_bf16 v[112:127], a[252:255], v[172:175], v[112:127]
    s_waitcnt lgkmcnt(3)
    ds_read_b128 a[232:235], v206 offset:40960
    v_cvt_pk_bf16_f32 v145, v98, v99
    v_exp_f32 v100, v100
    v_exp_f32 v101, v101
    v_mul_f32 v241, s54, v241
    v_cvt_pk_bf16_f32 v240, v240, v241
    v_accvgpr_write_b32 a112, v240
    s_waitcnt vmcnt(11)
    s_barrier
L_ih2:
    s_add_u32 m0, s43, 16384
    s_add_u32 s45, s42, 81920
    v_mfma_f32_32x32x16_bf16 v[112:127], a[216:219], v[176:179], v[112:127]
    s_waitcnt lgkmcnt(3)
    ds_read_b128 a[236:239], v207 offset:40960
    buffer_load_dwordx4 v224, s[12:15], s45 offen nt lds
    v_cvt_pk_bf16_f32 v146, v100, v101
    v_exp_f32 v102, v102
    v_exp_f32 v103, v103
    v_and_b32 v238, 112, v244
    v_lshl_add_u32 v238, v238, 3, s44
    v_accvgpr_read_b32 v242, a162
    v_accvgpr_read_b32 v243, a163
    v_mul_f32 v242, s54, v242
    v_mfma_f32_32x32x16_bf16 v[112:127], a[220:223], v[180:183], v[112:127]
    s_waitcnt lgkmcnt(3)
    ds_read_b64_tr_b16 a[240:241], v208 offset:32768
    ds_read_b64_tr_b16 a[242:243], v208 offset:34816
    v_cvt_pk_bf16_f32 v147, v102, v103
    v_exp_f32 v104, v104
    v_add_f32 v232, v232, v96
    v_add_u32 v238, L_ih4 - L_ibase, v238
    v_min_u32 v238, L_end - L_ibase - 64, v238
    v_mul_f32 v243, s54, v243
    v_cvt_pk_bf16_f32 v242, v242, v243
    v_accvgpr_write_b32 a113, v242
    v_mfma_f32_32x32x16_bf16 v[112:127], a[224:227], v[184:187], v[112:127]
    s_waitcnt lgkmcnt(4)
    ds_read_b64_tr_b16 a[244:245], v209 offset:32768
    ds_read_b64_tr_b16 a[246:247], v209 offset:34816
    buffer_load_dwordx4 v225, s[12:15], s45 offen offset:1024 nt lds
    v_exp_f32 v105, v105
    v_add_f32 v232, v232, v97
    v_accvgpr_read_b32 v240, a164
    v_accvgpr_read_b32 v241, a165
    v_mul_f32 v240, s54, v240
    v_mfma_f32_32x32x16_bf16 v[112:127], a[228:231], v[188:191], v[112:127]
    s_waitcnt lgkmcnt(5)
    global_load_dword a64, v238, s[90:91]
    ds_read_b64_tr_b16 a[248:249], v210 offset:32768
    ds_read_b64_tr_b16 a[250:251], v210 offset:34816
    v_cvt_pk_bf16_f32 v148, v104, v105
    v_exp_f32 v106, v106
    v_add_f32 v232, v232, v98
    v_mul_f32 v241, s54, v241
    v_cvt_pk_bf16_f32 v240, v240, v241
    v_accvgpr_write_b32 a114, v240
    v_mfma_f32_32x32x16_bf16 v[112:127], a[232:235], v[192:195], v[112:127]
    s_waitcnt lgkmcnt(6)
    ds_read_b64_tr_b16 a[252:253], v211 offset:32768
    ds_read_b64_tr_b16 a[254:255], v211 offset:34816
    buffer_load_dwordx4 v226, s[12:15], s45 offen offset:2048 nt lds
    v_exp_f32 v107, v107
    v_add_f32 v232, v232, v99
    v_add_f32 v232, v232, v100
    v_accvgpr_read_b32 v242, a166
    v_accvgpr_read_b32 v243, a167
    v_mul_f32 v242, s54, v242
    v_mfma_f32_32x32x16_bf16 v[112:127], a[236:239], v[196:199], v[112:127]
    s_waitcnt lgkmcnt(6)
    ds_read_b64_tr_b16 a[216:217], v208 offset:36864
    ds_read_b64_tr_b16 a[218:219], v208 offset:38912
    v_cvt_pk_bf16_f32 v149, v106, v107
    v_exp_f32 v108, v108
    v_add_f32 v232, v232, v101
    v_mul_f32 v243, s54, v243
    v_cvt_pk_bf16_f32 v242, v242, v243
    v_accvgpr_write_b32 a115, v242
    v_mfma_f32_32x32x16_bf16 v[0:15], a[240:243], v[144:147], v[0:15]
    s_waitcnt lgkmcnt(6)
    ds_read_b64_tr_b16 a[220:221], v209 offset:36864
    ds_read_b64_tr_b16 a[222:223], v209 offset:38912
    buffer_load_dwordx4 v227, s[12:15], s45 offen offset:3072 nt lds
    v_exp_f32 v109, v109
    v_add_f32 v232, v232, v102
    v_accvgpr_read_b32 v240, a168
    v_accvgpr_read_b32 v241, a169
    v_mul_f32 v240, s54, v240
    v_mfma_f32_32x32x16_bf16 v[16:31], a[244:247], v[144:147], v[16:31]
    s_waitcnt lgkmcnt(6)
    ds_read_b64_tr_b16 a[224:225], v210 offset:36864
    ds_read_b64_tr_b16 a[226:227], v210 offset:38912
    v_cvt_pk_bf16_f32 v150, v108, v109
    v_exp_f32 v110, v110
    v_add_f32 v232, v232, v103
    v_mul_f32 v241, s54, v241
    v_cvt_pk_bf16_f32 v240, v240, v241
    v_accvgpr_write_b32 a116, v240
    v_mfma_f32_32x32x16_bf16 v[32:47], a[248:251], v[144:147], v[32:47]
    s_waitcnt lgkmcnt(6)
    ds_read_b64_tr_b16 a[228:229], v211 offset:36864
    ds_read_b64_tr_b16 a[230:231], v211 offset:38912
    v_exp_f32 v111, v111
    v_add_f32 v232, v232, v104
    v_max3_f32 v234, v112, v113, v114
    v_accvgpr_read_b32 v242, a170
    v_accvgpr_read_b32 v243, a171
    v_mul_f32 v242, s54, v242
    v_mfma_f32_32x32x16_bf16 v[48:63], a[252:255], v[144:147], v[48:63]
    s_waitcnt lgkmcnt(6)
    ds_read_b128 a[232:235], v200 offset:49152
    v_cvt_pk_bf16_f32 v151, v110, v111
    v_add_f32 v232, v232, v105
    v_add_f32 v232, v232, v106
    v_max3_f32 v234, v234, v115, v116
    v_max3_f32 v234, v234, v117, v118
    v_mul_f32 v243, s54, v243
    v_cvt_pk_bf16_f32 v242, v242, v243
    v_accvgpr_write_b32 a117, v242
    v_mfma_f32_32x32x16_bf16 v[0:15], a[216:219], v[148:151], v[0:15]
    s_waitcnt lgkmcnt(5)
    ds_read_b128 a[236:239], v201 offset:49152
    v_add_f32 v232, v232, v107
    v_add_f32 v232, v232, v108
    v_max3_f32 v234, v234, v119, v120
    v_max3_f32 v234, v234, v121, v122
    v_accvgpr_read_b32 v240, a172
    v_accvgpr_read_b32 v241, a173
    v_mul_f32 v240, s54, v240
    v_mfma_f32_32x32x16_bf16 v[16:31], a[220:223], v[148:151], v[16:31]
    s_waitcnt lgkmcnt(4)
    ds_read_b128 a[240:243], v202 offset:49152
    v_add_f32 v232, v232, v109
    v_add_f32 v232, v232, v110
    v_max3_f32 v234, v234, v123, v124
    v_max3_f32 v234, v234, v125, v126
    v_mul_f32 v241, s54, v241
    v_cvt_pk_bf16_f32 v240, v240, v241
    v_accvgpr_write_b32 a118, v240
    v_mfma_f32_32x32x16_bf16 v[32:47], a[224:227], v[148:151], v[32:47]
    s_waitcnt lgkmcnt(3)
    ds_read_b128 a[244:247], v203 offset:49152
    v_add_f32 v232, v232, v111
    v_max_f32 v234, v234, v127
    v_cmp_lt_f32 vcc, 0x41000000, v234
    v_accvgpr_read_b32 v242, a174
    v_accvgpr_read_b32 v243, a175
    v_mul_f32 v242, s54, v242
    v_mfma_f32_32x32x16_bf16 v[48:63], a[228:231], v[148:151], v[48:63]
    s_waitcnt lgkmcnt(3)
    ds_read_b128 a[248:251], v204 offset:49152
    v_sub_f32 v162, 0, v235
    v_sub_f32 v163, 0, v235
    v_mul_f32 v243, s54, v243
    v_cvt_pk_bf16_f32 v242, v242, v243
    v_accvgpr_write_b32 a119, v242
    s_cbranch_vccnz L_rare5
L_back5:
    v_exp_f32 v112, v112
    v_exp_f32 v113, v113
    v_mfma_f32_32x32x16_bf16 v[96:111], a[232:235], v[168:171], v[128:143]
    s_waitcnt lgkmcnt(3)
    ds_read_b128 a[252:255], v205 offset:49152
    v_cvt_pk_bf16_f32 v144, v112, v113
    v_exp_f32 v114, v114
    v_exp_f32 v115, v115
    v_accvgpr_read_b32 v240, a176
    v_accvgpr_read_b32 v241, a177
    v_mul_f32 v240, s54, v240
    v_mfma_f32_32x32x16_bf16 v[96:111], a[236:239], v[172:175], v[96:111]
    s_waitcnt lgkmcnt(3)
    ds_read_b128 a[216:219], v206 offset:49152
    s_add_u32 m0, s43, 65536
    s_add_u32 s46, s42, 65536
    v_cvt_pk_bf16_f32 v145, v114, v115
    v_exp_f32 v116, v116
    v_exp_f32 v117, v117
    v_mul_f32 v241, s54, v241
    v_cvt_pk_bf16_f32 v240, v240, v241
    v_accvgpr_write_b32 a120, v240
    v_mfma_f32_32x32x16_bf16 v[96:111], a[240:243], v[176:179], v[96:111]
    s_waitcnt lgkmcnt(3)
    ds_read_b128 a[220:223], v207 offset:49152
    buffer_load_dwordx4 v228, s[16:19], s46 offen nt lds
    v_cvt_pk_bf16_f32 v146, v116, v117
    v_exp_f32 v118, v118
    v_exp_f32 v119, v119
    v_accvgpr_read_b32 v242, a178
    v_accvgpr_read_b32 v243, a179
    v_mul_f32 v242, s54, v242
    v_mfma_f32_32x32x16_bf16 v[96:111], a[244:247], v[180:183], v[96:111]
    s_waitcnt lgkmcnt(3)
    ds_read_b64_tr_b16 a[224:225], v208 offset:40960
    ds_read_b64_tr_b16 a[226:227], v208 offset:43008
    v_cvt_pk_bf16_f32 v147, v118, v119
    v_exp_f32 v120, v120
    v_add_f32 v232, v232, v112
    v_mul_f32 v243, s54, v243
    v_cvt_pk_bf16_f32 v242, v242, v243
    v_accvgpr_write_b32 a121, v242
    v_mfma_f32_32x32x16_bf16 v[96:111], a[248:251], v[184:187], v[96:111]
    s_waitcnt lgkmcnt(4)
    ds_read_b64_tr_b16 a[228:229], v209 offset:40960
    ds_read_b64_tr_b16 a[230:231], v209 offset:43008
    buffer_load_dwordx4 v229, s[16:19], s46 offen offset:1024 nt lds
    v_exp_f32 v121, v121
    v_add_f32 v232, v232, v113
    v_accvgpr_read_b32 v240, a180
    v_accvgpr_read_b32 v241, a181
    v_mul_f32 v240, s54, v240
    v_mfma_f32_32x32x16_bf16 v[96:111], a[252:255], v[188:191], v[96:111]
    s_waitcnt lgkmcnt(5)
    ds_read_b64_tr_b16 a[232:233], v210 offset:40960
    ds_read_b64_tr_b16 a[234:235], v210 offset:43008
    v_cvt_pk_bf16_f32 v148, v120, v121
    v_exp_f32 v122, v122
    v_add_f32 v232, v232, v114
    v_mul_f32 v241, s54, v241
    v_cvt_pk_bf16_f32 v240, v240, v241
    v_accvgpr_write_b32 a122, v240
    v_mfma_f32_32x32x16_bf16 v[96:111], a[216:219], v[192:195], v[96:111]
    s_waitcnt lgkmcnt(6)
    ds_read_b64_tr_b16 a[236:237], v211 offset:40960
    ds_read_b64_tr_b16 a[238:239], v211 offset:43008
    buffer_load_dwordx4 v228, s[16:19], s46 offen offset:2048 nt lds
    v_exp_f32 v123, v123
    v_add_f32 v232, v232, v115
    v_add_f32 v232, v232, v116
    v_accvgpr_read_b32 v242, a182
    v_accvgpr_read_b32 v243, a183
    v_mul_f32 v242, s54, v242
    v_mfma_f32_32x32x16_bf16 v[96:111], a[220:223], v[196:199], v[96:111]
    s_waitcnt lgkmcnt(6)
    ds_read_b64_tr_b16 a[240:241], v208 offset:45056
    ds_read_b64_tr_b16 a[242:243], v208 offset:47104
    v_cvt_pk_bf16_f32 v149, v122, v123
    v_exp_f32 v124, v124
    v_add_f32 v232, v232, v117
    v_mul_f32 v243, s54, v243
    v_cvt_pk_bf16_f32 v242, v242, v243
    v_accvgpr_write_b32 a123, v242
    v_mfma_f32_32x32x16_bf16 v[0:15], a[224:227], v[144:147], v[0:15]
    s_waitcnt lgkmcnt(6)
    ds_read_b64_tr_b16 a[244:245], v209 offset:45056
    ds_read_b64_tr_b16 a[246:247], v209 offset:47104
    buffer_load_dwordx4 v229, s[16:19], s46 offen offset:3072 nt lds
    v_exp_f32 v125, v125
    v_add_f32 v232, v232, v118
    v_accvgpr_read_b32 v240, a184
    v_accvgpr_read_b32 v241, a185
    v_mul_f32 v240, s54, v240
    v_mfma_f32_32x32x16_bf16 v[16:31], a[228:231], v[144:147], v[16:31]
    s_waitcnt lgkmcnt(6)
    ds_read_b64_tr_b16 a[248:249], v210 offset:45056
    ds_read_b64_tr_b16 a[250:251], v210 offset:47104
    v_cvt_pk_bf16_f32 v150, v124, v125
    v_exp_f32 v126, v126
    v_add_f32 v232, v232, v119
    v_mul_f32 v241, s54, v241
    v_cvt_pk_bf16_f32 v240, v240, v241
    v_accvgpr_write_b32 a124, v240
    v_mfma_f32_32x32x16_bf16 v[32:47], a[232:235], v[144:147], v[32:47]
    s_waitcnt lgkmcnt(6)
    ds_read_b64_tr_b16 a[252:253], v211 offset:45056
    ds_read_b64_tr_b16 a[254:255], v211 offset:47104
    v_exp_f32 v127, v127
    v_add_f32 v232, v232, v120
    v_max3_f32 v234, v96, v97, v98
    v_accvgpr_read_b32 v242, a186
    v_accvgpr_read_b32 v243, a187
    v_mul_f32 v242, s54, v242
    v_mfma_f32_32x32x16_bf16 v[48:63], a[236:239], v[144:147], v[48:63]
    s_waitcnt lgkmcnt(6)
    ds_read_b128 a[216:219], v212 offset:32768
    ds_read_b128 a[220:223], v213 offset:32768
    v_cvt_pk_bf16_f32 v151, v126, v127
    v_add_f32 v232, v232, v121
    v_add_f32 v232, v232, v122
    v_max3_f32 v234, v234, v99, v100
    v_max3_f32 v234, v234, v101, v102
    v_mul_f32 v243, s54, v243
    v_cvt_pk_bf16_f32 v242, v242, v243
    v_accvgpr_write_b32 a125, v242
    v_mfma_f32_32x32x16_bf16 v[0:15], a[240:243], v[148:151], v[0:15]
    s_waitcnt lgkmcnt(6)
    ds_read_b128 a[224:227], v214 offset:32768
    ds_read_b128 a[228:231], v215 offset:32768
    v_add_f32 v232, v232, v123
    v_add_f32 v232, v232, v124
    v_max3_f32 v234, v234, v103, v104
    v_max3_f32 v234, v234, v105, v106
    v_accvgpr_read_b32 v240, a188
    v_accvgpr_read_b32 v241, a189
    v_mul_f32 v240, s54, v240
    v_mfma_f32_32x32x16_bf16 v[16:31], a[244:247], v[148:151], v[16:31]
    s_waitcnt lgkmcnt(6)
    ds_read_b128 a[232:235], v212 offset:36864
    ds_read_b128 a[236:239], v213 offset:36864
    v_add_f32 v232, v232, v125
    v_add_f32 v232, v232, v126
    v_max3_f32 v234, v234, v107, v108
    v_max3_f32 v234, v234, v109, v110
    v_mul_f32 v241, s54, v241
    v_cvt_pk_bf16_f32 v240, v240, v241
    v_accvgpr_write_b32 a126, v240
    v_mfma_f32_32x32x16_bf16 v[32:47], a[248:251], v[148:151], v[32:47]
    s_waitcnt lgkmcnt(6)
    ds_read_b128 a[240:243], v214 offset:36864
    ds_read_b128 a[244:247], v215 offset:36864
    v_add_f32 v232, v232, v127
    v_max_f32 v234, v234, v111
    v_cmp_lt_f32 vcc, 0x41000000, v234
    v_accvgpr_read_b32 v242, a190
    v_accvgpr_read_b32 v243, a191
    v_mul_f32 v242, s54, v242
    v_mfma_f32_32x32x16_bf16 v[48:63], a[252:255], v[148:151], v[48:63]
    s_waitcnt lgkmcnt(7)
    ds_read_b128 a[248:251], v200 offset:57344
    v_mul_f32 v243, s54, v243
    v_cvt_pk_bf16_f32 v242, v242, v243
    v_accvgpr_write_b32 a127, v242
    s_cbranch_vccnz L_rare6
L_back6:
    v_mfma_f32_16x16x32_bf16 v[152:155], a[216:219], a[200:203], v[160:163]
    s_waitcnt lgkmcnt(7)
    ds_read_b128 a[252:255], v201 offset:57344
    v_mfma_f32_16x16x32_bf16 v[152:155], a[220:223], a[204:207], v[152:155]
    s_waitcnt lgkmcnt(7)
    v_mfma_f32_16x16x32_bf16 v[152:155], a[224:227], a[208:211], v[152:155]
    s_waitcnt lgkmcnt(6)
    ds_read_b128 a[216:219], v202 offset:57344
    v_mfma_f32_16x16x32_bf16 v[152:155], a[228:231], a[212:215], v[152:155]
    s_waitcnt lgkmcnt(6)
    v_mfma_f32_16x16x32_bf16 v[156:159], a[232:235], a[200:203], v[160:163]
    s_waitcnt lgkmcnt(5)
    ds_read_b128 a[220:223], v203 offset:57344
    v_mfma_f32_16x16x32_bf16 v[156:159], a[236:239], a[204:207], v[156:159]
    s_waitcnt lgkmcnt(5)
    v_mfma_f32_16x16x32_bf16 v[156:159], a[240:243], a[208:211], v[156:159]
    s_waitcnt lgkmcnt(4)
    ds_read_b128 a[224:227], v204 offset:57344
    v_mfma_f32_16x16x32_bf16 v[156:159], a[244:247], a[212:215], v[156:159]
    s_waitcnt lgkmcnt(4)
    v_exp_f32 v96, v96
    v_exp_f32 v97, v97
    v_mfma_f32_32x32x16_bf16 v[112:127], a[248:251], v[168:171], v[128:143]
    s_waitcnt lgkmcnt(3)
    ds_read_b128 a[228:231], v205 offset:57344
    v_cvt_pk_bf16_f32 v144, v96, v97
    v_exp_f32 v98, v98
    v_exp_f32 v99, v99
    v_accvgpr_read_b32 v240, a192
    v_mfma_f32_32x32x16_bf16 v[112:127], a[252:255], v[172:175], v[112:127]
    s_waitcnt lgkmcnt(3)
    ds_read_b128 a[232:235], v206 offset:57344
    v_cvt_pk_bf16_f32 v145, v98, v99
    v_exp_f32 v100, v100
    v_exp_f32 v101, v101
    v_mul_f32 v240, s54, v240
    s_waitcnt vmcnt(9)
    s_barrier
L_ih3:
    s_add_u32 m0, s43, 32768
    s_add_u32 s45, s42, 98304
    v_mfma_f32_32x32x16_bf16 v[112:127], a[216:219], v[176:179], v[112:127]
    s_waitcnt lgkmcnt(3)
    ds_read_b128 a[236:239], v207 offset:57344
    buffer_load_dwordx4 v224, s[12:15], s45 offen nt lds
    v_cvt_pk_bf16_f32 v146, v100, v101
    v_exp_f32 v102, v102
    v_exp_f32 v103, v103
    v_and_b32 v238, 112, v244
    v_lshl_add_u32 v238, v238, 3, s44
    v_accvgpr_read_b32 v241, a193
    v_mul_f32 v241, s54, v241
    v_mfma_f32_32x32x16_bf16 v[112:127], a[220:223], v[180:183], v[112:127]
    s_waitcnt lgkmcnt(3)
    ds_read_b64_tr_b16 a[240:241], v208 offset:49152
    ds_read_b64_tr_b16 a[242:243], v208 offset:51200
    v_cvt_pk_bf16_f32 v147, v102, v103
    v_exp_f32 v104, v104
    v_add_f32 v232, v232, v96
    v_add_u32 v238, L_ih5 - L_ibase, v238
    v_min_u32 v238, L_end - L_ibase - 64, v238
    v_accvgpr_read_b32 v242, a194
    v_mfma_f32_32x32x16_bf16 v[112:127], a[224:227], v[184:187], v[112:127]
    s_waitcnt lgkmcnt(4)
    ds_read_b64_tr_b16 a[244:245], v209 offset:49152
    ds_read_b64_tr_b16 a[246:247], v209 offset:51200
    buffer_load_dwordx4 v225, s[12:15], s45 offen offset:1024 nt lds
    v_exp_f32 v105, v105
    v_add_f32 v232, v232, v97
    v_mul_f32 v242, s54, v242
    v_accvgpr_read_b32 v243, a195
    v_mfma_f32_32x32x16_bf16 v[112:127], a[228:231], v[188:191], v[112:127]
    s_waitcnt lgkmcnt(5)
    global_load_dword a64, v238, s[90:91]
    ds_read_b64_tr_b16 a[248:249], v210 offset:49152
    ds_read_b64_tr_b16 a[250:251], v210 offset:51200
    v_cvt_pk_bf16_f32 v148, v104, v105
    v_exp_f32 v106, v106
    v_add_f32 v232, v232, v98
    v_mul_f32 v243, s54, v243
    v_mfma_f32_32x32x16_bf16 v[112:127], a[232:235], v[192:195], v[112:127]
    s_waitcnt lgkmcnt(6)
    ds_read_b64_tr_b16 a[252:253], v211 offset:49152
    ds_read_b64_tr_b16 a[254:255], v211 offset:51200
    buffer_load_dwordx4 v226, s[12:15], s45 offen offset:2048 nt lds
    v_exp_f32 v107, v107
    v_add_f32 v232, v232, v99
    v_add_f32 v232, v232, v100
    v_cvt_pk_bf16_f32 v240, v240, v241
    v_cvt_pk_bf16_f32 v241, v242, v243
    v_mfma_f32_32x32x16_bf16 v[112:127], a[236:239], v[196:199], v[112:127]
    s_waitcnt lgkmcnt(6)
    ds_read_b64_tr_b16 a[216:217], v208 offset:53248
    ds_read_b64_tr_b16 a[218:219], v208 offset:55296
    v_cvt_pk_bf16_f32 v149, v106, v107
    v_exp_f32 v108, v108
    v_add_f32 v232, v232, v101
    v_max3_f32 v235, v152, v153, v154
    v_max3_f32 v235, v235, v155, v156
    v_max3_f32 v235, v235, v157, v158
    v_max_f32 v235, v235, v159
    v_cmp_lt_f32 vcc, 0x41000000, v235
    s_nop 1
    s_cbranch_vccnz L_rare7
L_back7:
    v_add_u32 v239, 157696, v245
    v_mfma_f32_32x32x16_bf16 v[0:15], a[240:243], v[144:147], v[0:15]
    s_waitcnt lgkmcnt(6)
    ds_read_b64_tr_b16 a[220:221], v209 offset:53248
    ds_read_b64_tr_b16 a[222:223], v209 offset:55296
    ds_write_b64 v239, v[240:241] offset:0
    buffer_load_dwordx4 v227, s[12:15], s45 offen offset:3072 nt lds
    v_exp_f32 v109, v109
    v_add_f32 v232, v232, v102
    v_accvgpr_read_b32 v240, a196
    v_mfma_f32_32x32x16_bf16 v[16:31], a[244:247], v[144:147], v[16:31]
    s_waitcnt lgkmcnt(7)
    ds_read_b64_tr_b16 a[224:225], v210 offset:53248
    ds_read_b64_tr_b16 a[226:227], v210 offset:55296
    v_cvt_pk_bf16_f32 v150, v108, v109
    v_exp_f32 v110, v110
    v_add_f32 v232, v232, v103
    v_mul_f32 v240, s54, v240
    v_accvgpr_read_b32 v241, a197
    v_mfma_f32_32x32x16_bf16 v[32:47], a[248:251], v[144:147], v[32:47]
    s_waitcnt lgkmcnt(7)
    ds_read_b64_tr_b16 a[228:229], v211 offset:53248
    ds_read_b64_tr_b16 a[230:231], v211 offset:55296
    v_exp_f32 v111, v111
    v_add_f32 v232, v232, v104
    v_max3_f32 v234, v112, v113, v114
    v_mul_f32 v241, s54, v241
    v_mfma_f32_32x32x16_bf16 v[48:63], a[252:255], v[144:147], v[48:63]
    s_waitcnt lgkmcnt(7)
    ds_read_b128 a[232:235], v200 offset:0
    v_cvt_pk_bf16_f32 v151, v110, v111
    v_add_f32 v232, v232, v105
    v_add_f32 v232, v232, v106
    v_max3_f32 v234, v234, v115, v116
    v_max3_f32 v234, v234, v117, v118
    v_accvgpr_read_b32 v242, a198
    v_mul_f32 v242, s54, v242
    v_mfma_f32_32x32x16_bf16 v[0:15], a[216:219], v[148:151], v[0:15]
    s_waitcnt lgkmcnt(6)
    ds_read_b128 a[236:239], v201 offset:0
    v_add_f32 v232, v232, v107
    v_add_f32 v232, v232, v108
    v_max3_f32 v234, v234, v119, v120
    v_max3_f32 v234, v234, v121, v122
    v_accvgpr_read_b32 v243, a199
    v_mfma_f32_32x32x16_bf16 v[16:31], a[220:223], v[148:151], v[16:31]
    s_waitcnt lgkmcnt(4)
    ds_read_b128 a[240:243], v202 offset:0
    v_add_f32 v232, v232, v109
    v_add_f32 v232, v232, v110
    v_max3_f32 v234, v234, v123, v124
    v_max3_f32 v234, v234, v125, v126
    v_mul_f32 v243, s54, v243
    v_cvt_pk_bf16_f32 v240, v240, v241
    v_mfma_f32_32x32x16_bf16 v[32:47], a[224:227], v[148:151], v[32:47]
    s_waitcnt lgkmcnt(3)
    ds_read_b128 a[244:247], v203 offset:0
    v_add_f32 v232, v232, v111
    v_max_f32 v234, v234, v127
    v_cmp_lt_f32 vcc, 0x41000000, v234
    v_cvt_pk_bf16_f32 v241, v242, v243
    v_mfma_f32_32x32x16_bf16 v[48:63], a[228:231], v[148:151], v[48:63]
    s_waitcnt lgkmcnt(3)
    ds_write_b64 v239, v[240:241] offset:512
    ds_read_b128 a[248:251], v204 offset:0
    v_exp_f32 v152, v152
    v_exp_f32 v153, v153
    s_cbranch_vccnz L_rare8
L_back8:
    v_exp_f32 v112, v112
    v_exp_f32 v113, v113
    v_mfma_f32_32x32x16_bf16 v[96:111], a[232:235], v[168:171], v[128:143]
    s_waitcnt lgkmcnt(4)
    ds_read_b128 a[252:255], v205 offset:0
    v_cvt_pk_bf16_f32 v144, v112, v113
    v_exp_f32 v114, v114
    v_exp_f32 v115, v115
    v_mfma_f32_32x32x16_bf16 v[96:111], a[236:239], v[172:175], v[96:111]
    s_waitcnt lgkmcnt(4)
    ds_read_b128 a[216:219], v206 offset:0
    s_add_u32 m0, s43, 81920
    s_add_u32 s46, s42, 81920
    v_cvt_pk_bf16_f32 v145, v114, v115
    v_exp_f32 v116, v116
    v_exp_f32 v117, v117
    v_mfma_f32_32x32x16_bf16 v[96:111], a[240:243], v[176:179], v[96:111]
    s_waitcnt lgkmcnt(4)
    ds_read_b128 a[220:223], v207 offset:0
    buffer_load_dwordx4 v228, s[16:19], s46 offen nt lds
    v_cvt_pk_bf16_f32 v146, v116, v117
    v_exp_f32 v118, v118
    v_exp_f32 v119, v119
    v_mfma_f32_32x32x16_bf16 v[96:111], a[244:247], v[180:183], v[96:111]
    s_waitcnt lgkmcnt(3)
    ds_read_b64_tr_b16 a[224:225], v216 offset:32768
    ds_read_b64_tr_b16 a[226:227], v216 offset:36864
    ds_read_b64_tr_b16 a[228:229], v217 offset:32768
    ds_read_b64_tr_b16 a[230:231], v217 offset:36864
    v_cvt_pk_bf16_f32 v147, v118, v119
    v_exp_f32 v120, v120
    v_add_f32 v232, v232, v112
    v_mfma_f32_32x32x16_bf16 v[96:111], a[248:251], v[184:187], v[96:111]
    s_waitcnt lgkmcnt(6)
    ds_read_b64_tr_b16 a[232:233], v218 offset:32768
    ds_read_b64_tr_b16 a[234:235], v218 offset:36864
    ds_read_b64_tr_b16 a[236:237], v219 offset:32768
    ds_read_b64_tr_b16 a[238:239], v219 offset:36864
    buffer_load_dwordx4 v229, s[16:19], s46 offen offset:1024 nt lds
    v_exp_f32 v121, v121
    v_add_f32 v232, v232, v113
    v_mfma_f32_32x32x16_bf16 v[96:111], a[252:255], v[188:191], v[96:111]
    s_waitcnt lgkmcnt(9)
    ds_read_b64_tr_b16 a[240:241], v220 offset:32768
    ds_read_b64_tr_b16 a[242:243], v220 offset:36864
    ds_read_b64_tr_b16 a[244:245], v221 offset:32768
    ds_read_b64_tr_b16 a[246:247], v221 offset:36864
    v_cvt_pk_bf16_f32 v148, v120, v121
    v_exp_f32 v122, v122
    v_add_f32 v232, v232, v114
    v_mfma_f32_32x32x16_bf16 v[96:111], a[216:219], v[192:195], v[96:111]
    s_waitcnt lgkmcnt(12)
    ds_read_b64_tr_b16 a[248:249], v222 offset:32768
    ds_read_b64_tr_b16 a[250:251], v222 offset:36864
    ds_read_b64_tr_b16 a[252:253], v223 offset:32768
    ds_read_b64_tr_b16 a[254:255], v223 offset:36864
    buffer_load_dwordx4 v228, s[16:19], s46 offen offset:2048 nt lds
    v_exp_f32 v123, v123
    v_add_f32 v232, v232, v115
    v_add_f32 v232, v232, v116
    v_exp_f32 v154, v154
    v_exp_f32 v155, v155
    v_exp_f32 v156, v156
    v_exp_f32 v157, v157
    v_exp_f32 v158, v158
    v_exp_f32 v159, v159
    v_mfma_f32_32x32x16_bf16 v[96:111], a[220:223], v[196:199], v[96:111]
    s_waitcnt lgkmcnt(14)
    ds_read_b64_tr_b16 a[216:217], v208 offset:57344
    ds_read_b64_tr_b16 a[218:219], v208 offset:59392
    v_cvt_pk_bf16_f32 v149, v122, v123
    v_exp_f32 v124, v124
    v_add_f32 v232, v232, v117
    v_cvt_pk_bf16_f32 v164, v152, v153
    v_cvt_pk_bf16_f32 v165, v154, v155
    v_cvt_pk_bf16_f32 v166, v156, v157
    v_cvt_pk_bf16_f32 v167, v158, v159
    s_nop 1
    v_mfma_f32_16x16x32_bf16 v[64:67], a[224:227], v[164:167], v[64:67]
    s_waitcnt lgkmcnt(14)
    ds_read_b64_tr_b16 a[220:221], v209 offset:57344
    ds_read_b64_tr_b16 a[222:223], v209 offset:59392
    v_mfma_f32_16x16x32_bf16 v[68:71], a[228:231], v[164:167], v[68:71]
    s_waitcnt lgkmcnt(14)
    v_add_f32 v233, v233, v152
    v_add_f32 v233, v233, v153
    v_mfma_f32_16x16x32_bf16 v[72:75], a[232:235], v[164:167], v[72:75]
    s_waitcnt lgkmcnt(12)
    ds_read_b64_tr_b16 a[224:225], v210 offset:57344
    ds_read_b64_tr_b16 a[226:227], v210 offset:59392
    v_mfma_f32_16x16x32_bf16 v[76:79], a[236:239], v[164:167], v[76:79]
    s_waitcnt lgkmcnt(12)
    v_add_f32 v233, v233, v154
    v_add_f32 v233, v233, v155
    v_mfma_f32_16x16x32_bf16 v[80:83], a[240:243], v[164:167], v[80:83]
    s_waitcnt lgkmcnt(10)
    ds_read_b64_tr_b16 a[228:229], v211 offset:57344
    ds_read_b64_tr_b16 a[230:231], v211 offset:59392
    v_mfma_f32_16x16x32_bf16 v[84:87], a[244:247], v[164:167], v[84:87]
    s_waitcnt lgkmcnt(10)
    v_add_f32 v233, v233, v156
    v_add_f32 v233, v233, v157
    v_mfma_f32_16x16x32_bf16 v[88:91], a[248:251], v[164:167], v[88:91]
    s_waitcnt lgkmcnt(8)
    ds_read_b64_tr_b16 a[232:233], v208 offset:61440
    ds_read_b64_tr_b16 a[234:235], v208 offset:63488
    v_mfma_f32_16x16x32_bf16 v[92:95], a[252:255], v[164:167], v[92:95]
    s_waitcnt lgkmcnt(8)
    v_add_f32 v233, v233, v158
    v_add_f32 v233, v233, v159
    v_mfma_f32_32x32x16_bf16 v[0:15], a[216:219], v[144:147], v[0:15]
    s_waitcnt lgkmcnt(6)
    ds_read_b64_tr_b16 a[236:237], v209 offset:61440
    ds_read_b64_tr_b16 a[238:239], v209 offset:63488
    buffer_load_dwordx4 v229, s[16:19], s46 offen offset:3072 nt lds
    v_exp_f32 v125, v125
    v_add_f32 v232, v232, v118
    v_mfma_f32_32x32x16_bf16 v[16:31], a[220:223], v[144:147], v[16:31]
    s_waitcnt lgkmcnt(6)
    ds_read_b64_tr_b16 a[240:241], v210 offset:61440
    ds_read_b64_tr_b16 a[242:243], v210 offset:63488
    v_cvt_pk_bf16_f32 v150, v124, v125
    v_exp_f32 v126, v126
    v_add_f32 v232, v232, v119
    v_mfma_f32_32x32x16_bf16 v[32:47], a[224:227], v[144:147], v[32:47]
    s_waitcnt lgkmcnt(6)
    ds_read_b64_tr_b16 a[244:245], v211 offset:61440
    ds_read_b64_tr_b16 a[246:247], v211 offset:63488
    v_exp_f32 v127, v127
    v_add_f32 v232, v232, v120
    v_max3_f32 v234, v96, v97, v98
    v_mfma_f32_32x32x16_bf16 v[48:63], a[228:231], v[144:147], v[48:63]
    s_waitcnt lgkmcnt(6)
    ds_read_b128 a[248:251], v200 offset:8192
    v_cvt_pk_bf16_f32 v151, v126, v127
    v_add_f32 v232, v232, v121
    v_add_f32 v232, v232, v122
    v_max3_f32 v234, v234, v99, v100
    v_max3_f32 v234, v234, v101, v102
    v_mfma_f32_32x32x16_bf16 v[0:15], a[232:235], v[148:151], v[0:15]
    s_waitcnt lgkmcnt(5)
    ds_read_b128 a[252:255], v201 offset:8192
    v_add_f32 v232, v232, v123
    v_add_f32 v232, v232, v124
    v_max3_f32 v234, v234, v103, v104
    v_max3_f32 v234, v234, v105, v106
    v_mfma_f32_32x32x16_bf16 v[16:31], a[236:239], v[148:151], v[16:31]
    s_waitcnt lgkmcnt(4)
    ds_read_b128 a[216:219], v202 offset:8192
    v_add_f32 v232, v232, v125
    v_add_f32 v232, v232, v126
    v_max3_f32 v234, v234, v107, v108
    v_max3_f32 v234, v234, v109, v110
    v_mfma_f32_32x32x16_bf16 v[32:47], a[240:243], v[148:151], v[32:47]
    s_waitcnt lgkmcnt(3)
    ds_read_b128 a[220:223], v203 offset:8192
    v_add_f32 v232, v232, v127
    v_max_f32 v234, v234, v111
    v_cmp_lt_f32 vcc, 0x41000000, v234
    v_mfma_f32_32x32x16_bf16 v[48:63], a[244:247], v[148:151], v[48:63]
    s_waitcnt lgkmcnt(3)
    ds_read_b128 a[224:227], v204 offset:8192
    s_cbranch_vccnz L_rare9
L_back9:
    v_exp_f32 v96, v96
    v_exp_f32 v97, v97
    v_mfma_f32_32x32x16_bf16 v[112:127], a[248:251], v[168:171], v[128:143]
    s_waitcnt lgkmcnt(3)
    ds_read_b128 a[228:231], v205 offset:8192
    v_cvt_pk_bf16_f32 v144, v96, v97
    v_exp_f32 v98, v98
    v_exp_f32 v99, v99
    v_mfma_f32_32x32x16_bf16 v[112:127], a[252:255], v[172:175], v[112:127]
    s_waitcnt lgkmcnt(3)
    ds_read_b128 a[232:235], v206 offset:8192
    v_cvt_pk_bf16_f32 v145, v98, v99
    v_exp_f32 v100, v100
    v_exp_f32 v101, v101
    s_waitcnt vmcnt(9)
    s_barrier
L_ih4:
    s_add_u32 m0, s43, 49152
    s_add_u32 s45, s42, 114688
    v_mfma_f32_32x32x16_bf16 v[112:127], a[216:219], v[176:179], v[112:127]
    s_waitcnt lgkmcnt(3)
    ds_read_b128 a[236:239], v207 offset:8192
    buffer_load_dwordx4 v224, s[12:15], s45 offen nt lds
    v_cvt_pk_bf16_f32 v146, v100, v101
    v_exp_f32 v102, v102
    v_exp_f32 v103, v103
    v_and_b32 v238, 112, v244
    v_lshl_add_u32 v238, v238, 3, s44
    v_mfma_f32_32x32x16_bf16 v[112:127], a[220:223], v[180:183], v[112:127]
    s_waitcnt lgkmcnt(3)
    ds_read_b64_tr_b16 a[240:241], v208 offset:0
    ds_read_b64_tr_b16 a[242:243], v208 offset:2048
    v_cvt_pk_bf16_f32 v147, v102, v103
    v_exp_f32 v104, v104
    v_add_f32 v232, v232, v96
    v_add_u32 v238, L_ih6 - L_ibase, v238
    v_min_u32 v238, L_end - L_ibase - 64, v238
    v_mfma_f32_32x32x16_bf16 v[112:127], a[224:227], v[184:187], v[112:127]
    s_waitcnt lgkmcnt(4)
    ds_read_b64_tr_b16 a[244:245], v209 offset:0
    ds_read_b64_tr_b16 a[246:247], v209 offset:2048
    buffer_load_dwordx4 v225, s[12:15], s45 offen offset:1024 nt lds
    v_exp_f32 v105, v105
    v_add_f32 v232, v232, v97
    v_mfma_f32_32x32x16_bf16 v[112:127], a[228:231], v[188:191], v[112:127]
    s_waitcnt lgkmcnt(5)
    global_load_dword a64, v238, s[90:91]
    ds_read_b64_tr_b16 a[248:249], v210 offset:0
    ds_read_b64_tr_b16 a[250:251], v210 offset:2048
    v_cvt_pk_bf16_f32 v148, v104, v105
    v_exp_f32 v106, v106
    v_add_f32 v232, v232, v98
    v_mfma_f32_32x32x16_bf16 v[112:127], a[232:235], v[192:195], v[112:127]
    s_waitcnt lgkmcnt(6)
    ds_read_b64_tr_b16 a[252:253], v211 offset:0
    ds_read_b64_tr_b16 a[254:255], v211 offset:2048
    buffer_load_dwordx4 v226, s[12:15], s45 offen offset:2048 nt lds
    v_exp_f32 v107, v107
    v_add_f32 v232, v232, v99
    v_add_f32 v232, v232, v100
    v_mfma_f32_32x32x16_bf16 v[112:127], a[236:239], v[196:199], v[112:127]
    s_waitcnt lgkmcnt(6)
    ds_read_b64_tr_b16 a[216:217], v208 offset:4096
    ds_read_b64_tr_b16 a[218:219], v208 offset:6144
    v_cvt_pk_bf16_f32 v149, v106, v107
    v_exp_f32 v108, v108
    v_add_f32 v232, v232, v101
    v_mfma_f32_32x32x16_bf16 v[0:15], a[240:243], v[144:147], v[0:15]
    s_waitcnt lgkmcnt(6)
    ds_read_b64_tr_b16 a[220:221], v209 offset:4096
    ds_read_b64_tr_b16 a[222:223], v209 offset:6144
    buffer_load_dwordx4 v227, s[12:15], s45 offen offset:3072 nt lds
    v_exp_f32 v109, v109
    v_add_f32 v232, v232, v102
    v_mfma_f32_32x32x16_bf16 v[16:31], a[244:247], v[144:147], v[16:31]
    s_waitcnt lgkmcnt(6)
    ds_read_b64_tr_b16 a[224:225], v210 offset:4096
    ds_read_b64_tr_b16 a[226:227], v210 offset:6144
    v_cvt_pk_bf16_f32 v150, v108, v109
    v_exp_f32 v110, v110
    v_add_f32 v232, v232, v103
    v_mfma_f32_32x32x16_bf16 v[32:47], a[248:251], v[144:147], v[32:47]
    s_waitcnt lgkmcnt(6)
    ds_read_b64_tr_b16 a[228:229], v211 offset:4096
    ds_read_b64_tr_b16 a[230:231], v211 offset:6144
    v_exp_f32 v111, v111
    v_add_f32 v232, v232, v104
    v_max3_f32 v234, v112, v113, v114
    v_mfma_f32_32x32x16_bf16 v[48:63], a[252:255], v[144:147], v[48:63]
    s_waitcnt lgkmcnt(6)
    ds_read_b128 a[232:235], v200 offset:16384
    v_cvt_pk_bf16_f32 v151, v110, v111
    v_add_f32 v232, v232, v105
    v_add_f32 v232, v232, v106
    v_max3_f32 v234, v234, v115, v116
    v_max3_f32 v234, v234, v117, v118
    v_mfma_f32_32x32x16_bf16 v[0:15], a[216:219], v[148:151], v[0:15]
    s_waitcnt lgkmcnt(5)
    ds_read_b128 a[176:179], v254 offset:26624
    ds_read_b128 a[236:239], v201 offset:16384
    v_add_f32 v232, v232, v107
    v_add_f32 v232, v232, v108
    v_max3_f32 v234, v234, v119, v120
    v_max3_f32 v234, v234, v121, v122
    v_mfma_f32_32x32x16_bf16 v[16:31], a[220:223], v[148:151], v[16:31]
    s_waitcnt lgkmcnt(5)
    ds_read_b128 a[180:183], v254 offset:27648
    ds_read_b128 a[240:243], v202 offset:16384
    v_add_f32 v232, v232, v109
    v_add_f32 v232, v232, v110
    v_max3_f32 v234, v234, v123, v124
    v_max3_f32 v234, v234, v125, v126
    v_mfma_f32_32x32x16_bf16 v[32:47], a[224:227], v[148:151], v[32:47]
    s_waitcnt lgkmcnt(5)
    ds_read_b128 a[184:187], v254 offset:28672
    ds_read_b128 a[188:191], v254 offset:29696
    ds_read_b128 a[244:247], v203 offset:16384
    v_add_f32 v232, v232, v111
    v_max_f32 v234, v234, v127
    v_cmp_lt_f32 vcc, 0x41000000, v234
    v_mfma_f32_32x32x16_bf16 v[48:63], a[228:231], v[148:151], v[48:63]
    s_waitcnt lgkmcnt(7)
    ds_read_b128 a[248:251], v204 offset:16384
    s_cbranch_vccnz L_rare10
L_back10:
    v_exp_f32 v112, v112
    v_exp_f32 v113, v113
    v_mfma_f32_32x32x16_bf16 v[96:111], a[232:235], v[168:171], v[128:143]
    s_waitcnt lgkmcnt(6)
    ds_read_b128 a[252:255], v205 offset:16384
    v_cvt_pk_bf16_f32 v144, v112, v113
    v_exp_f32 v114, v114
    v_exp_f32 v115, v115
    v_mfma_f32_32x32x16_bf16 v[96:111], a[236:239], v[172:175], v[96:111]
    s_waitcnt lgkmcnt(5)
    ds_read_b128 a[216:219], v206 offset:16384
    s_add_u32 m0, s43, 98304
    s_add_u32 s46, s42, 98304
    v_cvt_pk_bf16_f32 v145, v114, v115
    v_exp_f32 v116, v116
    v_exp_f32 v117, v117
    v_mfma_f32_32x32x16_bf16 v[96:111], a[240:243], v[176:179], v[96:111]
    s_waitcnt lgkmcnt(3)
    ds_read_b128 a[220:223], v207 offset:16384
    buffer_load_dwordx4 v228, s[16:19], s46 offen nt lds
    v_cvt_pk_bf16_f32 v146, v116, v117
    v_exp_f32 v118, v118
    v_exp_f32 v119, v119
    v_mfma_f32_32x32x16_bf16 v[96:111], a[244:247], v[180:183], v[96:111]
    s_waitcnt lgkmcnt(3)
    ds_read_b64_tr_b16 a[224:225], v208 offset:8192
    ds_read_b64_tr_b16 a[226:227], v208 offset:10240
    v_cvt_pk_bf16_f32 v147, v118, v119
    v_exp_f32 v120, v120
    v_add_f32 v232, v232, v112
    v_mfma_f32_32x32x16_bf16 v[96:111], a[248:251], v[184:187], v[96:111]
    s_waitcnt lgkmcnt(4)
    ds_read_b64_tr_b16 a[228:229], v209 offset:8192
    ds_read_b64_tr_b16 a[230:231], v209 offset:10240
    buffer_load_dwordx4 v229, s[16:19], s46 offen offset:1024 nt lds
    v_exp_f32 v121, v121
    v_add_f32 v232, v232, v113
    v_mfma_f32_32x32x16_bf16 v[96:111], a[252:255], v[188:191], v[96:111]
    s_waitcnt lgkmcnt(5)
    ds_read_b64_tr_b16 a[232:233], v210 offset:8192
    ds_read_b64_tr_b16 a[234:235], v210 offset:10240
    v_cvt_pk_bf16_f32 v148, v120, v121
    v_exp_f32 v122, v122
    v_add_f32 v232, v232, v114
    v_mfma_f32_32x32x16_bf16 v[96:111], a[216:219], v[192:195], v[96:111]
    s_waitcnt lgkmcnt(6)
    ds_read_b64_tr_b16 a[236:237], v211 offset:8192
    ds_read_b64_tr_b16 a[238:239], v211 offset:10240
    buffer_load_dwordx4 v228, s[16:19], s46 offen offset:2048 nt lds
    v_exp_f32 v123, v123
    v_add_f32 v232, v232, v115
    v_add_f32 v232, v232, v116
    v_mfma_f32_32x32x16_bf16 v[96:111], a[220:223], v[196:199], v[96:111]
    s_waitcnt lgkmcnt(6)
    ds_read_b64_tr_b16 a[240:241], v208 offset:12288
    ds_read_b64_tr_b16 a[242:243], v208 offset:14336
    v_cvt_pk_bf16_f32 v149, v122, v123
    v_exp_f32 v124, v124
    v_add_f32 v232, v232, v117
    v_mfma_f32_32x32x16_bf16 v[0:15], a[224:227], v[144:147], v[0:15]
    s_waitcnt lgkmcnt(6)
    ds_read_b64_tr_b16 a[244:245], v209 offset:12288
    ds_read_b64_tr_b16 a[246:247], v209 offset:14336
    buffer_load_dwordx4 v229, s[16:19], s46 offen offset:3072 nt lds
    v_exp_f32 v125, v125
    v_add_f32 v232, v232, v118
    v_mfma_f32_32x32x16_bf16 v[16:31], a[228:231], v[144:147], v[16:31]
    s_waitcnt lgkmcnt(6)
    ds_read_b64_tr_b16 a[248:249], v210 offset:12288
    ds_read_b64_tr_b16 a[250:251], v210 offset:14336
    v_cvt_pk_bf16_f32 v150, v124, v125
    v_exp_f32 v126, v126
    v_add_f32 v232, v232, v119
    v_mfma_f32_32x32x16_bf16 v[32:47], a[232:235], v[144:147], v[32:47]
    s_waitcnt lgkmcnt(6)
    ds_read_b64_tr_b16 a[252:253], v211 offset:12288
    ds_read_b64_tr_b16 a[254:255], v211 offset:14336
    v_exp_f32 v127, v127
    v_add_f32 v232, v232, v120
    v_max3_f32 v234, v96, v97, v98
    v_mfma_f32_32x32x16_bf16 v[48:63], a[236:239], v[144:147], v[48:63]
    s_waitcnt lgkmcnt(6)
    ds_read_b128 a[216:219], v212 offset:0
    ds_read_b128 a[220:223], v213 offset:0
    v_cvt_pk_bf16_f32 v151, v126, v127
    v_add_f32 v232, v232, v121
    v_add_f32 v232, v232, v122
    v_max3_f32 v234, v234, v99, v100
    v_max3_f32 v234, v234, v101, v102
    v_mfma_f32_32x32x16_bf16 v[0:15], a[240:243], v[148:151], v[0:15]
    s_waitcnt lgkmcnt(6)
    ds_read_b128 a[224:227], v214 offset:0
    ds_read_b128 a[228:231], v215 offset:0
    v_add_f32 v232, v232, v123
    v_add_f32 v232, v232, v124
    v_max3_f32 v234, v234, v103, v104
    v_max3_f32 v234, v234, v105, v106
    v_mfma_f32_32x32x16_bf16 v[16:31], a[244:247], v[148:151], v[16:31]
    s_waitcnt lgkmcnt(6)
    ds_read_b128 a[232:235], v212 offset:4096
    ds_read_b128 a[236:239], v213 offset:4096
    v_add_f32 v232, v232, v125
    v_add_f32 v232, v232, v126
    v_max3_f32 v234, v234, v107, v108
    v_max3_f32 v234, v234, v109, v110
    v_mfma_f32_32x32x16_bf16 v[32:47], a[248:251], v[148:151], v[32:47]
    s_waitcnt lgkmcnt(6)
    ds_read_b128 a[240:243], v214 offset:4096
    ds_read_b128 a[244:247], v215 offset:4096
    v_add_f32 v232, v232, v127
    v_max_f32 v234, v234, v111
    v_cmp_lt_f32 vcc, 0x41000000, v234
    v_mfma_f32_32x32x16_bf16 v[48:63], a[252:255], v[148:151], v[48:63]
    s_waitcnt lgkmcnt(7)
    ds_read_b128 a[248:251], v200 offset:24576
    s_cbranch_vccnz L_rare11
L_back11:
    v_mfma_f32_16x16x32_bf16 v[152:155], a[216:219], a[200:203], v[160:163]
    s_waitcnt lgkmcnt(7)
    ds_read_b128 a[252:255], v201 offset:24576
    v_mfma_f32_16x16x32_bf16 v[152:155], a[220:223], a[204:207], v[152:155]
    s_waitcnt lgkmcnt(7)
    v_mfma_f32_16x16x32_bf16 v[152:155], a[224:227], a[208:211], v[152:155]
    s_waitcnt lgkmcnt(6)
    ds_read_b128 a[216:219], v202 offset:24576
    v_mfma_f32_16x16x32_bf16 v[152:155], a[228:231], a[212:215], v[152:155]
    s_waitcnt lgkmcnt(6)
    v_mfma_f32_16x16x32_bf16 v[156:159], a[232:235], a[200:203], v[160:163]
    s_waitcnt lgkmcnt(5)
    ds_read_b128 a[220:223], v203 offset:24576
    v_mfma_f32_16x16x32_bf16 v[156:159], a[236:239], a[204:207], v[156:159]
    s_waitcnt lgkmcnt(5)
    v_mfma_f32_16x16x32_bf16 v[156:159], a[240:243], a[208:211], v[156:159]
    s_waitcnt lgkmcnt(4)
    ds_read_b128 a[224:227], v204 offset:24576
    v_mfma_f32_16x16x32_bf16 v[156:159], a[244:247], a[212:215], v[156:159]
    s_waitcnt lgkmcnt(4)
    v_exp_f32 v96, v96
    v_exp_f32 v97, v97
    v_mfma_f32_32x32x16_bf16 v[112:127], a[248:251], v[168:171], v[128:143]
    s_waitcnt lgkmcnt(3)
    ds_read_b128 a[228:231], v205 offset:24576
    v_cvt_pk_bf16_f32 v144, v96, v97
    v_exp_f32 v98, v98
    v_exp_f32 v99, v99
    v_mfma_f32_32x32x16_bf16 v[112:127], a[252:255], v[172:175], v[112:127]
    s_waitcnt lgkmcnt(3)
    ds_read_b128 a[232:235], v206 offset:24576
    v_cvt_pk_bf16_f32 v145, v98, v99
    v_exp_f32 v100, v100
    v_exp_f32 v101, v101
    s_waitcnt vmcnt(9)
    s_barrier
L_ih5:
    s_add_u32 m0, s43, 0
    s_add_u32 s45, s52, 0
    v_mfma_f32_32x32x16_bf16 v[112:127], a[216:219], v[176:179], v[112:127]
    s_waitcnt lgkmcnt(3)
    ds_read_b128 a[236:239], v207 offset:24576
    buffer_load_dwordx4 v224, s[12:15], s45 offen nt lds
    v_cvt_pk_bf16_f32 v146, v100, v101
    v_exp_f32 v102, v102
    v_exp_f32 v103, v103
    v_and_b32 v238, 112, v244
    v_lshl_add_u32 v238, v238, 3, s44
    v_mfma_f32_32x32x16_bf16 v[112:127], a[220:223], v[180:183], v[112:127]
    s_waitcnt lgkmcnt(3)
    ds_read_b64_tr_b16 a[240:241], v208 offset:16384
    ds_read_b64_tr_b16 a[242:243], v208 offset:18432
    v_cvt_pk_bf16_f32 v147, v102, v103
    v_exp_f32 v104, v104
    v_add_f32 v232, v232, v96
    v_add_u32 v238, L_ih7 - L_ibase, v238
    v_min_u32 v238, L_end - L_ibase - 64, v238
    v_mfma_f32_32x32x16_bf16 v[112:127], a[224:227], v[184:187], v[112:127]
    s_waitcnt lgkmcnt(4)
    ds_read_b64_tr_b16 a[244:245], v209 offset:16384
    ds_read_b64_tr_b16 a[246:247], v209 offset:18432
    buffer_load_dwordx4 v225, s[12:15], s45 offen offset:1024 nt lds
    v_exp_f32 v105, v105
    v_add_f32 v232, v232, v97
    v_mfma_f32_32x32x16_bf16 v[112:127], a[228:231], v[188:191], v[112:127]
    s_waitcnt lgkmcnt(5)
    global_load_dword a140, v238, s[90:91]
    ds_read_b64_tr_b16 a[248:249], v210 offset:16384
    ds_read_b64_tr_b16 a[250:251], v210 offset:18432
    v_cvt_pk_bf16_f32 v148, v104, v105
    v_exp_f32 v106, v106
    v_add_f32 v232, v232, v98
    v_mfma_f32_32x32x16_bf16 v[112:127], a[232:235], v[192:195], v[112:127]
    s_waitcnt lgkmcnt(6)
    ds_read_b64_tr_b16 a[252:253], v211 offset:16384
    ds_read_b64_tr_b16 a[254:255], v211 offset:18432
    buffer_load_dwordx4 v226, s[12:15], s45 offen offset:2048 nt lds
    v_exp_f32 v107, v107
    v_add_f32 v232, v232, v99
    v_add_f32 v232, v232, v100
    v_mfma_f32_32x32x16_bf16 v[112:127], a[236:239], v[196:199], v[112:127]
    s_waitcnt lgkmcnt(6)
    ds_read_b64_tr_b16 a[216:217], v208 offset:20480
    ds_read_b64_tr_b16 a[218:219], v208 offset:22528
    v_cvt_pk_bf16_f32 v149, v106, v107
    v_exp_f32 v108, v108
    v_add_f32 v232, v232, v101
    v_max3_f32 v235, v152, v153, v154
    v_max3_f32 v235, v235, v155, v156
    v_max3_f32 v235, v235, v157, v158
    v_max_f32 v235, v235, v159
    v_cmp_lt_f32 vcc, 0x41000000, v235
    s_nop 1
    s_cbranch_vccnz L_rare12
L_back12:
    v_mfma_f32_32x32x16_bf16 v[0:15], a[240:243], v[144:147], v[0:15]
    s_waitcnt lgkmcnt(6)
    ds_read_b64_tr_b16 a[220:221], v209 offset:20480
    ds_read_b64_tr_b16 a[222:223], v209 offset:22528
    buffer_load_dwordx4 v227, s[12:15], s45 offen offset:3072 nt lds
    v_exp_f32 v109, v109
    v_add_f32 v232, v232, v102
    v_mfma_f32_32x32x16_bf16 v[16:31], a[244:247], v[144:147], v[16:31]
    s_waitcnt lgkmcnt(6)
    ds_read_b64_tr_b16 a[224:225], v210 offset:20480
    ds_read_b64_tr_b16 a[226:227], v210 offset:22528
    v_cvt_pk_bf16_f32 v150, v108, v109
    v_exp_f32 v110, v110
    v_add_f32 v232, v232, v103
    v_mfma_f32_32x32x16_bf16 v[32:47], a[248:251], v[144:147], v[32:47]
    s_waitcnt lgkmcnt(6)
    ds_read_b64_tr_b16 a[228:229], v211 offset:20480
    ds_read_b64_tr_b16 a[230:231], v211 offset:22528
    v_exp_f32 v111, v111
    v_add_f32 v232, v232, v104
    v_max3_f32 v234, v112, v113, v114
    v_mfma_f32_32x32x16_bf16 v[48:63], a[252:255], v[144:147], v[48:63]
    s_waitcnt lgkmcnt(6)
    ds_read_b128 a[232:235], v200 offset:32768
    v_cvt_pk_bf16_f32 v151, v110, v111
    v_add_f32 v232, v232, v105
    v_add_f32 v232, v232, v106
    v_max3_f32 v234, v234, v115, v116
    v_max3_f32 v234, v234, v117, v118
    v_mfma_f32_32x32x16_bf16 v[0:15], a[216:219], v[148:151], v[0:15]
    s_waitcnt lgkmcnt(5)
    ds_read_b128 a[236:239], v201 offset:32768
    v_add_f32 v232, v232, v107
    v_add_f32 v232, v232, v108
    v_max3_f32 v234, v234, v119, v120
    v_max3_f32 v234, v234, v121, v122
    v_mfma_f32_32x32x16_bf16 v[16:31], a[220:223], v[148:151], v[16:31]
    s_waitcnt lgkmcnt(4)
    ds_read_b128 a[240:243], v202 offset:32768
    v_add_f32 v232, v232, v109
    v_add_f32 v232, v232, v110
    v_max3_f32 v234, v234, v123, v124
    v_max3_f32 v234, v234, v125, v126
    v_mfma_f32_32x32x16_bf16 v[32:47], a[224:227], v[148:151], v[32:47]
    s_waitcnt lgkmcnt(3)
    ds_read_b128 a[244:247], v203 offset:32768
    v_add_f32 v232, v232, v111
    v_max_f32 v234, v234, v127
    v_cmp_lt_f32 vcc, 0x41000000, v234
    v_exp_f32 v152, v152
    v_mfma_f32_32x32x16_bf16 v[48:63], a[228:231], v[148:151], v[48:63]
    s_waitcnt lgkmcnt(3)
    ds_read_b128 a[248:251], v204 offset:32768
    v_exp_f32 v153, v153
    v_add_f32 v233, v233, v152
    v_exp_f32 v154, v154
    s_cbranch_vccnz L_rare13
L_back13:
    v_exp_f32 v112, v112
    v_exp_f32 v113, v113
    v_mfma_f32_32x32x16_bf16 v[96:111], a[232:235], v[168:171], v[128:143]
    s_waitcnt lgkmcnt(3)
    ds_read_b128 a[252:255], v205 offset:32768
    v_cvt_pk_bf16_f32 v144, v112, v113
    v_exp_f32 v114, v114
    v_exp_f32 v115, v115
    v_mfma_f32_32x32x16_bf16 v[96:111], a[236:239], v[172:175], v[96:111]
    s_waitcnt lgkmcnt(3)
    ds_read_b128 a[216:219], v206 offset:32768
    s_add_u32 m0, s43, 114688
    s_add_u32 s46, s42, 114688
    v_cvt_pk_bf16_f32 v145, v114, v115
    v_exp_f32 v116, v116
    v_exp_f32 v117, v117
    v_mfma_f32_32x32x16_bf16 v[96:111], a[240:243], v[176:179], v[96:111]
    s_waitcnt lgkmcnt(3)
    ds_read_b128 a[220:223], v207 offset:32768
    buffer_load_dwordx4 v228, s[16:19], s46 offen nt lds
    v_cvt_pk_bf16_f32 v146, v116, v117
    v_exp_f32 v118, v118
    v_exp_f32 v119, v119
    v_mfma_f32_32x32x16_bf16 v[96:111], a[244:247], v[180:183], v[96:111]
    s_waitcnt lgkmcnt(3)
    ds_read_b64_tr_b16 a[224:225], v216 offset:0
    ds_read_b64_tr_b16 a[226:227], v216 offset:4096
    ds_read_b64_tr_b16 a[228:229], v217 offset:0
    ds_read_b64_tr_b16 a[230:231], v217 offset:4096
    v_cvt_pk_bf16_f32 v147, v118, v119
    v_exp_f32 v120, v120
    v_add_f32 v232, v232, v112
    v_mfma_f32_32x32x16_bf16 v[96:111], a[248:251], v[184:187], v[96:111]
    s_waitcnt lgkmcnt(6)
    ds_read_b64_tr_b16 a[232:233], v218 offset:0
    ds_read_b64_tr_b16 a[234:235], v218 offset:4096
    ds_read_b64_tr_b16 a[236:237], v219 offset:0
    ds_read_b64_tr_b16 a[238:239], v219 offset:4096
    buffer_load_dwordx4 v229, s[16:19], s46 offen offset:1024 nt lds
    v_exp_f32 v121, v121
    v_add_f32 v232, v232, v113
    v_mfma_f32_32x32x16_bf16 v[96:111], a[252:255], v[188:191], v[96:111]
    s_waitcnt lgkmcnt(9)
    ds_read_b64_tr_b16 a[240:241], v220 offset:0
    ds_read_b64_tr_b16 a[242:243], v220 offset:4096
    ds_read_b64_tr_b16 a[244:245], v221 offset:0
    ds_read_b64_tr_b16 a[246:247], v221 offset:4096
    v_cvt_pk_bf16_f32 v148, v120, v121
    v_exp_f32 v122, v122
    v_add_f32 v232, v232, v114
    v_mfma_f32_32x32x16_bf16 v[96:111], a[216:219], v[192:195], v[96:111]
    s_waitcnt lgkmcnt(12)
    ds_read_b64_tr_b16 a[248:249], v222 offset:0
    ds_read_b64_tr_b16 a[250:251], v222 offset:4096
    ds_read_b64_tr_b16 a[252:253], v223 offset:0
    ds_read_b64_tr_b16 a[254:255], v223 offset:4096
    buffer_load_dwordx4 v228, s[16:19], s46 offen offset:2048 nt lds
    v_exp_f32 v123, v123
    v_add_f32 v232, v232, v115
    v_add_f32 v232, v232, v116
    v_exp_f32 v155, v155
    v_exp_f32 v156, v156
    v_exp_f32 v157, v157
    v_exp_f32 v158, v158
    v_exp_f32 v159, v159
    v_mfma_f32_32x32x16_bf16 v[96:111], a[220:223], v[196:199], v[96:111]
    s_waitcnt lgkmcnt(14)
    ds_read_b64_tr_b16 a[216:217], v208 offset:24576
    ds_read_b64_tr_b16 a[218:219], v208 offset:26624
    v_cvt_pk_bf16_f32 v149, v122, v123
    v_exp_f32 v124, v124
    v_add_f32 v232, v232, v117
    v_cvt_pk_bf16_f32 v164, v152, v153
    v_cvt_pk_bf16_f32 v165, v154, v155
    v_cvt_pk_bf16_f32 v166, v156, v157
    v_cvt_pk_bf16_f32 v167, v158, v159
    s_nop 1
    v_mfma_f32_16x16x32_bf16 v[64:67], a[224:227], v[164:167], v[64:67]
    s_waitcnt lgkmcnt(14)
    ds_read_b64_tr_b16 a[220:221], v209 offset:24576
    ds_read_b64_tr_b16 a[222:223], v209 offset:26624
    v_mfma_f32_16x16x32_bf16 v[68:71], a[228:231], v[164:167], v[68:71]
    s_waitcnt lgkmcnt(14)
    v_add_f32 v233, v233, v153
    v_add_f32 v233, v233, v154
    v_mfma_f32_16x16x32_bf16 v[72:75], a[232:235], v[164:167], v[72:75]
    s_waitcnt lgkmcnt(12)
    ds_read_b64_tr_b16 a[224:225], v210 offset:24576
    ds_read_b64_tr_b16 a[226:227], v210 offset:26624
    v_mfma_f32_16x16x32_bf16 v[76:79], a[236:239], v[164:167], v[76:79]
    s_waitcnt lgkmcnt(12)
    v_add_f32 v233, v233, v155
    v_add_f32 v233, v233, v156
    v_mfma_f32_16x16x32_bf16 v[80:83], a[240:243], v[164:167], v[80:83]
    s_waitcnt lgkmcnt(10)
    ds_read_b64_tr_b16 a[228:229], v211 offset:24576
    ds_read_b64_tr_b16 a[230:231], v211 offset:26624
    v_mfma_f32_16x16x32_bf16 v[84:87], a[244:247], v[164:167], v[84:87]
    s_waitcnt lgkmcnt(10)
    v_add_f32 v233, v233, v157
    v_add_f32 v233, v233, v158
    v_mfma_f32_16x16x32_bf16 v[88:91], a[248:251], v[164:167], v[88:91]
    s_waitcnt lgkmcnt(8)
    ds_read_b64_tr_b16 a[232:233], v208 offset:28672
    ds_read_b64_tr_b16 a[234:235], v208 offset:30720
    v_mfma_f32_16x16x32_bf16 v[92:95], a[252:255], v[164:167], v[92:95]
    s_waitcnt lgkmcnt(8)
    v_add_f32 v233, v233, v159
    v_mfma_f32_32x32x16_bf16 v[0:15], a[216:219], v[144:147], v[0:15]
    s_waitcnt lgkmcnt(6)
    ds_read_b64_tr_b16 a[236:237], v209 offset:28672
    ds_read_b64_tr_b16 a[238:239], v209 offset:30720
    buffer_load_dwordx4 v229, s[16:19], s46 offen offset:3072 nt lds
    s_load_dword s93, s[94:95], 0
    v_exp_f32 v125, v125
    v_add_f32 v232, v232, v118
    v_mfma_f32_32x32x16_bf16 v[16:31], a[220:223], v[144:147], v[16:31]
    s_waitcnt lgkmcnt(6)
    ds_read_b64_tr_b16 a[240:241], v210 offset:28672
    ds_read_b64_tr_b16 a[242:243], v210 offset:30720
    v_cvt_pk_bf16_f32 v150, v124, v125
    v_exp_f32 v126, v126
    v_add_f32 v232, v232, v119
    v_mfma_f32_32x32x16_bf16 v[32:47], a[224:227], v[144:147], v[32:47]
    s_waitcnt lgkmcnt(6)
    ds_read_b64_tr_b16 a[244:245], v211 offset:28672
    ds_read_b64_tr_b16 a[246:247], v211 offset:30720
    v_exp_f32 v127, v127
    v_add_f32 v232, v232, v120
    v_max3_f32 v234, v96, v97, v98
    v_mfma_f32_32x32x16_bf16 v[48:63], a[228:231], v[144:147], v[48:63]
    s_waitcnt lgkmcnt(6)
    ds_read_b128 a[248:251], v200 offset:40960
    v_cvt_pk_bf16_f32 v151, v126, v127
    v_add_f32 v232, v232, v121
    v_add_f32 v232, v232, v122
    v_max3_f32 v234, v234, v99, v100
    v_max3_f32 v234, v234, v101, v102
    v_mfma_f32_32x32x16_bf16 v[0:15], a[232:235], v[148:151], v[0:15]
    s_waitcnt lgkmcnt(5)
    ds_read_b128 a[252:255], v201 offset:40960
    v_add_f32 v232, v232, v123
    v_add_f32 v232, v232, v124
    v_max3_f32 v234, v234, v103, v104
    v_max3_f32 v234, v234, v105, v106
    v_mfma_f32_32x32x16_bf16 v[16:31], a[236:239], v[148:151], v[16:31]
    s_waitcnt lgkmcnt(4)
    ds_read_b128 a[216:219], v202 offset:40960
    v_add_f32 v232, v232, v125
    v_add_f32 v232, v232, v126
    v_max3_f32 v234, v234, v107, v108
    v_max3_f32 v234, v234, v109, v110
    v_mfma_f32_32x32x16_bf16 v[32:47], a[240:243], v[148:151], v[32:47]
    s_waitcnt lgkmcnt(3)
    ds_read_b128 a[220:223], v203 offset:40960
    v_add_f32 v232, v232, v127
    v_max_f32 v234, v234, v111
    v_cmp_lt_f32 vcc, 0x41000000, v234
    v_mfma_f32_32x32x16_bf16 v[48:63], a[244:247], v[148:151], v[48:63]
    s_waitcnt lgkmcnt(3)
    ds_read_b128 a[224:227], v204 offset:40960
    s_cbranch_vccnz L_rare14
L_back14:
    v_exp_f32 v96, v96
    v_exp_f32 v97, v97
    v_mfma_f32_32x32x16_bf16 v[112:127], a[248:251], v[168:171], v[128:143]
    s_waitcnt lgkmcnt(3)
    ds_read_b128 a[228:231], v205 offset:40960
    v_cvt_pk_bf16_f32 v144, v96, v97
    v_exp_f32 v98, v98
    v_exp_f32 v99, v99
    v_mfma_f32_32x32x16_bf16 v[112:127], a[252:255], v[172:175], v[112:127]
    s_waitcnt lgkmcnt(3)
    ds_read_b128 a[232:235], v206 offset:40960
    v_cvt_pk_bf16_f32 v145, v98, v99
    v_exp_f32 v100, v100
    v_exp_f32 v101, v101
    s_waitcnt vmcnt(9)
    s_barrier
L_ih6:
    s_add_u32 m0, s43, 16384
    s_add_u32 s45, s52, 16384
    v_mfma_f32_32x32x16_bf16 v[112:127], a[216:219], v[176:179], v[112:127]
    s_waitcnt lgkmcnt(3)
    ds_read_b128 a[236:239], v207 offset:40960
    buffer_load_dwordx4 v224, s[12:15], s45 offen nt lds
    v_cvt_pk_bf16_f32 v146, v100, v101
    v_exp_f32 v102, v102
    v_exp_f32 v103, v103
    v_and_b32 v238, 112, v244
    v_lshl_add_u32 v238, v238, 3, s44
    v_mfma_f32_32x32x16_bf16 v[112:127], a[220:223], v[180:183], v[112:127]
    s_waitcnt lgkmcnt(3)
    ds_read_b64_tr_b16 a[240:241], v208 offset:32768
    ds_read_b64_tr_b16 a[242:243], v208 offset:34816
    v_cvt_pk_bf16_f32 v147, v102, v103
    v_exp_f32 v104, v104
    v_add_f32 v232, v232, v96
    v_add_u32 v238, L_ih8 - L_ibase, v238
    v_min_u32 v238, L_end - L_ibase - 64, v238
    v_mfma_f32_32x32x16_bf16 v[112:127], a[224:227], v[184:187], v[112:127]
    s_waitcnt lgkmcnt(4)
    ds_read_b64_tr_b16 a[244:245], v209 offset:32768
    ds_read_b64_tr_b16 a[246:247], v209 offset:34816
    buffer_load_dwordx4 v225, s[12:15], s45 offen offset:1024 nt lds
    v_exp_f32 v105, v105
    v_add_f32 v232, v232, v97
    v_mfma_f32_32x32x16_bf16 v[112:127], a[228:231], v[188:191], v[112:127]
    s_waitcnt lgkmcnt(5)
    global_load_dword a140, v238, s[90:91]
    ds_read_b64_tr_b16 a[248:249], v210 offset:32768
    ds_read_b64_tr_b16 a[250:251], v210 offset:34816
    v_cvt_pk_bf16_f32 v148, v104, v105
    v_exp_f32 v106, v106
    v_add_f32 v232, v232, v98
    v_mfma_f32_32x32x16_bf16 v[112:127], a[232:235], v[192:195], v[112:127]
    s_waitcnt lgkmcnt(6)
    ds_read_b64_tr_b16 a[252:253], v211 offset:32768
    ds_read_b64_tr_b16 a[254:255], v211 offset:34816
    buffer_load_dwordx4 v226, s[12:15], s45 offen offset:2048 nt lds
    v_exp_f32 v107, v107
    v_add_f32 v232, v232, v99
    v_add_f32 v232, v232, v100
    v_mfma_f32_32x32x16_bf16 v[112:127], a[236:239], v[196:199], v[112:127]
    s_waitcnt lgkmcnt(6)
    ds_read_b64_tr_b16 a[216:217], v208 offset:36864
    ds_read_b64_tr_b16 a[218:219], v208 offset:38912
    v_cvt_pk_bf16_f32 v149, v106, v107
    v_exp_f32 v108, v108
    v_add_f32 v232, v232, v101
    v_mfma_f32_32x32x16_bf16 v[0:15], a[240:243], v[144:147], v[0:15]
    s_waitcnt lgkmcnt(6)
    ds_read_b64_tr_b16 a[220:221], v209 offset:36864
    ds_read_b64_tr_b16 a[222:223], v209 offset:38912
    buffer_load_dwordx4 v227, s[12:15], s45 offen offset:3072 nt lds
    v_exp_f32 v109, v109
    v_add_f32 v232, v232, v102
    v_mfma_f32_32x32x16_bf16 v[16:31], a[244:247], v[144:147], v[16:31]
    s_waitcnt lgkmcnt(6)
    ds_read_b64_tr_b16 a[224:225], v210 offset:36864
    ds_read_b64_tr_b16 a[226:227], v210 offset:38912
    v_cvt_pk_bf16_f32 v150, v108, v109
    v_exp_f32 v110, v110
    v_add_f32 v232, v232, v103
    v_mfma_f32_32x32x16_bf16 v[32:47], a[248:251], v[144:147], v[32:47]
    s_waitcnt lgkmcnt(6)
    ds_read_b64_tr_b16 a[228:229], v211 offset:36864
    ds_read_b64_tr_b16 a[230:231], v211 offset:38912
    v_exp_f32 v111, v111
    v_add_f32 v232, v232, v104
    v_max3_f32 v234, v112, v113, v114
    v_mfma_f32_32x32x16_bf16 v[48:63], a[252:255], v[144:147], v[48:63]
    s_waitcnt lgkmcnt(6)
    ds_read_b128 a[232:235], v200 offset:49152
    v_cvt_pk_bf16_f32 v151, v110, v111
    v_add_f32 v232, v232, v105
    v_add_f32 v232, v232, v106
    v_max3_f32 v234, v234, v115, v116
    v_max3_f32 v234, v234, v117, v118
    v_mfma_f32_32x32x16_bf16 v[0:15], a[216:219], v[148:151], v[0:15]
    s_waitcnt lgkmcnt(5)
    ds_read_b128 a[236:239], v201 offset:49152
    v_add_f32 v232, v232, v107
    v_add_f32 v232, v232, v108
    v_max3_f32 v234, v234, v119, v120
    v_max3_f32 v234, v234, v121, v122
    v_mfma_f32_32x32x16_bf16 v[16:31], a[220:223], v[148:151], v[16:31]
    s_waitcnt lgkmcnt(4)
    ds_read_b128 a[240:243], v202 offset:49152
    v_add_f32 v232, v232, v109
    v_add_f32 v232, v232, v110
    v_max3_f32 v234, v234, v123, v124
    v_max3_f32 v234, v234, v125, v126
    v_mfma_f32_32x32x16_bf16 v[32:47], a[224:227], v[148:151], v[32:47]
    s_waitcnt lgkmcnt(3)
    ds_read_b128 a[244:247], v203 offset:49152
    v_add_f32 v232, v232, v111
    v_max_f32 v234, v234, v127
    v_cmp_lt_f32 vcc, 0x41000000, v234
    v_mfma_f32_32x32x16_bf16 v[48:63], a[228:231], v[148:151], v[48:63]
    s_waitcnt lgkmcnt(3)
    ds_read_b128 a[248:251], v204 offset:49152
    s_cbranch_vccnz L_rare15
L_back15:
    v_exp_f32 v112, v112
    v_exp_f32 v113, v113
    v_mfma_f32_32x32x16_bf16 v[96:111], a[232:235], v[168:171], v[128:143]
    s_waitcnt lgkmcnt(3)
    ds_read_b128 a[252:255], v205 offset:49152
    v_cvt_pk_bf16_f32 v144, v112, v113
    v_exp_f32 v114, v114
    v_exp_f32 v115, v115
    v_mfma_f32_32x32x16_bf16 v[96:111], a[236:239], v[172:175], v[96:111]
    s_waitcnt lgkmcnt(3)
    ds_read_b128 a[216:219], v206 offset:49152
    s_add_u32 m0, s43, 65536
    s_add_u32 s46, s52, 0
    v_cvt_pk_bf16_f32 v145, v114, v115
    v_exp_f32 v116, v116
    v_exp_f32 v117, v117
    v_mfma_f32_32x32x16_bf16 v[96:111], a[240:243], v[176:179], v[96:111]
    s_waitcnt lgkmcnt(3)
    ds_read_b128 a[220:223], v207 offset:49152
    buffer_load_dwordx4 v228, s[16:19], s46 offen nt lds
    v_cvt_pk_bf16_f32 v146, v116, v117
    v_exp_f32 v118, v118
    v_exp_f32 v119, v119
    v_mfma_f32_32x32x16_bf16 v[96:111], a[244:247], v[180:183], v[96:111]
    s_waitcnt lgkmcnt(3)
    ds_read_b64_tr_b16 a[224:225], v208 offset:40960
    ds_read_b64_tr_b16 a[226:227], v208 offset:43008
    v_cvt_pk_bf16_f32 v147, v118, v119
    v_exp_f32 v120, v120
    v_add_f32 v232, v232, v112
    v_mfma_f32_32x32x16_bf16 v[96:111], a[248:251], v[184:187], v[96:111]
    s_waitcnt lgkmcnt(4)
    ds_read_b64_tr_b16 a[228:229], v209 offset:40960
    ds_read_b64_tr_b16 a[230:231], v209 offset:43008
    buffer_load_dwordx4 v229, s[16:19], s46 offen offset:1024 nt lds
    v_exp_f32 v121, v121
    v_add_f32 v232, v232, v113
    v_mfma_f32_32x32x16_bf16 v[96:111], a[252:255], v[188:191], v[96:111]
    s_waitcnt lgkmcnt(5)
    ds_read_b64_tr_b16 a[232:233], v210 offset:40960
    ds_read_b64_tr_b16 a[234:235], v210 offset:43008
    v_cvt_pk_bf16_f32 v148, v120, v121
    v_exp_f32 v122, v122
    v_add_f32 v232, v232, v114
    v_mfma_f32_32x32x16_bf16 v[96:111], a[216:219], v[192:195], v[96:111]
    s_waitcnt lgkmcnt(6)
    ds_read_b64_tr_b16 a[236:237], v211 offset:40960
    ds_read_b64_tr_b16 a[238:239], v211 offset:43008
    buffer_load_dwordx4 v228, s[16:19], s46 offen offset:2048 nt lds
    v_exp_f32 v123, v123
    v_add_f32 v232, v232, v115
    v_add_f32 v232, v232, v116
    v_mfma_f32_32x32x16_bf16 v[96:111], a[220:223], v[196:199], v[96:111]
    s_waitcnt lgkmcnt(6)
    ds_read_b64_tr_b16 a[240:241], v208 offset:45056
    ds_read_b64_tr_b16 a[242:243], v208 offset:47104
    v_cvt_pk_bf16_f32 v149, v122, v123
    v_exp_f32 v124, v124
    v_add_f32 v232, v232, v117
    v_mfma_f32_32x32x16_bf16 v[0:15], a[224:227], v[144:147], v[0:15]
    s_waitcnt lgkmcnt(6)
    ds_read_b64_tr_b16 a[244:245], v209 offset:45056
    ds_read_b64_tr_b16 a[246:247], v209 offset:47104
    buffer_load_dwordx4 v229, s[16:19], s46 offen offset:3072 nt lds
    v_exp_f32 v125, v125
    v_add_f32 v232, v232, v118
    v_mfma_f32_32x32x16_bf16 v[16:31], a[228:231], v[144:147], v[16:31]
    s_waitcnt lgkmcnt(6)
    ds_read_b64_tr_b16 a[248:249], v210 offset:45056
    ds_read_b64_tr_b16 a[250:251], v210 offset:47104
    v_cvt_pk_bf16_f32 v150, v124, v125
    v_exp_f32 v126, v126
    v_add_f32 v232, v232, v119
    v_mfma_f32_32x32x16_bf16 v[32:47], a[232:235], v[144:147], v[32:47]
    s_waitcnt lgkmcnt(6)
    ds_read_b64_tr_b16 a[252:253], v211 offset:45056
    ds_read_b64_tr_b16 a[254:255], v211 offset:47104
    v_exp_f32 v127, v127
    v_add_f32 v232, v232, v120
    v_max3_f32 v234, v96, v97, v98
    v_mfma_f32_32x32x16_bf16 v[48:63], a[236:239], v[144:147], v[48:63]
    s_waitcnt lgkmcnt(6)
    ds_read_b128 a[216:219], v212 offset:32768
    v_cvt_pk_bf16_f32 v151, v126, v127
    v_add_f32 v232, v232, v121
    v_add_f32 v232, v232, v122
    v_max3_f32 v234, v234, v99, v100
    v_max3_f32 v234, v234, v101, v102
    v_mfma_f32_32x32x16_bf16 v[0:15], a[240:243], v[148:151], v[0:15]
    s_waitcnt lgkmcnt(5)
    ds_read_b128 a[220:223], v213 offset:32768
    ds_read_b128 a[224:227], v214 offset:32768
    v_add_f32 v232, v232, v123
    v_add_f32 v232, v232, v124
    v_max3_f32 v234, v234, v103, v104
    v_max3_f32 v234, v234, v105, v106
    v_mfma_f32_32x32x16_bf16 v[16:31], a[244:247], v[148:151], v[16:31]
    s_waitcnt lgkmcnt(5)
    ds_read_b128 a[228:231], v215 offset:32768
    ds_read_b128 a[232:235], v212 offset:36864
    v_add_f32 v232, v232, v125
    v_add_f32 v232, v232, v126
    v_max3_f32 v234, v234, v107, v108
    v_max3_f32 v234, v234, v109, v110
    v_mfma_f32_32x32x16_bf16 v[32:47], a[248:251], v[148:151], v[32:47]
    s_waitcnt lgkmcnt(5)
    ds_read_b128 a[236:239], v213 offset:36864
    ds_read_b128 a[240:243], v214 offset:36864
    v_add_f32 v232, v232, v127
    v_max_f32 v234, v234, v111
    v_cmp_lt_f32 vcc, 0x41000000, v234
    v_mfma_f32_32x32x16_bf16 v[48:63], a[252:255], v[148:151], v[48:63]
    ds_read_b128 a[244:247], v215 offset:36864
    ds_read_b128 a[248:251], v200 offset:57344
    s_waitcnt lgkmcnt(0)
    s_waitcnt lgkmcnt(8)
    s_cmp_eq_u32 s93, 0
    s_cbranch_scc1 L_poll0
L_pback0:
    v_mov_b32 v255, s93
    s_cbranch_vccnz L_rare16
L_back16:
    v_mfma_f32_16x16x32_bf16 v[152:155], a[216:219], a[200:203], v[160:163]
    s_waitcnt lgkmcnt(7)
    ds_read_b128 a[252:255], v201 offset:57344
    v_mfma_f32_16x16x32_bf16 v[152:155], a[220:223], a[204:207], v[152:155]
    s_waitcnt lgkmcnt(7)
    v_mfma_f32_16x16x32_bf16 v[152:155], a[224:227], a[208:211], v[152:155]
    s_waitcnt lgkmcnt(6)
    ds_read_b128 a[216:219], v202 offset:57344
    v_mfma_f32_16x16x32_bf16 v[152:155], a[228:231], a[212:215], v[152:155]
    s_waitcnt lgkmcnt(6)
    v_mfma_f32_16x16x32_bf16 v[156:159], a[232:235], a[200:203], v[160:163]
    s_waitcnt lgkmcnt(5)
    ds_read_b128 a[220:223], v203 offset:57344
    v_mfma_f32_16x16x32_bf16 v[156:159], a[236:239], a[204:207], v[156:159]
    s_waitcnt lgkmcnt(5)
    v_mfma_f32_16x16x32_bf16 v[156:159], a[240:243], a[208:211], v[156:159]
    s_waitcnt lgkmcnt(4)
    ds_read_b128 a[224:227], v204 offset:57344
    v_mfma_f32_16x16x32_bf16 v[156:159], a[244:247], a[212:215], v[156:159]
    s_waitcnt lgkmcnt(4)
    v_exp_f32 v96, v96
    v_exp_f32 v97, v97
    v_mfma_f32_32x32x16_bf16 v[112:127], a[248:251], v[168:171], v[128:143]
    s_waitcnt lgkmcnt(3)
    ds_read_b128 a[228:231], v205 offset:57344
    v_cvt_pk_bf16_f32 v144, v96, v97
    v_exp_f32 v98, v98
    v_exp_f32 v99, v99
    v_mfma_f32_32x32x16_bf16 v[112:127], a[252:255], v[172:175], v[112:127]
    s_waitcnt lgkmcnt(3)
    ds_read_b128 a[232:235], v206 offset:57344
    v_cvt_pk_bf16_f32 v145, v98, v99
    v_exp_f32 v100, v100
    v_exp_f32 v101, v101
    s_waitcnt vmcnt(9)
    s_barrier
L_ih7:
    s_add_u32 m0, s43, 32768
    s_add_u32 s45, s52, 32768
    v_mfma_f32_32x32x16_bf16 v[112:127], a[216:219], v[176:179], v[112:127]
    s_waitcnt lgkmcnt(3)
    ds_read_b128 a[236:239], v207 offset:57344
    buffer_load_dwordx4 v224, s[12:15], s45 offen nt lds
    v_cvt_pk_bf16_f32 v146, v100, v101
    v_exp_f32 v102, v102
    v_exp_f32 v103, v103
    v_and_b32 v238, 112, v244
    v_lshl_add_u32 v238, v238, 3, s44
    v_mfma_f32_32x32x16_bf16 v[112:127], a[220:223], v[180:183], v[112:127]
    s_waitcnt lgkmcnt(3)
    ds_read_b64_tr_b16 a[240:241], v208 offset:49152
    ds_read_b64_tr_b16 a[242:243], v208 offset:51200
    v_cvt_pk_bf16_f32 v147, v102, v103
    v_exp_f32 v104, v104
    v_add_f32 v232, v232, v96
    v_add_u32 v238, L_ih9 - L_ibase, v238
    v_min_u32 v238, L_end - L_ibase - 64, v238
    v_mfma_f32_32x32x16_bf16 v[112:127], a[224:227], v[184:187], v[112:127]
    s_waitcnt lgkmcnt(4)
    ds_read_b64_tr_b16 a[244:245], v209 offset:49152
    ds_read_b64_tr_b16 a[246:247], v209 offset:51200
    buffer_load_dwordx4 v225, s[12:15], s45 offen offset:1024 nt lds
    v_exp_f32 v105, v105
    v_add_f32 v232, v232, v97
    v_mfma_f32_32x32x16_bf16 v[112:127], a[228:231], v[188:191], v[112:127]
    s_waitcnt lgkmcnt(5)
    global_load_dword a140, v238, s[90:91]
    ds_read_b64_tr_b16 a[248:249], v210 offset:49152
    ds_read_b64_tr_b16 a[250:251], v210 offset:51200
    v_cvt_pk_bf16_f32 v148, v104, v105
    v_exp_f32 v106, v106
    v_add_f32 v232, v232, v98
    v_mfma_f32_32x32x16_bf16 v[112:127], a[232:235], v[192:195], v[112:127]
    s_waitcnt lgkmcnt(6)
    ds_read_b64_tr_b16 a[252:253], v211 offset:49152
    ds_read_b64_tr_b16 a[254:255], v211 offset:51200
    buffer_load_dwordx4 v226, s[12:15], s45 offen offset:2048 nt lds
    v_exp_f32 v107, v107
    v_add_f32 v232, v232, v99
    v_add_f32 v232, v232, v100
    v_mfma_f32_32x32x16_bf16 v[112:127], a[236:239], v[196:199], v[112:127]
    s_waitcnt lgkmcnt(6)
    ds_read_b64_tr_b16 a[216:217], v208 offset:53248
    ds_read_b64_tr_b16 a[218:219], v208 offset:55296
    v_cvt_pk_bf16_f32 v149, v106, v107
    v_exp_f32 v108, v108
    v_add_f32 v232, v232, v101
    v_max3_f32 v235, v152, v153, v154
    v_max3_f32 v235, v235, v155, v156
    v_max3_f32 v235, v235, v157, v158
    v_max_f32 v235, v235, v159
    v_cmp_lt_f32 vcc, 0x41000000, v235
    s_nop 1
    s_cbranch_vccnz L_rare17
L_back17:
    v_mfma_f32_32x32x16_bf16 v[0:15], a[240:243], v[144:147], v[0:15]
    s_waitcnt lgkmcnt(6)
    ds_read_b64_tr_b16 a[220:221], v209 offset:53248
    ds_read_b64_tr_b16 a[222:223], v209 offset:55296
    buffer_load_dwordx4 v227, s[12:15], s45 offen offset:3072 nt lds
    v_exp_f32 v109, v109
    v_add_f32 v232, v232, v102
    v_mfma_f32_32x32x16_bf16 v[16:31], a[244:247], v[144:147], v[16:31]
    s_waitcnt lgkmcnt(6)
    ds_read_b64_tr_b16 a[224:225], v210 offset:53248
    ds_read_b64_tr_b16 a[226:227], v210 offset:55296
    v_cvt_pk_bf16_f32 v150, v108, v109
    v_exp_f32 v110, v110
    v_add_f32 v232, v232, v103
    v_mfma_f32_32x32x16_bf16 v[32:47], a[248:251], v[144:147], v[32:47]
    s_waitcnt lgkmcnt(6)
    ds_read_b64_tr_b16 a[228:229], v211 offset:53248
    ds_read_b64_tr_b16 a[230:231], v211 offset:55296
    v_exp_f32 v111, v111
    v_add_f32 v232, v232, v104
    v_max3_f32 v234, v112, v113, v114
    v_mfma_f32_32x32x16_bf16 v[48:63], a[252:255], v[144:147], v[48:63]
    s_waitcnt lgkmcnt(6)
    ds_read_b128 a[232:235], v200 offset:0
    v_cvt_pk_bf16_f32 v151, v110, v111
    v_add_f32 v232, v232, v105
    v_add_f32 v232, v232, v106
    v_max3_f32 v234, v234, v115, v116
    v_max3_f32 v234, v234, v117, v118
    v_mfma_f32_32x32x16_bf16 v[0:15], a[216:219], v[148:151], v[0:15]
    s_waitcnt lgkmcnt(5)
    ds_read_b128 a[236:239], v201 offset:0
    v_add_f32 v232, v232, v107
    v_add_f32 v232, v232, v108
    v_max3_f32 v234, v234, v119, v120
    v_max3_f32 v234, v234, v121, v122
    v_mfma_f32_32x32x16_bf16 v[16:31], a[220:223], v[148:151], v[16:31]
    s_waitcnt lgkmcnt(4)
    ds_read_b128 a[240:243], v202 offset:0
    v_add_f32 v232, v232, v109
    v_add_f32 v232, v232, v110
    v_max3_f32 v234, v234, v123, v124
    v_max3_f32 v234, v234, v125, v126
    v_mfma_f32_32x32x16_bf16 v[32:47], a[224:227], v[148:151], v[32:47]
    s_waitcnt lgkmcnt(3)
    ds_read_b128 a[244:247], v203 offset:0
    v_add_f32 v232, v232, v111
    v_max_f32 v234, v234, v127
    v_cmp_lt_f32 vcc, 0x41000000, v234
    v_exp_f32 v152, v152
    v_mfma_f32_32x32x16_bf16 v[48:63], a[228:231], v[148:151], v[48:63]
    s_waitcnt lgkmcnt(3)
    ds_read_b128 a[248:251], v204 offset:0
    v_exp_f32 v153, v153
    v_add_f32 v233, v233, v152
    v_exp_f32 v154, v154
    s_cbranch_vccnz L_rare18
L_back18:
    v_exp_f32 v112, v112
    v_exp_f32 v113, v113
    v_mfma_f32_32x32x16_bf16 v[96:111], a[232:235], a[96:99], 0
    s_waitcnt lgkmcnt(3)
    ds_read_b128 a[252:255], v205 offset:0
    v_cvt_pk_bf16_f32 v144, v112, v113
    v_exp_f32 v114, v114
    v_exp_f32 v115, v115
    v_mfma_f32_32x32x16_bf16 v[96:111], a[236:239], a[100:103], v[96:111]
    s_waitcnt lgkmcnt(3)
    ds_read_b128 a[216:219], v206 offset:0
    s_add_u32 m0, s43, 81920
    s_add_u32 s46, s52, 16384
    v_cvt_pk_bf16_f32 v145, v114, v115
    v_exp_f32 v116, v116
    v_exp_f32 v117, v117
    v_mfma_f32_32x32x16_bf16 v[96:111], a[240:243], a[104:107], v[96:111]
    s_waitcnt lgkmcnt(3)
    ds_read_b128 a[220:223], v207 offset:0
    buffer_load_dwordx4 v228, s[16:19], s46 offen nt lds
    v_cvt_pk_bf16_f32 v146, v116, v117
    v_exp_f32 v118, v118
    v_exp_f32 v119, v119
    v_mfma_f32_32x32x16_bf16 v[96:111], a[244:247], a[108:111], v[96:111]
    s_waitcnt lgkmcnt(3)
    ds_read_b64_tr_b16 a[224:225], v216 offset:32768
    ds_read_b64_tr_b16 a[226:227], v216 offset:36864
    ds_read_b64_tr_b16 a[228:229], v217 offset:32768
    ds_read_b64_tr_b16 a[230:231], v217 offset:36864
    v_cvt_pk_bf16_f32 v147, v118, v119
    v_exp_f32 v120, v120
    v_add_f32 v232, v232, v112
    v_mfma_f32_32x32x16_bf16 v[96:111], a[248:251], a[112:115], v[96:111]
    s_waitcnt lgkmcnt(6)
    ds_read_b64_tr_b16 a[232:233], v218 offset:32768
    ds_read_b64_tr_b16 a[234:235], v218 offset:36864
    ds_read_b64_tr_b16 a[236:237], v219 offset:32768
    ds_read_b64_tr_b16 a[238:239], v219 offset:36864
    buffer_load_dwordx4 v229, s[16:19], s46 offen offset:1024 nt lds
    v_exp_f32 v121, v121
    v_add_f32 v232, v232, v113
    v_mfma_f32_32x32x16_bf16 v[96:111], a[252:255], a[116:119], v[96:111]
    s_waitcnt lgkmcnt(9)
    ds_read_b64_tr_b16 a[240:241], v220 offset:32768
    ds_read_b64_tr_b16 a[242:243], v220 offset:36864
    ds_read_b64_tr_b16 a[244:245], v221 offset:32768
    ds_read_b64_tr_b16 a[246:247], v221 offset:36864
    v_cvt_pk_bf16_f32 v148, v120, v121
    v_exp_f32 v122, v122
    v_add_f32 v232, v232, v114
    v_mfma_f32_32x32x16_bf16 v[96:111], a[216:219], a[120:123], v[96:111]
    s_waitcnt lgkmcnt(12)
    ds_read_b64_tr_b16 a[248:249], v222 offset:32768
    ds_read_b64_tr_b16 a[250:251], v222 offset:36864
    ds_read_b64_tr_b16 a[252:253], v223 offset:32768
    ds_read_b64_tr_b16 a[254:255], v223 offset:36864
    buffer_load_dwordx4 v228, s[16:19], s46 offen offset:2048 nt lds
    v_exp_f32 v123, v123
    v_add_f32 v232, v232, v115
    v_add_f32 v232, v232, v116
    v_exp_f32 v155, v155
    v_exp_f32 v156, v156
    v_exp_f32 v157, v157
    v_exp_f32 v158, v158
    v_exp_f32 v159, v159
    v_mfma_f32_32x32x16_bf16 v[96:111], a[220:223], a[124:127], v[96:111]
    s_waitcnt lgkmcnt(14)
    ds_read_b64_tr_b16 a[216:217], v208 offset:57344
    ds_read_b64_tr_b16 a[218:219], v208 offset:59392
    v_cvt_pk_bf16_f32 v149, v122, v123
    v_exp_f32 v124, v124
    v_add_f32 v232, v232, v117
    v_cvt_pk_bf16_f32 v164, v152, v153
    v_cvt_pk_bf16_f32 v165, v154, v155
    v_cvt_pk_bf16_f32 v166, v156, v157
    v_cvt_pk_bf16_f32 v167, v158, v159
    s_nop 1
    v_mfma_f32_16x16x32_bf16 v[64:67], a[224:227], v[164:167], v[64:67]
    s_waitcnt lgkmcnt(14)
    ds_read_b64_tr_b16 a[220:221], v209 offset:57344
    ds_read_b64_tr_b16 a[222:223], v209 offset:59392
    v_mfma_f32_16x16x32_bf16 v[68:71], a[228:231], v[164:167], v[68:71]
    s_waitcnt lgkmcnt(14)
    v_add_f32 v233, v233, v153
    v_add_f32 v233, v233, v154
    v_mfma_f32_16x16x32_bf16 v[72:75], a[232:235], v[164:167], v[72:75]
    s_waitcnt lgkmcnt(12)
    ds_read_b64_tr_b16 a[224:225], v210 offset:57344
    ds_read_b64_tr_b16 a[226:227], v210 offset:59392
    v_mfma_f32_16x16x32_bf16 v[76:79], a[236:239], v[164:167], v[76:79]
    s_waitcnt lgkmcnt(12)
    v_add_f32 v233, v233, v155
    v_add_f32 v233, v233, v156
    v_mfma_f32_16x16x32_bf16 v[80:83], a[240:243], v[164:167], v[80:83]
    s_waitcnt lgkmcnt(10)
    ds_read_b64_tr_b16 a[228:229], v211 offset:57344
    ds_read_b64_tr_b16 a[230:231], v211 offset:59392
    v_mfma_f32_16x16x32_bf16 v[84:87], a[244:247], v[164:167], v[84:87]
    s_waitcnt lgkmcnt(10)
    v_add_f32 v233, v233, v157
    v_add_f32 v233, v233, v158
    v_mfma_f32_16x16x32_bf16 v[88:91], a[248:251], v[164:167], v[88:91]
    s_waitcnt lgkmcnt(8)
    ds_read_b64_tr_b16 a[232:233], v208 offset:61440
    ds_read_b64_tr_b16 a[234:235], v208 offset:63488
    v_mfma_f32_16x16x32_bf16 v[92:95], a[252:255], v[164:167], v[92:95]
    s_waitcnt lgkmcnt(8)
    v_add_f32 v233, v233, v159
    v_mov_b32 v238, v233
    v_mfma_f32_32x32x16_bf16 v[0:15], a[216:219], v[144:147], v[0:15]
    s_waitcnt lgkmcnt(6)
    ds_read_b64_tr_b16 a[236:237], v209 offset:61440
    ds_read_b64_tr_b16 a[238:239], v209 offset:63488
    buffer_load_dwordx4 v229, s[16:19], s46 offen offset:3072 nt lds
    v_exp_f32 v125, v125
    v_add_f32 v232, v232, v118
    v_mfma_f32_32x32x16_bf16 v[16:31], a[220:223], v[144:147], v[16:31]
    s_waitcnt lgkmcnt(6)
    ds_read_b64_tr_b16 a[240:241], v210 offset:61440
    ds_read_b64_tr_b16 a[242:243], v210 offset:63488
    v_cvt_pk_bf16_f32 v150, v124, v125
    v_exp_f32 v126, v126
    v_add_f32 v232, v232, v119
    v_mfma_f32_32x32x16_bf16 v[32:47], a[224:227], v[144:147], v[32:47]
    s_waitcnt lgkmcnt(6)
    ds_read_b64_tr_b16 a[244:245], v211 offset:61440
    ds_read_b64_tr_b16 a[246:247], v211 offset:63488
    v_exp_f32 v127, v127
    v_add_f32 v232, v232, v120
    v_permlane16_swap_b32 v238, v233
    v_mfma_f32_32x32x16_bf16 v[48:63], a[228:231], v[144:147], v[48:63]
    s_waitcnt lgkmcnt(6)
    ds_read_b128 a[208:211], v200 offset:8192
    v_cvt_pk_bf16_f32 v151, v126, v127
    v_add_f32 v232, v232, v121
    v_add_f32 v232, v232, v122
    v_add_f32 v233, v238, v233
    v_mov_b32 v238, v233
    v_mfma_f32_32x32x16_bf16 v[0:15], a[232:235], v[148:151], v[0:15]
    s_waitcnt lgkmcnt(5)
    ds_read_b128 a[212:215], v201 offset:8192
    v_add_f32 v232, v232, v123
    v_add_f32 v232, v232, v124
    v_permlane32_swap_b32 v238, v233
    v_add_f32 v161, v238, v233
    v_mov_b32 v160, v160
    v_mfma_f32_32x32x16_bf16 v[16:31], a[236:239], v[148:151], v[16:31]
    s_waitcnt lgkmcnt(4)
    ds_read_b128 a[216:219], v202 offset:8192
    v_add_f32 v232, v232, v125
    v_add_f32 v232, v232, v126
    v_and_b32 v242, 240, v244
    v_lshrrev_b32 v242, 1, v242
    v_add_u32 v242, 155648, v242
    v_mfma_f32_32x32x16_bf16 v[32:47], a[240:243], v[148:151], v[32:47]
    s_waitcnt lgkmcnt(3)
    s_mul_i32 s77, s36, 6144
    ds_read_b128 a[220:223], v203 offset:8192
    v_add_f32 v232, v232, v127
    v_lshrrev_b32 v240, 5, s43
    v_add_u32 v240, v240, v242
    v_add_u32 v241, s77, v244
    v_mfma_f32_32x32x16_bf16 v[48:63], a[244:247], v[148:151], v[48:63]
    s_waitcnt lgkmcnt(3)
    ds_write_b64 v240, v[160:161] offset:0
    ds_read_b128 a[224:227], v204 offset:8192
    v_mov_b32 v236, v232
    v_add_u32 v241, 131072, v241
    v_max3_f32 v234, v96, v97, v98
    v_max3_f32 v234, v234, v99, v100
    v_mfma_f32_32x32x16_bf16 v[112:127], a[208:211], a[96:99], 0
    s_waitcnt lgkmcnt(4)
    ds_write_b128 v241, v[72:75] offset:0
    ds_write_b128 v241, v[76:79] offset:1024
    ds_write_b128 v241, v[80:83] offset:2048
    ds_write_b128 v241, v[84:87] offset:3072
    ds_write_b128 v241, v[88:91] offset:4096
    ds_read_b128 a[228:231], v205 offset:8192
    v_mfma_f32_32x32x16_bf16 v[112:127], a[212:215], a[100:103], v[112:127]
    s_waitcnt lgkmcnt(9)
    ds_write_b128 v241, v[92:95] offset:5120
    ds_read_b128 a[232:235], v206 offset:8192
    v_permlane32_swap_b32 v236, v232
    v_add_f32 v243, v236, v232
    v_max3_f32 v234, v234, v101, v102
    v_max3_f32 v234, v234, v103, v104
    s_waitcnt vmcnt(9) lgkmcnt(1)
    s_barrier
L_ih8:
    s_add_u32 m0, s43, 49152
    s_add_u32 s45, s52, 49152
    v_mfma_f32_32x32x16_bf16 v[112:127], a[216:219], a[104:107], v[112:127]
    ds_read_b128 a[236:239], v207 offset:8192
    buffer_load_dwordx4 v224, s[12:15], s45 offen nt lds
    v_max3_f32 v234, v234, v105, v106
    v_max3_f32 v234, v234, v107, v108
    v_and_b32 v238, 112, v244
    v_lshl_add_u32 v238, v238, 3, s44
    v_mfma_f32_32x32x16_bf16 v[112:127], a[220:223], a[108:111], v[112:127]
    ds_read_b64_tr_b16 a[240:241], v208 offset:0
    ds_read_b64_tr_b16 a[242:243], v208 offset:2048
    v_max3_f32 v234, v234, v109, v110
    v_max_f32 v234, v234, v111
    v_add_u32 v238, L_ih10 - L_ibase, v238
    v_min_u32 v238, L_end - L_ibase - 64, v238
    v_mfma_f32_32x32x16_bf16 v[112:127], a[224:227], a[112:115], v[112:127]
    ds_read_b64_tr_b16 a[244:245], v209 offset:0
    ds_read_b64_tr_b16 a[246:247], v209 offset:2048
    buffer_load_dwordx4 v225, s[12:15], s45 offen offset:1024 nt lds
    v_rcp_f32 v243, v243
    v_mov_b32 v236, v234
    v_mfma_f32_32x32x16_bf16 v[112:127], a[228:231], a[116:119], v[112:127]
    s_waitcnt lgkmcnt(5)
    global_load_dword a140, v238, s[90:91]
    ds_read_b64_tr_b16 a[248:249], v210 offset:0
    ds_read_b64_tr_b16 a[250:251], v210 offset:2048
    v_permlane32_swap_b32 v236, v234
    v_max_f32 v234, v236, v234
    v_sub_f32 v96, v96, v234
    v_exp_f32 v96, v96
    v_mfma_f32_32x32x16_bf16 v[112:127], a[232:235], a[120:123], v[112:127]
    s_waitcnt lgkmcnt(6)
    ds_read_b64_tr_b16 a[252:253], v211 offset:0
    ds_read_b64_tr_b16 a[254:255], v211 offset:2048
    buffer_load_dwordx4 v226, s[12:15], s45 offen offset:2048 nt lds
    v_sub_f32 v97, v97, v234
    v_exp_f32 v97, v97
    v_sub_f32 v98, v98, v234
    v_exp_f32 v98, v98
    v_sub_f32 v99, v99, v234
    v_exp_f32 v99, v99
    v_sub_f32 v100, v100, v234
    v_exp_f32 v100, v100
    v_sub_f32 v101, v101, v234
    v_exp_f32 v101, v101
    v_sub_f32 v102, v102, v234
    v_exp_f32 v102, v102
    v_sub_f32 v103, v103, v234
    v_exp_f32 v103, v103
    v_mfma_f32_32x32x16_bf16 v[112:127], a[236:239], a[124:127], v[112:127]
    s_waitcnt lgkmcnt(6)
    ds_read_b64_tr_b16 a[208:209], v208 offset:4096
    ds_read_b64_tr_b16 a[210:211], v208 offset:6144
    v_cvt_pk_bf16_f32 v144, v96, v97
    v_cvt_pk_bf16_f32 v145, v98, v99
    v_cvt_pk_bf16_f32 v146, v100, v101
    v_cvt_pk_bf16_f32 v147, v102, v103
    v_mul_f32 v0, v243, v0
    v_mul_f32 v1, v243, v1
    v_cvt_pk_bf16_f32 v0, v0, v1
    v_accvgpr_write_b32 a0, v0
    v_mul_f32 v2, v243, v2
    v_mul_f32 v3, v243, v3
    v_cvt_pk_bf16_f32 v1, v2, v3
    v_accvgpr_write_b32 a1, v1
    v_mul_f32 v4, v243, v4
    v_mul_f32 v5, v243, v5
    v_cvt_pk_bf16_f32 v2, v4, v5
    v_accvgpr_write_b32 a2, v2
    v_mul_f32 v6, v243, v6
    v_mul_f32 v7, v243, v7
    v_cvt_pk_bf16_f32 v3, v6, v7
    v_accvgpr_write_b32 a3, v3
    v_mul_f32 v8, v243, v8
    v_mul_f32 v9, v243, v9
    v_cvt_pk_bf16_f32 v4, v8, v9
    v_accvgpr_write_b32 a4, v4
    v_mul_f32 v10, v243, v10
    v_mul_f32 v11, v243, v11
    v_cvt_pk_bf16_f32 v5, v10, v11
    v_accvgpr_write_b32 a5, v5
    v_mul_f32 v12, v243, v12
    v_mul_f32 v13, v243, v13
    v_cvt_pk_bf16_f32 v6, v12, v13
    v_accvgpr_write_b32 a6, v6
    v_mul_f32 v14, v243, v14
    v_mul_f32 v15, v243, v15
    v_cvt_pk_bf16_f32 v7, v14, v15
    v_accvgpr_write_b32 a7, v7
    v_mfma_f32_32x32x16_bf16 v[0:15], a[240:243], v[144:147], 0
    s_waitcnt lgkmcnt(6)
    ds_read_b64_tr_b16 a[212:213], v209 offset:4096
    ds_read_b64_tr_b16 a[214:215], v209 offset:6144
    buffer_load_dwordx4 v227, s[12:15], s45 offen offset:3072 nt lds
    v_mul_f32 v16, v243, v16
    v_mul_f32 v17, v243, v17
    v_cvt_pk_bf16_f32 v16, v16, v17
    v_accvgpr_write_b32 a8, v16
    v_mul_f32 v18, v243, v18
    v_mul_f32 v19, v243, v19
    v_cvt_pk_bf16_f32 v17, v18, v19
    v_accvgpr_write_b32 a9, v17
    v_mul_f32 v20, v243, v20
    v_mul_f32 v21, v243, v21
    v_cvt_pk_bf16_f32 v18, v20, v21
    v_accvgpr_write_b32 a10, v18
    v_mul_f32 v22, v243, v22
    v_mul_f32 v23, v243, v23
    v_cvt_pk_bf16_f32 v19, v22, v23
    v_accvgpr_write_b32 a11, v19
    v_mul_f32 v24, v243, v24
    v_mul_f32 v25, v243, v25
    v_cvt_pk_bf16_f32 v20, v24, v25
    v_accvgpr_write_b32 a12, v20
    v_mul_f32 v26, v243, v26
    v_mul_f32 v27, v243, v27
    v_cvt_pk_bf16_f32 v21, v26, v27
    v_accvgpr_write_b32 a13, v21
    v_mul_f32 v28, v243, v28
    v_mul_f32 v29, v243, v29
    v_cvt_pk_bf16_f32 v22, v28, v29
    v_accvgpr_write_b32 a14, v22
    v_mul_f32 v30, v243, v30
    v_mul_f32 v31, v243, v31
    v_cvt_pk_bf16_f32 v23, v30, v31
    v_accvgpr_write_b32 a15, v23
    v_mfma_f32_32x32x16_bf16 v[16:31], a[244:247], v[144:147], 0
    s_waitcnt lgkmcnt(6)
    ds_read_b64_tr_b16 a[216:217], v210 offset:4096
    ds_read_b64_tr_b16 a[218:219], v210 offset:6144
    v_sub_f32 v112, v112, v234
    v_sub_f32 v113, v113, v234
    v_sub_f32 v114, v114, v234
    v_sub_f32 v115, v115, v234
    v_mul_f32 v32, v243, v32
    v_mul_f32 v33, v243, v33
    v_cvt_pk_bf16_f32 v32, v32, v33
    v_accvgpr_write_b32 a16, v32
    v_mul_f32 v34, v243, v34
    v_mul_f32 v35, v243, v35
    v_cvt_pk_bf16_f32 v33, v34, v35
    v_accvgpr_write_b32 a17, v33
    v_mul_f32 v36, v243, v36
    v_mul_f32 v37, v243, v37
    v_cvt_pk_bf16_f32 v34, v36, v37
    v_accvgpr_write_b32 a18, v34
    v_mul_f32 v38, v243, v38
    v_mul_f32 v39, v243, v39
    v_cvt_pk_bf16_f32 v35, v38, v39
    v_accvgpr_write_b32 a19, v35
    v_mul_f32 v40, v243, v40
    v_mul_f32 v41, v243, v41
    v_cvt_pk_bf16_f32 v36, v40, v41
    v_accvgpr_write_b32 a20, v36
    v_mul_f32 v42, v243, v42
    v_mul_f32 v43, v243, v43
    v_cvt_pk_bf16_f32 v37, v42, v43
    v_accvgpr_write_b32 a21, v37
    v_mul_f32 v44, v243, v44
    v_mul_f32 v45, v243, v45
    v_cvt_pk_bf16_f32 v38, v44, v45
    v_accvgpr_write_b32 a22, v38
    v_mul_f32 v46, v243, v46
    v_mul_f32 v47, v243, v47
    v_cvt_pk_bf16_f32 v39, v46, v47
    v_accvgpr_write_b32 a23, v39
    v_mfma_f32_32x32x16_bf16 v[32:47], a[248:251], v[144:147], 0
    s_waitcnt lgkmcnt(6)
    ds_read_b64_tr_b16 a[220:221], v211 offset:4096
    ds_read_b64_tr_b16 a[222:223], v211 offset:6144
    v_sub_f32 v116, v116, v234
    v_sub_f32 v117, v117, v234
    v_sub_f32 v118, v118, v234
    v_sub_f32 v119, v119, v234
    v_mul_f32 v48, v243, v48
    v_mul_f32 v49, v243, v49
    v_cvt_pk_bf16_f32 v48, v48, v49
    v_accvgpr_write_b32 a24, v48
    v_mul_f32 v50, v243, v50
    v_mul_f32 v51, v243, v51
    v_cvt_pk_bf16_f32 v49, v50, v51
    v_accvgpr_write_b32 a25, v49
    v_mul_f32 v52, v243, v52
    v_mul_f32 v53, v243, v53
    v_cvt_pk_bf16_f32 v50, v52, v53
    v_accvgpr_write_b32 a26, v50
    v_mul_f32 v54, v243, v54
    v_mul_f32 v55, v243, v55
    v_cvt_pk_bf16_f32 v51, v54, v55
    v_accvgpr_write_b32 a27, v51
    v_mul_f32 v56, v243, v56
    v_mul_f32 v57, v243, v57
    v_cvt_pk_bf16_f32 v52, v56, v57
    v_accvgpr_write_b32 a28, v52
    v_mul_f32 v58, v243, v58
    v_mul_f32 v59, v243, v59
    v_cvt_pk_bf16_f32 v53, v58, v59
    v_accvgpr_write_b32 a29, v53
    v_mul_f32 v60, v243, v60
    v_mul_f32 v61, v243, v61
    v_cvt_pk_bf16_f32 v54, v60, v61
    v_accvgpr_write_b32 a30, v54
    v_mul_f32 v62, v243, v62
    v_mul_f32 v63, v243, v63
    v_cvt_pk_bf16_f32 v55, v62, v63
    v_accvgpr_write_b32 a31, v55
    v_sub_f32 v104, v104, v234
    v_exp_f32 v104, v104
    v_sub_f32 v105, v105, v234
    v_exp_f32 v105, v105
    v_sub_f32 v106, v106, v234
    v_exp_f32 v106, v106
    v_sub_f32 v107, v107, v234
    v_exp_f32 v107, v107
    v_sub_f32 v108, v108, v234
    v_exp_f32 v108, v108
    v_sub_f32 v109, v109, v234
    v_exp_f32 v109, v109
    v_sub_f32 v110, v110, v234
    v_exp_f32 v110, v110
    v_sub_f32 v111, v111, v234
    v_exp_f32 v111, v111
    v_mfma_f32_32x32x16_bf16 v[48:63], a[252:255], v[144:147], 0
    s_waitcnt lgkmcnt(6)
    ds_read_b128 a[224:227], v200 offset:16384
    v_cvt_pk_bf16_f32 v148, v104, v105
    v_cvt_pk_bf16_f32 v149, v106, v107
    v_cvt_pk_bf16_f32 v150, v108, v109
    v_cvt_pk_bf16_f32 v151, v110, v111
    v_sub_f32 v120, v120, v234
    v_sub_f32 v121, v121, v234
    v_sub_f32 v122, v122, v234
    v_sub_f32 v123, v123, v234
    v_mfma_f32_32x32x16_bf16 v[0:15], a[208:211], v[148:151], v[0:15]
    s_waitcnt lgkmcnt(5)
    ds_read_b128 a[228:231], v201 offset:16384
    v_sub_f32 v124, v124, v234
    v_sub_f32 v125, v125, v234
    v_sub_f32 v126, v126, v234
    v_sub_f32 v127, v127, v234
    v_sub_f32 v128, 0, v234
    v_mfma_f32_32x32x16_bf16 v[16:31], a[212:215], v[148:151], v[16:31]
    s_waitcnt lgkmcnt(4)
    ds_read_b128 a[232:235], v202 offset:16384
    v_sub_f32 v129, 0, v234
    v_sub_f32 v130, 0, v234
    v_sub_f32 v131, 0, v234
    v_sub_f32 v132, 0, v234
    v_sub_f32 v133, 0, v234
    v_mfma_f32_32x32x16_bf16 v[32:47], a[216:219], v[148:151], v[32:47]
    s_waitcnt lgkmcnt(3)
    ds_read_b128 a[236:239], v203 offset:16384
    v_sub_f32 v134, 0, v234
    v_sub_f32 v135, 0, v234
    v_sub_f32 v136, 0, v234
    v_sub_f32 v137, 0, v234
    v_sub_f32 v138, 0, v234
    v_mfma_f32_32x32x16_bf16 v[48:63], a[220:223], v[148:151], v[48:63]
    s_waitcnt lgkmcnt(3)
    ds_read_b128 a[240:243], v204 offset:16384
    v_sub_f32 v139, 0, v234
    v_sub_f32 v140, 0, v234
    v_sub_f32 v141, 0, v234
    v_sub_f32 v142, 0, v234
    v_sub_f32 v143, 0, v234
    v_max3_f32 v234, v112, v113, v114
    v_max3_f32 v234, v234, v115, v116
    v_max3_f32 v234, v234, v117, v118
    v_max3_f32 v234, v234, v119, v120
    v_max3_f32 v234, v234, v121, v122
    v_max3_f32 v234, v234, v123, v124
    v_max3_f32 v234, v234, v125, v126
    v_max_f32 v234, v234, v127
    v_cmp_lt_f32 vcc, 0x41000000, v234
    v_mov_b32 v232, 0
    v_add_f32 v232, v232, v96
    v_add_f32 v232, v232, v97
    v_add_f32 v232, v232, v98
    v_add_f32 v232, v232, v99
    v_add_f32 v232, v232, v100
    v_add_f32 v232, v232, v101
    v_add_f32 v232, v232, v102
    v_add_f32 v232, v232, v103
    v_add_f32 v232, v232, v104
    v_add_f32 v232, v232, v105
    v_add_f32 v232, v232, v106
    v_add_f32 v232, v232, v107
    v_add_f32 v232, v232, v108
    v_add_f32 v232, v232, v109
    v_add_f32 v232, v232, v110
    v_add_f32 v232, v232, v111
    s_cbranch_vccnz L_rare19
L_back19:
    v_exp_f32 v112, v112
    v_exp_f32 v113, v113
    v_mfma_f32_32x32x16_bf16 v[96:111], a[224:227], a[96:99], v[128:143]
    s_waitcnt lgkmcnt(3)
    ds_read_b128 a[244:247], v205 offset:16384
    v_cvt_pk_bf16_f32 v144, v112, v113
    v_exp_f32 v114, v114
    v_exp_f32 v115, v115
    v_mfma_f32_32x32x16_bf16 v[96:111], a[228:231], a[100:103], v[96:111]
    s_waitcnt lgkmcnt(3)
    ds_read_b128 a[248:251], v206 offset:16384
    s_add_u32 m0, s43, 98304
    s_add_u32 s46, s52, 32768
    v_cvt_pk_bf16_f32 v145, v114, v115
    v_exp_f32 v116, v116
    v_exp_f32 v117, v117
    v_mfma_f32_32x32x16_bf16 v[96:111], a[232:235], a[104:107], v[96:111]
    s_waitcnt lgkmcnt(3)
    ds_read_b128 a[252:255], v207 offset:16384
    buffer_load_dwordx4 v228, s[16:19], s46 offen nt lds
    v_cvt_pk_bf16_f32 v146, v116, v117
    v_exp_f32 v118, v118
    v_exp_f32 v119, v119
    v_mfma_f32_32x32x16_bf16 v[96:111], a[236:239], a[108:111], v[96:111]
    s_waitcnt lgkmcnt(3)
    ds_read_b64_tr_b16 a[208:209], v208 offset:8192
    ds_read_b64_tr_b16 a[210:211], v208 offset:10240
    v_cvt_pk_bf16_f32 v147, v118, v119
    v_exp_f32 v120, v120
    v_add_f32 v232, v232, v112
    v_mfma_f32_32x32x16_bf16 v[96:111], a[240:243], a[112:115], v[96:111]
    s_waitcnt lgkmcnt(4)
    ds_read_b64_tr_b16 a[212:213], v209 offset:8192
    ds_read_b64_tr_b16 a[214:215], v209 offset:10240
    buffer_load_dwordx4 v229, s[16:19], s46 offen offset:1024 nt lds
    v_exp_f32 v121, v121
    v_add_f32 v232, v232, v113
    v_mfma_f32_32x32x16_bf16 v[96:111], a[244:247], a[116:119], v[96:111]
    s_waitcnt lgkmcnt(5)
    ds_read_b64_tr_b16 a[216:217], v210 offset:8192
    ds_read_b64_tr_b16 a[218:219], v210 offset:10240
    v_cvt_pk_bf16_f32 v148, v120, v121
    v_exp_f32 v122, v122
    v_add_f32 v232, v232, v114
    v_mfma_f32_32x32x16_bf16 v[96:111], a[248:251], a[120:123], v[96:111]
    s_waitcnt lgkmcnt(6)
    s_add_u32 s77, s36, 0
    s_and_b32 s77, s77, 3
    s_lshl_b32 s74, s77, 7
    ds_read_b64_tr_b16 a[220:221], v211 offset:8192
    ds_read_b64_tr_b16 a[222:223], v211 offset:10240
    buffer_load_dwordx4 v228, s[16:19], s46 offen offset:2048 nt lds
    v_exp_f32 v123, v123
    v_add_f32 v232, v232, v115
    v_add_f32 v232, v232, v116
    v_add_u32 v166, s74, v242
    v_mfma_f32_32x32x16_bf16 v[96:111], a[252:255], a[124:127], v[96:111]
    s_waitcnt lgkmcnt(6)
    ds_read_b64 v[152:153], v166 offset:0
    s_add_u32 s77, s36, 1
    s_and_b32 s77, s77, 3
    s_lshl_b32 s74, s77, 7
    ds_read_b64_tr_b16 a[224:225], v208 offset:12288
    ds_read_b64_tr_b16 a[226:227], v208 offset:14336
    v_cvt_pk_bf16_f32 v149, v122, v123
    v_exp_f32 v124, v124
    v_add_f32 v232, v232, v117
    v_add_u32 v166, s74, v242
    v_mfma_f32_32x32x16_bf16 v[0:15], a[208:211], v[144:147], v[0:15]
    s_waitcnt lgkmcnt(7)
    ds_read_b64 v[154:155], v166 offset:0
    s_mul_i32 s74, s77, 6144
    ds_read_b64_tr_b16 a[228:229], v209 offset:12288
    ds_read_b64_tr_b16 a[230:231], v209 offset:14336
    buffer_load_dwordx4 v229, s[16:19], s46 offen offset:3072 nt lds
    v_exp_f32 v125, v125
    v_add_f32 v232, v232, v118
    v_add_u32 v167, s74, v244
    v_mfma_f32_32x32x16_bf16 v[16:31], a[212:215], v[144:147], v[16:31]
    s_waitcnt lgkmcnt(8)
    s_add_u32 s77, s36, 2
    s_and_b32 s77, s77, 3
    s_lshl_b32 s74, s77, 7
    ds_read_b64_tr_b16 a[232:233], v210 offset:12288
    ds_read_b64_tr_b16 a[234:235], v210 offset:14336
    v_cvt_pk_bf16_f32 v150, v124, v125
    v_exp_f32 v126, v126
    v_add_f32 v232, v232, v119
    v_add_u32 v167, 131072, v167
    v_add_u32 v166, s74, v242
    v_mfma_f32_32x32x16_bf16 v[32:47], a[216:219], v[144:147], v[32:47]
    s_waitcnt lgkmcnt(8)
    ds_read_b128 v[72:75], v167 offset:4096
    ds_read_b128 v[76:79], v167 offset:5120
    ds_read_b64 v[156:157], v166 offset:0
    s_mul_i32 s74, s77, 6144
    ds_read_b64_tr_b16 a[236:237], v211 offset:12288
    ds_read_b64_tr_b16 a[238:239], v211 offset:14336
    v_exp_f32 v127, v127
    v_add_f32 v232, v232, v120
    v_max3_f32 v234, v96, v97, v98
    v_add_u32 v167, s74, v244
    v_mfma_f32_32x32x16_bf16 v[48:63], a[220:223], v[144:147], v[48:63]
    s_waitcnt lgkmcnt(10)
    s_add_u32 s77, s36, 3
    s_and_b32 s77, s77, 3
    s_lshl_b32 s74, s77, 7
    ds_read_b128 a[240:243], v212 offset:0
    ds_read_b128 a[244:247], v213 offset:0
    v_cvt_pk_bf16_f32 v151, v126, v127
    v_add_f32 v232, v232, v121
    v_add_f32 v232, v232, v122
    v_max3_f32 v234, v234, v99, v100
    v_max3_f32 v234, v234, v101, v102
    v_add_u32 v166, s74, v242
    v_mfma_f32_32x32x16_bf16 v[0:15], a[224:227], v[148:151], v[0:15]
    s_waitcnt lgkmcnt(9)
    ds_read_b64 v[158:159], v166 offset:0
    ds_read_b128 a[248:251], v214 offset:0
    ds_read_b128 a[252:255], v215 offset:0
    v_add_f32 v232, v232, v123
    v_add_f32 v232, v232, v124
    v_max3_f32 v234, v234, v103, v104
    v_max3_f32 v234, v234, v105, v106
    v_mfma_f32_32x32x16_bf16 v[16:31], a[228:231], v[148:151], v[16:31]
    s_waitcnt lgkmcnt(10)
    ds_read_b128 a[208:211], v212 offset:4096
    ds_read_b128 a[212:215], v213 offset:4096
    v_add_f32 v232, v232, v125
    v_add_f32 v232, v232, v126
    v_max3_f32 v234, v234, v107, v108
    v_max3_f32 v234, v234, v109, v110
    v_mfma_f32_32x32x16_bf16 v[32:47], a[232:235], v[148:151], v[32:47]
    s_waitcnt lgkmcnt(4)
    ds_read_b128 a[216:219], v214 offset:4096
    ds_read_b128 a[220:223], v215 offset:4096
    v_add_f32 v232, v232, v127
    v_max_f32 v234, v234, v111
    v_cmp_lt_f32 vcc, 0x41000000, v234
    v_min_f32 v160, v152, v154
    v_min3_f32 v160, v160, v156, v158
    v_sub_f32 v152, v160, v152
    v_exp_f32 v152, v152
    v_sub_f32 v154, v160, v154
    v_exp_f32 v154, v154
    v_sub_f32 v156, v160, v156
    v_exp_f32 v156, v156
    v_sub_f32 v158, v160, v158
    v_exp_f32 v158, v158
    v_mfma_f32_32x32x16_bf16 v[48:63], a[236:239], v[148:151], v[48:63]
    ds_read_b128 a[224:227], v200 offset:24576
    v_add_u32 v167, 131072, v167
    v_mul_f32 v161, v152, v153
    v_fma_f32 v161, v154, v155, v161
    v_fma_f32 v161, v156, v157, v161
    v_fma_f32 v161, v158, v159, v161
    v_rcp_f32 v161, v161
    s_cbranch_vccnz L_rare20
L_back20:
    v_mul_f32 v152, v152, v161
    v_mul_f32 v154, v154, v161
    v_mul_f32 v64, v152, v64
    v_fma_f32 v64, v154, v72, v64
    v_mul_f32 v65, v152, v65
    v_fma_f32 v65, v154, v73, v65
    v_mul_f32 v66, v152, v66
    v_fma_f32 v66, v154, v74, v66
    v_mul_f32 v67, v152, v67
    v_fma_f32 v67, v154, v75, v67
    v_mul_f32 v68, v152, v68
    v_fma_f32 v68, v154, v76, v68
    v_mul_f32 v69, v152, v69
    v_fma_f32 v69, v154, v77, v69
    v_mul_f32 v70, v152, v70
    v_fma_f32 v70, v154, v78, v70
    v_mul_f32 v71, v152, v71
    v_fma_f32 v71, v154, v79, v71
    v_mfma_f32_16x16x32_bf16 v[152:155], a[240:243], a[176:179], 0
    ds_read_b128 v[80:83], v167 offset:2048
    ds_read_b128 v[84:87], v167 offset:3072
    s_mul_i32 s74, s77, 6144
    ds_read_b128 a[228:231], v201 offset:24576
    v_add_u32 v167, s74, v244
    v_add_u32 v167, 131072, v167
    v_mfma_f32_16x16x32_bf16 v[152:155], a[244:247], a[180:183], v[152:155]
    s_waitcnt lgkmcnt(9)
    ds_read_b128 v[88:91], v167 offset:0
    ds_read_b128 v[92:95], v167 offset:1024
    v_mfma_f32_16x16x32_bf16 v[152:155], a[248:251], a[184:187], v[152:155]
    s_waitcnt lgkmcnt(10)
    ds_read_b128 a[232:235], v202 offset:24576
    v_mul_f32 v156, v156, v161
    v_mfma_f32_16x16x32_bf16 v[152:155], a[252:255], a[188:191], v[152:155]
    s_waitcnt lgkmcnt(1)
    v_mul_f32 v158, v158, v161
    v_fma_f32 v64, v156, v80, v64
    v_fma_f32 v64, v158, v88, v64
    v_fma_f32 v65, v156, v81, v65
    v_fma_f32 v65, v158, v89, v65
    v_fma_f32 v66, v156, v82, v66
    v_fma_f32 v66, v158, v90, v66
    v_fma_f32 v67, v156, v83, v67
    v_fma_f32 v67, v158, v91, v67
    v_fma_f32 v68, v156, v84, v68
    v_fma_f32 v68, v158, v92, v68
    v_fma_f32 v69, v156, v85, v69
    v_fma_f32 v69, v158, v93, v69
    v_fma_f32 v70, v156, v86, v70
    v_fma_f32 v70, v158, v94, v70
    v_fma_f32 v71, v156, v87, v71
    v_fma_f32 v71, v158, v95, v71
    v_mfma_f32_16x16x32_bf16 v[156:159], a[208:211], a[176:179], 0
    ds_read_b128 a[236:239], v203 offset:24576
    v_cvt_pk_bf16_f32 v162, v64, v65
    v_mfma_f32_16x16x32_bf16 v[156:159], a[212:215], a[180:183], v[156:159]
    v_cvt_pk_bf16_f32 v163, v66, v67
    v_cvt_pk_bf16_f32 v164, v68, v69
    v_mfma_f32_16x16x32_bf16 v[156:159], a[216:219], a[184:187], v[156:159]
    ds_read_b128 a[240:243], v204 offset:24576
    v_cvt_pk_bf16_f32 v165, v70, v71
    v_mfma_f32_16x16x32_bf16 v[156:159], a[220:223], a[188:191], v[156:159]
    v_exp_f32 v96, v96
    v_exp_f32 v97, v97
    v_mfma_f32_32x32x16_bf16 v[112:127], a[224:227], a[96:99], v[128:143]
    ds_read_b128 a[244:247], v205 offset:24576
    v_cvt_pk_bf16_f32 v144, v96, v97
    v_exp_f32 v98, v98
    v_exp_f32 v99, v99
    v_mfma_f32_32x32x16_bf16 v[112:127], a[228:231], a[100:103], v[112:127]
    s_waitcnt lgkmcnt(3)
    ds_read_b128 a[248:251], v206 offset:24576
    v_cvt_pk_bf16_f32 v145, v98, v99
    v_exp_f32 v100, v100
    v_exp_f32 v101, v101
    s_waitcnt vmcnt(9)
    s_barrier
L_ih9:
    s_add_u32 m0, s43, 0
    s_add_u32 s45, s52, 65536
    v_mfma_f32_32x32x16_bf16 v[112:127], a[232:235], a[104:107], v[112:127]
    s_waitcnt lgkmcnt(3)
    ds_read_b128 a[252:255], v207 offset:24576
    buffer_load_dwordx4 v224, s[12:15], s45 offen nt lds
    v_cvt_pk_bf16_f32 v146, v100, v101
    v_exp_f32 v102, v102
    v_exp_f32 v103, v103
    v_and_b32 v238, 112, v244
    v_lshl_add_u32 v238, v238, 3, s44
    v_mfma_f32_32x32x16_bf16 v[112:127], a[236:239], a[108:111], v[112:127]
    s_waitcnt lgkmcnt(3)
    ds_read_b64_tr_b16 a[208:209], v208 offset:16384
    ds_read_b64_tr_b16 a[210:211], v208 offset:18432
    v_cvt_pk_bf16_f32 v147, v102, v103
    v_exp_f32 v104, v104
    v_add_f32 v232, v232, v96
    v_add_u32 v238, L_ih11 - L_ibase, v238
    v_min_u32 v238, L_end - L_ibase - 64, v238
    v_mfma_f32_32x32x16_bf16 v[112:127], a[240:243], a[112:115], v[112:127]
    s_waitcnt lgkmcnt(4)
    ds_read_b64_tr_b16 a[212:213], v209 offset:16384
    ds_read_b64_tr_b16 a[214:215], v209 offset:18432
    buffer_load_dwordx4 v225, s[12:15], s45 offen offset:1024 nt lds
    v_exp_f32 v105, v105
    v_add_f32 v232, v232, v97
    v_mfma_f32_32x32x16_bf16 v[112:127], a[244:247], a[116:119], v[112:127]
    s_waitcnt lgkmcnt(5)
    global_load_dword a140, v238, s[90:91]
    ds_read_b64_tr_b16 a[216:217], v210 offset:16384
    ds_read_b64_tr_b16 a[218:219], v210 offset:18432
    v_cvt_pk_bf16_f32 v148, v104, v105
    v_exp_f32 v106, v106
    v_add_f32 v232, v232, v98
    v_mfma_f32_32x32x16_bf16 v[112:127], a[248:251], a[120:123], v[112:127]
    s_waitcnt lgkmcnt(6)
    ds_read_b64_tr_b16 a[220:221], v211 offset:16384
    ds_read_b64_tr_b16 a[222:223], v211 offset:18432
    buffer_load_dwordx4 v226, s[12:15], s45 offen offset:2048 nt lds
    v_exp_f32 v107, v107
    v_add_f32 v232, v232, v99
    v_add_f32 v232, v232, v100
    v_mfma_f32_32x32x16_bf16 v[112:127], a[252:255], a[124:127], v[112:127]
    s_waitcnt lgkmcnt(6)
    ds_read_b64_tr_b16 a[224:225], v208 offset:20480
    ds_read_b64_tr_b16 a[226:227], v208 offset:22528
    v_cvt_pk_bf16_f32 v149, v106, v107
    v_exp_f32 v108, v108
    v_add_f32 v232, v232, v101
    v_mfma_f32_32x32x16_bf16 v[0:15], a[208:211], v[144:147], v[0:15]
    s_waitcnt lgkmcnt(6)
    ds_read_b64_tr_b16 a[228:229], v209 offset:20480
    ds_read_b64_tr_b16 a[230:231], v209 offset:22528
    buffer_load_dwordx4 v227, s[12:15], s45 offen offset:3072 nt lds
    v_exp_f32 v109, v109
    v_add_f32 v232, v232, v102
    v_mfma_f32_32x32x16_bf16 v[16:31], a[212:215], v[144:147], v[16:31]
    s_waitcnt lgkmcnt(6)
    ds_read_b64_tr_b16 a[232:233], v210 offset:20480
    ds_read_b64_tr_b16 a[234:235], v210 offset:22528
    v_cvt_pk_bf16_f32 v150, v108, v109
    v_exp_f32 v110, v110
    v_add_f32 v232, v232, v103
    v_mfma_f32_32x32x16_bf16 v[32:47], a[216:219], v[144:147], v[32:47]
    s_waitcnt lgkmcnt(6)
    ds_read_b64_tr_b16 a[236:237], v211 offset:20480
    ds_read_b64_tr_b16 a[238:239], v211 offset:22528
    v_exp_f32 v111, v111
    v_add_f32 v232, v232, v104
    v_max3_f32 v234, v112, v113, v114
    v_mfma_f32_32x32x16_bf16 v[48:63], a[220:223], v[144:147], v[48:63]
    s_waitcnt lgkmcnt(6)
    ds_read_b128 a[240:243], v200 offset:32768
    v_cvt_pk_bf16_f32 v151, v110, v111
    v_add_f32 v232, v232, v105
    v_add_f32 v232, v232, v106
    v_max3_f32 v234, v234, v115, v116
    v_max3_f32 v234, v234, v117, v118
    v_mfma_f32_32x32x16_bf16 v[0:15], a[224:227], v[148:151], v[0:15]
    s_waitcnt lgkmcnt(5)
    ds_read_b128 a[244:247], v201 offset:32768
    v_add_f32 v232, v232, v107
    v_add_f32 v232, v232, v108
    v_max3_f32 v234, v234, v119, v120
    v_max3_f32 v234, v234, v121, v122
    v_max3_f32 v235, v152, v153, v154
    v_mfma_f32_32x32x16_bf16 v[16:31], a[228:231], v[148:151], v[16:31]
    s_waitcnt lgkmcnt(4)
    ds_read_b128 a[248:251], v202 offset:32768
    v_add_f32 v232, v232, v109
    v_add_f32 v232, v232, v110
    v_max3_f32 v234, v234, v123, v124
    v_max3_f32 v234, v234, v125, v126
    v_max3_f32 v235, v235, v155, v156
    v_mfma_f32_32x32x16_bf16 v[32:47], a[232:235], v[148:151], v[32:47]
    s_waitcnt lgkmcnt(3)
    ds_read_b128 a[252:255], v203 offset:32768
    v_add_f32 v232, v232, v111
    v_max_f32 v234, v234, v127
    v_cmp_lt_f32 vcc, 0x41000000, v234
    v_max3_f32 v235, v235, v157, v158
    v_max_f32 v235, v235, v159
    v_mfma_f32_32x32x16_bf16 v[48:63], a[236:239], v[148:151], v[48:63]
    s_waitcnt lgkmcnt(3)
    ds_read_b128 a[208:211], v204 offset:32768
    v_accvgpr_write_b32 a136, v162
    v_accvgpr_write_b32 a137, v163
    v_accvgpr_write_b32 a138, v164
    v_accvgpr_write_b32 a139, v165
    v_mov_b32 v238, v235
    s_cbranch_vccnz L_rare21
L_back21:
    v_exp_f32 v112, v112
    v_exp_f32 v113, v113
    v_mfma_f32_32x32x16_bf16 v[96:111], a[240:243], a[96:99], v[128:143]
    s_waitcnt lgkmcnt(3)
    ds_read_b128 a[212:215], v205 offset:32768
    v_cvt_pk_bf16_f32 v144, v112, v113
    v_exp_f32 v114, v114
    v_exp_f32 v115, v115
    v_mfma_f32_32x32x16_bf16 v[96:111], a[244:247], a[100:103], v[96:111]
    s_waitcnt lgkmcnt(3)
    ds_read_b128 a[216:219], v206 offset:32768
    s_add_u32 m0, s43, 114688
    s_add_u32 s46, s52, 49152
    v_cvt_pk_bf16_f32 v145, v114, v115
    v_exp_f32 v116, v116
    v_exp_f32 v117, v117
    v_mfma_f32_32x32x16_bf16 v[96:111], a[248:251], a[104:107], v[96:111]
    s_waitcnt lgkmcnt(3)
    ds_read_b128 a[220:223], v207 offset:32768
    buffer_load_dwordx4 v228, s[16:19], s46 offen nt lds
    v_cvt_pk_bf16_f32 v146, v116, v117
    v_exp_f32 v118, v118
    v_exp_f32 v119, v119
    v_mfma_f32_32x32x16_bf16 v[96:111], a[252:255], a[108:111], v[96:111]
    s_waitcnt lgkmcnt(3)
    ds_read_b64_tr_b16 a[224:225], v216 offset:0
    ds_read_b64_tr_b16 a[226:227], v216 offset:4096
    ds_read_b64_tr_b16 a[228:229], v217 offset:0
    ds_read_b64_tr_b16 a[230:231], v217 offset:4096
    v_cvt_pk_bf16_f32 v147, v118, v119
    v_exp_f32 v120, v120
    v_add_f32 v232, v232, v112
    v_mfma_f32_32x32x16_bf16 v[96:111], a[208:211], a[112:115], v[96:111]
    s_waitcnt lgkmcnt(6)
    ds_read_b64_tr_b16 a[232:233], v218 offset:0
    ds_read_b64_tr_b16 a[234:235], v218 offset:4096
    ds_read_b64_tr_b16 a[236:237], v219 offset:0
    ds_read_b64_tr_b16 a[238:239], v219 offset:4096
    buffer_load_dwordx4 v229, s[16:19], s46 offen offset:1024 nt lds
    v_exp_f32 v121, v121
    v_add_f32 v232, v232, v113
    v_mfma_f32_32x32x16_bf16 v[96:111], a[212:215], a[116:119], v[96:111]
    s_waitcnt lgkmcnt(9)
    ds_read_b64_tr_b16 a[240:241], v220 offset:0
    ds_read_b64_tr_b16 a[242:243], v220 offset:4096
    ds_read_b64_tr_b16 a[244:245], v221 offset:0
    ds_read_b64_tr_b16 a[246:247], v221 offset:4096
    v_cvt_pk_bf16_f32 v148, v120, v121
    v_exp_f32 v122, v122
    v_add_f32 v232, v232, v114
    v_permlane16_swap_b32 v238, v235
    v_max_f32 v235, v238, v235
    v_mov_b32 v238, v235
    v_mfma_f32_32x32x16_bf16 v[96:111], a[216:219], a[120:123], v[96:111]
    s_waitcnt lgkmcnt(12)
    ds_read_b64_tr_b16 a[248:249], v222 offset:0
    ds_read_b64_tr_b16 a[250:251], v222 offset:4096
    ds_read_b64_tr_b16 a[252:253], v223 offset:0
    ds_read_b64_tr_b16 a[254:255], v223 offset:4096
    buffer_load_dwordx4 v228, s[16:19], s46 offen offset:2048 nt lds
    v_exp_f32 v123, v123
    v_add_f32 v232, v232, v115
    v_add_f32 v232, v232, v116
    v_permlane32_swap_b32 v238, v235
    v_max_f32 v235, v238, v235
    v_sub_f32 v152, v152, v235
    v_sub_f32 v153, v153, v235
    v_sub_f32 v154, v154, v235
    v_sub_f32 v155, v155, v235
    v_sub_f32 v156, v156, v235
    v_sub_f32 v157, v157, v235
    v_sub_f32 v158, v158, v235
    v_sub_f32 v159, v159, v235
    v_exp_f32 v152, v152
    v_exp_f32 v153, v153
    v_exp_f32 v154, v154
    v_exp_f32 v155, v155
    v_exp_f32 v156, v156
    v_exp_f32 v157, v157
    v_exp_f32 v158, v158
    v_exp_f32 v159, v159
    v_mfma_f32_32x32x16_bf16 v[96:111], a[220:223], a[124:127], v[96:111]
    s_waitcnt lgkmcnt(14)
    ds_read_b64_tr_b16 a[208:209], v208 offset:24576
    ds_read_b64_tr_b16 a[210:211], v208 offset:26624
    v_cvt_pk_bf16_f32 v149, v122, v123
    v_exp_f32 v124, v124
    v_add_f32 v232, v232, v117
    v_cvt_pk_bf16_f32 v164, v152, v153
    v_cvt_pk_bf16_f32 v165, v154, v155
    v_cvt_pk_bf16_f32 v166, v156, v157
    v_cvt_pk_bf16_f32 v167, v158, v159
    s_nop 1
    v_mfma_f32_16x16x32_bf16 v[64:67], a[224:227], v[164:167], 0
    s_waitcnt lgkmcnt(14)
    ds_read_b64_tr_b16 a[212:213], v209 offset:24576
    ds_read_b64_tr_b16 a[214:215], v209 offset:26624
    v_mfma_f32_16x16x32_bf16 v[68:71], a[228:231], v[164:167], 0
    s_waitcnt lgkmcnt(14)
    v_sub_f32 v160, 0, v235
    v_sub_f32 v161, 0, v235
    v_mfma_f32_16x16x32_bf16 v[72:75], a[232:235], v[164:167], 0
    s_waitcnt lgkmcnt(12)
    ds_read_b64_tr_b16 a[216:217], v210 offset:24576
    ds_read_b64_tr_b16 a[218:219], v210 offset:26624
    v_mfma_f32_16x16x32_bf16 v[76:79], a[236:239], v[164:167], 0
    s_waitcnt lgkmcnt(12)
    v_sub_f32 v162, 0, v235
    v_sub_f32 v163, 0, v235
    v_mfma_f32_16x16x32_bf16 v[80:83], a[240:243], v[164:167], 0
    s_waitcnt lgkmcnt(10)
    ds_read_b64_tr_b16 a[220:221], v211 offset:24576
    ds_read_b64_tr_b16 a[222:223], v211 offset:26624
    v_mfma_f32_16x16x32_bf16 v[84:87], a[244:247], v[164:167], 0
    s_waitcnt lgkmcnt(10)
    v_mov_b32 v233, 0
    v_add_f32 v233, v233, v152
    v_mfma_f32_16x16x32_bf16 v[88:91], a[248:251], v[164:167], 0
    s_waitcnt lgkmcnt(8)
    ds_read_b64_tr_b16 a[224:225], v208 offset:28672
    ds_read_b64_tr_b16 a[226:227], v208 offset:30720
    v_mfma_f32_16x16x32_bf16 v[92:95], a[252:255], v[164:167], 0
    s_waitcnt lgkmcnt(8)
    v_add_f32 v233, v233, v153
    v_add_f32 v233, v233, v154
    v_mfma_f32_32x32x16_bf16 v[0:15], a[208:211], v[144:147], v[0:15]
    s_waitcnt lgkmcnt(6)
    ds_read_b64_tr_b16 a[228:229], v209 offset:28672
    ds_read_b64_tr_b16 a[230:231], v209 offset:30720
    buffer_load_dwordx4 v229, s[16:19], s46 offen offset:3072 nt lds
    v_exp_f32 v125, v125
    v_add_f32 v232, v232, v118
    v_mfma_f32_32x32x16_bf16 v[16:31], a[212:215], v[144:147], v[16:31]
    s_waitcnt lgkmcnt(6)
    ds_read_b64_tr_b16 a[232:233], v210 offset:28672
    ds_read_b64_tr_b16 a[234:235], v210 offset:30720
    v_cvt_pk_bf16_f32 v150, v124, v125
    v_exp_f32 v126, v126
    v_add_f32 v232, v232, v119
    v_mfma_f32_32x32x16_bf16 v[32:47], a[216:219], v[144:147], v[32:47]
    s_waitcnt lgkmcnt(6)
    ds_read_b64_tr_b16 a[236:237], v211 offset:28672
    ds_read_b64_tr_b16 a[238:239], v211 offset:30720
    v_exp_f32 v127, v127
    v_add_f32 v232, v232, v120
    v_max3_f32 v234, v96, v97, v98
    v_mfma_f32_32x32x16_bf16 v[48:63], a[220:223], v[144:147], v[48:63]
    s_waitcnt lgkmcnt(6)
    ds_read_b128 a[240:243], v200 offset:40960
    v_cvt_pk_bf16_f32 v151, v126, v127
    v_add_f32 v232, v232, v121
    v_add_f32 v232, v232, v122
    v_max3_f32 v234, v234, v99, v100
    v_max3_f32 v234, v234, v101, v102
    v_mfma_f32_32x32x16_bf16 v[0:15], a[224:227], v[148:151], v[0:15]
    s_waitcnt lgkmcnt(5)
    ds_read_b128 a[244:247], v201 offset:40960
    v_add_f32 v232, v232, v123
    v_add_f32 v232, v232, v124
    v_max3_f32 v234, v234, v103, v104
    v_max3_f32 v234, v234, v105, v106
    v_add_f32 v233, v233, v155
    v_mfma_f32_32x32x16_bf16 v[16:31], a[228:231], v[148:151], v[16:31]
    s_waitcnt lgkmcnt(4)
    ds_read_b128 a[248:251], v202 offset:40960
    v_add_f32 v232, v232, v125
    v_add_f32 v232, v232, v126
    v_max3_f32 v234, v234, v107, v108
    v_max3_f32 v234, v234, v109, v110
    v_add_f32 v233, v233, v156
    v_mfma_f32_32x32x16_bf16 v[32:47], a[232:235], v[148:151], v[32:47]
    s_waitcnt lgkmcnt(3)
    ds_read_b128 a[252:255], v203 offset:40960
    v_add_f32 v232, v232, v127
    v_max_f32 v234, v234, v111
    v_cmp_lt_f32 vcc, 0x41000000, v234
    v_add_f32 v233, v233, v157
    v_add_f32 v233, v233, v158
    v_mfma_f32_32x32x16_bf16 v[48:63], a[236:239], v[148:151], v[48:63]
    s_waitcnt lgkmcnt(3)
    ds_read_b128 a[208:211], v204 offset:40960
    v_add_f32 v233, v233, v159
    s_cbranch_vccnz L_rare22
L_back22:
    v_exp_f32 v96, v96
    v_exp_f32 v97, v97
    v_mfma_f32_32x32x16_bf16 v[112:127], a[240:243], a[96:99], v[128:143]
    s_waitcnt lgkmcnt(3)
    ds_read_b128 a[212:215], v205 offset:40960
    v_cvt_pk_bf16_f32 v144, v96, v97
    v_exp_f32 v98, v98
    v_exp_f32 v99, v99
    v_mfma_f32_32x32x16_bf16 v[112:127], a[244:247], a[100:103], v[112:127]
    s_waitcnt lgkmcnt(3)
    ds_read_b128 a[216:219], v206 offset:40960
    v_cvt_pk_bf16_f32 v145, v98, v99
    v_exp_f32 v100, v100
    v_exp_f32 v101, v101
    s_waitcnt vmcnt(9)
    s_barrier
L_ih10:
    s_add_u32 m0, s43, 16384
    s_add_u32 s45, s52, 81920
    v_mfma_f32_32x32x16_bf16 v[112:127], a[248:251], a[104:107], v[112:127]
    s_waitcnt lgkmcnt(3)
    ds_read_b128 a[220:223], v207 offset:40960
    buffer_load_dwordx4 v224, s[12:15], s45 offen nt lds
    v_cvt_pk_bf16_f32 v146, v100, v101
    v_exp_f32 v102, v102
    v_exp_f32 v103, v103
    v_and_b32 v238, 112, v244
    v_lshl_add_u32 v238, v238, 3, s44
    v_mfma_f32_32x32x16_bf16 v[112:127], a[252:255], a[108:111], v[112:127]
    s_waitcnt lgkmcnt(3)
    ds_read_b64_tr_b16 a[224:225], v208 offset:32768
    ds_read_b64_tr_b16 a[226:227], v208 offset:34816
    v_cvt_pk_bf16_f32 v147, v102, v103
    v_exp_f32 v104, v104
    v_add_f32 v232, v232, v96
    v_add_u32 v238, L_ih12 - L_ibase, v238
    v_min_u32 v238, L_end - L_ibase - 64, v238
    v_mfma_f32_32x32x16_bf16 v[112:127], a[208:211], a[112:115], v[112:127]
    s_waitcnt lgkmcnt(4)
    ds_read_b64_tr_b16 a[228:229], v209 offset:32768
    ds_read_b64_tr_b16 a[230:231], v209 offset:34816
    buffer_load_dwordx4 v225, s[12:15], s45 offen offset:1024 nt lds
    v_exp_f32 v105, v105
    v_add_f32 v232, v232, v97
    v_mfma_f32_32x32x16_bf16 v[112:127], a[212:215], a[116:119], v[112:127]
    s_waitcnt lgkmcnt(5)
    global_load_dword a140, v238, s[90:91]
    ds_read_b64_tr_b16 a[232:233], v210 offset:32768
    ds_read_b64_tr_b16 a[234:235], v210 offset:34816
    v_cvt_pk_bf16_f32 v148, v104, v105
    v_exp_f32 v106, v106
    v_add_f32 v232, v232, v98
    v_mfma_f32_32x32x16_bf16 v[112:127], a[216:219], a[120:123], v[112:127]
    s_waitcnt lgkmcnt(6)
    ds_read_b64_tr_b16 a[236:237], v211 offset:32768
    ds_read_b64_tr_b16 a[238:239], v211 offset:34816
    buffer_load_dwordx4 v226, s[12:15], s45 offen offset:2048 nt lds
    v_exp_f32 v107, v107
    v_add_f32 v232, v232, v99
    v_add_f32 v232, v232, v100
    v_mfma_f32_32x32x16_bf16 v[112:127], a[220:223], a[124:127], v[112:127]
    s_waitcnt lgkmcnt(6)
    ds_read_b64_tr_b16 a[240:241], v208 offset:36864
    ds_read_b64_tr_b16 a[242:243], v208 offset:38912
    v_cvt_pk_bf16_f32 v149, v106, v107
    v_exp_f32 v108, v108
    v_add_f32 v232, v232, v101
    v_mfma_f32_32x32x16_bf16 v[0:15], a[224:227], v[144:147], v[0:15]
    s_waitcnt lgkmcnt(6)
    ds_read_b64_tr_b16 a[244:245], v209 offset:36864
    ds_read_b64_tr_b16 a[246:247], v209 offset:38912
    buffer_load_dwordx4 v227, s[12:15], s45 offen offset:3072 nt lds
    v_exp_f32 v109, v109
    v_add_f32 v232, v232, v102
    v_mfma_f32_32x32x16_bf16 v[16:31], a[228:231], v[144:147], v[16:31]
    s_waitcnt lgkmcnt(6)
    ds_read_b64_tr_b16 a[248:249], v210 offset:36864
    ds_read_b64_tr_b16 a[250:251], v210 offset:38912
    v_cvt_pk_bf16_f32 v150, v108, v109
    v_exp_f32 v110, v110
    v_add_f32 v232, v232, v103
    v_mfma_f32_32x32x16_bf16 v[32:47], a[232:235], v[144:147], v[32:47]
    s_waitcnt lgkmcnt(6)
    ds_read_b64_tr_b16 a[252:253], v211 offset:36864
    ds_read_b64_tr_b16 a[254:255], v211 offset:38912
    v_exp_f32 v111, v111
    v_add_f32 v232, v232, v104
    v_max3_f32 v234, v112, v113, v114
    v_mfma_f32_32x32x16_bf16 v[48:63], a[236:239], v[144:147], v[48:63]
    s_waitcnt lgkmcnt(6)
    ds_read_b128 a[208:211], v200 offset:49152
    v_cvt_pk_bf16_f32 v151, v110, v111
    v_add_f32 v232, v232, v105
    v_add_f32 v232, v232, v106
    v_max3_f32 v234, v234, v115, v116
    v_max3_f32 v234, v234, v117, v118
    v_mfma_f32_32x32x16_bf16 v[0:15], a[240:243], v[148:151], v[0:15]
    s_waitcnt lgkmcnt(5)
    ds_read_b128 a[212:215], v201 offset:49152
    v_add_f32 v232, v232, v107
    v_add_f32 v232, v232, v108
    v_max3_f32 v234, v234, v119, v120
    v_max3_f32 v234, v234, v121, v122
    v_mfma_f32_32x32x16_bf16 v[16:31], a[244:247], v[148:151], v[16:31]
    s_waitcnt lgkmcnt(4)
    ds_read_b128 a[216:219], v202 offset:49152
    v_add_f32 v232, v232, v109
    v_add_f32 v232, v232, v110
    v_max3_f32 v234, v234, v123, v124
    v_max3_f32 v234, v234, v125, v126
    v_mfma_f32_32x32x16_bf16 v[32:47], a[248:251], v[148:151], v[32:47]
    s_waitcnt lgkmcnt(3)
    ds_read_b128 a[220:223], v203 offset:49152
    v_add_f32 v232, v232, v111
    v_max_f32 v234, v234, v127
    v_cmp_lt_f32 vcc, 0x41000000, v234
    v_mfma_f32_32x32x16_bf16 v[48:63], a[252:255], v[148:151], v[48:63]
    s_waitcnt lgkmcnt(3)
    ds_read_b128 a[224:227], v204 offset:49152
    s_cbranch_vccnz L_rare23
L_back23:
    v_exp_f32 v112, v112
    v_exp_f32 v113, v113
    v_mfma_f32_32x32x16_bf16 v[96:111], a[208:211], a[96:99], v[128:143]
    s_waitcnt lgkmcnt(3)
    ds_read_b128 a[228:231], v205 offset:49152
    v_cvt_pk_bf16_f32 v144, v112, v113
    v_exp_f32 v114, v114
    v_exp_f32 v115, v115
    v_mfma_f32_32x32x16_bf16 v[96:111], a[212:215], a[100:103], v[96:111]
    s_waitcnt lgkmcnt(3)
    ds_read_b128 a[232:235], v206 offset:49152
    s_add_u32 m0, s43, 65536
    s_add_u32 s46, s52, 65536
    v_cvt_pk_bf16_f32 v145, v114, v115
    v_exp_f32 v116, v116
    v_exp_f32 v117, v117
    v_mfma_f32_32x32x16_bf16 v[96:111], a[216:219], a[104:107], v[96:111]
    s_waitcnt lgkmcnt(3)
    ds_read_b128 a[236:239], v207 offset:49152
    buffer_load_dwordx4 v228, s[16:19], s46 offen nt lds
    v_cvt_pk_bf16_f32 v146, v116, v117
    v_exp_f32 v118, v118
    v_exp_f32 v119, v119
    v_mfma_f32_32x32x16_bf16 v[96:111], a[220:223], a[108:111], v[96:111]
    s_waitcnt lgkmcnt(3)
    ds_read_b64_tr_b16 a[240:241], v208 offset:40960
    ds_read_b64_tr_b16 a[242:243], v208 offset:43008
    v_cvt_pk_bf16_f32 v147, v118, v119
    v_exp_f32 v120, v120
    v_add_f32 v232, v232, v112
    v_mfma_f32_32x32x16_bf16 v[96:111], a[224:227], a[112:115], v[96:111]
    s_waitcnt lgkmcnt(4)
    ds_read_b64_tr_b16 a[244:245], v209 offset:40960
    ds_read_b64_tr_b16 a[246:247], v209 offset:43008
    buffer_load_dwordx4 v229, s[16:19], s46 offen offset:1024 nt lds
    v_exp_f32 v121, v121
    v_add_f32 v232, v232, v113
    v_mfma_f32_32x32x16_bf16 v[96:111], a[228:231], a[116:119], v[96:111]
    s_waitcnt lgkmcnt(5)
    ds_read_b64_tr_b16 a[248:249], v210 offset:40960
    ds_read_b64_tr_b16 a[250:251], v210 offset:43008
    v_cvt_pk_bf16_f32 v148, v120, v121
    v_exp_f32 v122, v122
    v_add_f32 v232, v232, v114
    v_mfma_f32_32x32x16_bf16 v[96:111], a[232:235], a[120:123], v[96:111]
    s_waitcnt lgkmcnt(6)
    ds_read_b64_tr_b16 a[252:253], v211 offset:40960
    ds_read_b64_tr_b16 a[254:255], v211 offset:43008
    buffer_load_dwordx4 v228, s[16:19], s46 offen offset:2048 nt lds
    v_exp_f32 v123, v123
    v_add_f32 v232, v232, v115
    v_add_f32 v232, v232, v116
    v_mfma_f32_32x32x16_bf16 v[96:111], a[236:239], a[124:127], v[96:111]
    s_waitcnt lgkmcnt(6)
    ds_read_b64_tr_b16 a[208:209], v208 offset:45056
    ds_read_b64_tr_b16 a[210:211], v208 offset:47104
    v_cvt_pk_bf16_f32 v149, v122, v123
    v_exp_f32 v124, v124
    v_add_f32 v232, v232, v117
    v_mfma_f32_32x32x16_bf16 v[0:15], a[240:243], v[144:147], v[0:15]
    s_waitcnt lgkmcnt(6)
    ds_read_b64_tr_b16 a[212:213], v209 offset:45056
    ds_read_b64_tr_b16 a[214:215], v209 offset:47104
    buffer_load_dwordx4 v229, s[16:19], s46 offen offset:3072 nt lds
    v_exp_f32 v125, v125
    v_add_f32 v232, v232, v118
    v_mfma_f32_32x32x16_bf16 v[16:31], a[244:247], v[144:147], v[16:31]
    s_waitcnt lgkmcnt(6)
    ds_read_b64_tr_b16 a[216:217], v210 offset:45056
    ds_read_b64_tr_b16 a[218:219], v210 offset:47104
    v_cvt_pk_bf16_f32 v150, v124, v125
    v_exp_f32 v126, v126
    v_add_f32 v232, v232, v119
    v_add_u32 v237, 131072, v245
    v_mfma_f32_32x32x16_bf16 v[32:47], a[248:251], v[144:147], v[32:47]
    s_waitcnt lgkmcnt(6)
    ds_read_b64_tr_b16 a[220:221], v211 offset:45056
    ds_read_b64_tr_b16 a[222:223], v211 offset:47104
    ds_write_b64 v237, a[136:137] offset:0
    v_exp_f32 v127, v127
    v_add_f32 v232, v232, v120
    v_max3_f32 v234, v96, v97, v98
    v_mfma_f32_32x32x16_bf16 v[48:63], a[252:255], v[144:147], v[48:63]
    s_waitcnt lgkmcnt(7)
    ds_write_b64 v237, a[138:139] offset:512
    ds_read_b128 a[224:227], v212 offset:32768
    ds_read_b128 a[228:231], v213 offset:32768
    v_cvt_pk_bf16_f32 v151, v126, v127
    v_add_f32 v232, v232, v121
    v_add_f32 v232, v232, v122
    v_max3_f32 v234, v234, v99, v100
    v_max3_f32 v234, v234, v101, v102
    v_mfma_f32_32x32x16_bf16 v[0:15], a[208:211], v[148:151], v[0:15]
    s_waitcnt lgkmcnt(8)
    ds_read_b128 a[232:235], v214 offset:32768
    ds_read_b128 a[236:239], v215 offset:32768
    v_add_f32 v232, v232, v123
    v_add_f32 v232, v232, v124
    v_max3_f32 v234, v234, v103, v104
    v_max3_f32 v234, v234, v105, v106
    v_mfma_f32_32x32x16_bf16 v[16:31], a[212:215], v[148:151], v[16:31]
    s_waitcnt lgkmcnt(8)
    ds_read_b128 a[240:243], v212 offset:36864
    ds_read_b128 a[244:247], v213 offset:36864
    v_add_f32 v232, v232, v125
    v_add_f32 v232, v232, v126
    v_max3_f32 v234, v234, v107, v108
    v_max3_f32 v234, v234, v109, v110
    v_mfma_f32_32x32x16_bf16 v[32:47], a[216:219], v[148:151], v[32:47]
    s_waitcnt lgkmcnt(8)
    ds_read_b128 a[248:251], v214 offset:36864
    ds_read_b128 a[252:255], v215 offset:36864
    v_add_f32 v232, v232, v127
    v_max_f32 v234, v234, v111
    v_cmp_lt_f32 vcc, 0x41000000, v234
    v_mfma_f32_32x32x16_bf16 v[48:63], a[220:223], v[148:151], v[48:63]
    s_waitcnt lgkmcnt(7)
    ds_read_b128 a[208:211], v200 offset:57344
    s_cbranch_vccnz L_rare24
L_back24:
    v_mfma_f32_16x16x32_bf16 v[152:155], a[224:227], a[176:179], v[160:163]
    s_waitcnt lgkmcnt(7)
    ds_read_b128 a[212:215], v201 offset:57344
    v_mfma_f32_16x16x32_bf16 v[152:155], a[228:231], a[180:183], v[152:155]
    s_waitcnt lgkmcnt(7)
    v_mfma_f32_16x16x32_bf16 v[152:155], a[232:235], a[184:187], v[152:155]
    s_waitcnt lgkmcnt(6)
    ds_read_b128 a[216:219], v202 offset:57344
    v_mfma_f32_16x16x32_bf16 v[152:155], a[236:239], a[188:191], v[152:155]
    s_waitcnt lgkmcnt(6)
    v_mfma_f32_16x16x32_bf16 v[156:159], a[240:243], a[176:179], v[160:163]
    s_waitcnt lgkmcnt(5)
    ds_read_b128 a[220:223], v203 offset:57344
    v_mfma_f32_16x16x32_bf16 v[156:159], a[244:247], a[180:183], v[156:159]
    s_waitcnt lgkmcnt(5)
    v_mfma_f32_16x16x32_bf16 v[156:159], a[248:251], a[184:187], v[156:159]
    s_waitcnt lgkmcnt(4)
    ds_read_b128 a[224:227], v204 offset:57344
    v_mfma_f32_16x16x32_bf16 v[156:159], a[252:255], a[188:191], v[156:159]
    s_waitcnt lgkmcnt(4)
    v_exp_f32 v96, v96
    v_exp_f32 v97, v97
    v_mfma_f32_32x32x16_bf16 v[112:127], a[208:211], a[96:99], v[128:143]
    s_waitcnt lgkmcnt(3)
    ds_read_b128 a[228:231], v205 offset:57344
    v_cvt_pk_bf16_f32 v144, v96, v97
    v_exp_f32 v98, v98
    v_exp_f32 v99, v99
    v_mfma_f32_32x32x16_bf16 v[112:127], a[212:215], a[100:103], v[112:127]
    s_waitcnt lgkmcnt(3)
    ds_read_b128 a[232:235], v206 offset:57344
    v_cvt_pk_bf16_f32 v145, v98, v99
    v_exp_f32 v100, v100
    v_exp_f32 v101, v101
    s_waitcnt vmcnt(9)
    s_barrier
L_ih11:
    s_add_u32 m0, s43, 32768
    s_add_u32 s45, s52, 98304
    v_mfma_f32_32x32x16_bf16 v[112:127], a[216:219], a[104:107], v[112:127]
    s_waitcnt lgkmcnt(3)
    ds_read_b128 a[236:239], v207 offset:57344
    buffer_load_dwordx4 v224, s[12:15], s45 offen nt lds
    v_cvt_pk_bf16_f32 v146, v100, v101
    v_exp_f32 v102, v102
    v_exp_f32 v103, v103
    v_and_b32 v238, 112, v244
    v_lshl_add_u32 v238, v238, 3, s44
    v_mfma_f32_32x32x16_bf16 v[112:127], a[220:223], a[108:111], v[112:127]
    s_waitcnt lgkmcnt(3)
    ds_read_b64_tr_b16 a[240:241], v208 offset:49152
    ds_read_b64_tr_b16 a[242:243], v208 offset:51200
    v_cvt_pk_bf16_f32 v147, v102, v103
    v_exp_f32 v104, v104
    v_add_f32 v232, v232, v96
    v_add_u32 v238, L_ih13 - L_ibase, v238
    v_min_u32 v238, L_end - L_ibase - 64, v238
    v_mfma_f32_32x32x16_bf16 v[112:127], a[224:227], a[112:115], v[112:127]
    s_waitcnt lgkmcnt(4)
    ds_read_b64_tr_b16 a[244:245], v209 offset:49152
    ds_read_b64_tr_b16 a[246:247], v209 offset:51200
    buffer_load_dwordx4 v225, s[12:15], s45 offen offset:1024 nt lds
    v_exp_f32 v105, v105
    v_add_f32 v232, v232, v97
    v_mfma_f32_32x32x16_bf16 v[112:127], a[228:231], a[116:119], v[112:127]
    s_waitcnt lgkmcnt(5)
    global_load_dword a140, v238, s[90:91]
    ds_read_b64_tr_b16 a[248:249], v210 offset:49152
    ds_read_b64_tr_b16 a[250:251], v210 offset:51200
    v_cvt_pk_bf16_f32 v148, v104, v105
    v_exp_f32 v106, v106
    v_add_f32 v232, v232, v98
    v_mfma_f32_32x32x16_bf16 v[112:127], a[232:235], a[120:123], v[112:127]
    s_waitcnt lgkmcnt(6)
    ds_read_b64_tr_b16 a[252:253], v211 offset:49152
    ds_read_b64_tr_b16 a[254:255], v211 offset:51200
    buffer_load_dwordx4 v226, s[12:15], s45 offen offset:2048 nt lds
    v_exp_f32 v107, v107
    v_add_f32 v232, v232, v99
    v_add_f32 v232, v232, v100
    v_mfma_f32_32x32x16_bf16 v[112:127], a[236:239], a[124:127], v[112:127]
    s_waitcnt lgkmcnt(6)
    ds_read_b64_tr_b16 a[208:209], v208 offset:53248
    ds_read_b64_tr_b16 a[210:211], v208 offset:55296
    v_cvt_pk_bf16_f32 v149, v106, v107
    v_exp_f32 v108, v108
    v_add_f32 v232, v232, v101
    v_max3_f32 v235, v152, v153, v154
    v_max3_f32 v235, v235, v155, v156
    v_max3_f32 v235, v235, v157, v158
    v_max_f32 v235, v235, v159
    v_cmp_lt_f32 vcc, 0x41000000, v235
    s_nop 1
    s_cbranch_vccnz L_rare25
L_back25:
    v_mfma_f32_32x32x16_bf16 v[0:15], a[240:243], v[144:147], v[0:15]
    s_waitcnt lgkmcnt(6)
    ds_read_b64_tr_b16 a[212:213], v209 offset:53248
    ds_read_b64_tr_b16 a[214:215], v209 offset:55296
    buffer_load_dwordx4 v227, s[12:15], s45 offen offset:3072 nt lds
    v_exp_f32 v109, v109
    v_add_f32 v232, v232, v102
    v_mfma_f32_32x32x16_bf16 v[16:31], a[244:247], v[144:147], v[16:31]
    s_waitcnt lgkmcnt(6)
    ds_read_b64_tr_b16 a[216:217], v210 offset:53248
    ds_read_b64_tr_b16 a[218:219], v210 offset:55296
    v_cvt_pk_bf16_f32 v150, v108, v109
    v_exp_f32 v110, v110
    v_add_f32 v232, v232, v103
    v_mfma_f32_32x32x16_bf16 v[32:47], a[248:251], v[144:147], v[32:47]
    s_waitcnt lgkmcnt(6)
    ds_read_b64_tr_b16 a[220:221], v211 offset:53248
    ds_read_b64_tr_b16 a[222:223], v211 offset:55296
    v_exp_f32 v111, v111
    v_add_f32 v232, v232, v104
    v_max3_f32 v234, v112, v113, v114
    v_mfma_f32_32x32x16_bf16 v[48:63], a[252:255], v[144:147], v[48:63]
    s_waitcnt lgkmcnt(6)
    ds_read_b128 a[224:227], v200 offset:0
    v_cvt_pk_bf16_f32 v151, v110, v111
    v_add_f32 v232, v232, v105
    v_add_f32 v232, v232, v106
    v_max3_f32 v234, v234, v115, v116
    v_max3_f32 v234, v234, v117, v118
    v_mfma_f32_32x32x16_bf16 v[0:15], a[208:211], v[148:151], v[0:15]
    s_waitcnt lgkmcnt(5)
    ds_read_b128 a[228:231], v201 offset:0
    v_add_f32 v232, v232, v107
    v_add_f32 v232, v232, v108
    v_max3_f32 v234, v234, v119, v120
    v_max3_f32 v234, v234, v121, v122
    v_mfma_f32_32x32x16_bf16 v[16:31], a[212:215], v[148:151], v[16:31]
    s_waitcnt lgkmcnt(4)
    ds_read_b128 a[232:235], v202 offset:0
    v_add_f32 v232, v232, v109
    v_add_f32 v232, v232, v110
    v_max3_f32 v234, v234, v123, v124
    v_max3_f32 v234, v234, v125, v126
    v_mfma_f32_32x32x16_bf16 v[32:47], a[216:219], v[148:151], v[32:47]
    s_waitcnt lgkmcnt(3)
    ds_read_b128 a[236:239], v203 offset:0
    v_add_f32 v232, v232, v111
    v_max_f32 v234, v234, v127
    v_cmp_lt_f32 vcc, 0x41000000, v234
    v_exp_f32 v152, v152
    v_mfma_f32_32x32x16_bf16 v[48:63], a[220:223], v[148:151], v[48:63]
    s_waitcnt lgkmcnt(3)
    ds_read_b128 a[240:243], v204 offset:0
    v_exp_f32 v153, v153
    v_add_f32 v233, v233, v152
    v_exp_f32 v154, v154
    s_cbranch_vccnz L_rare26
L_back26:
    v_exp_f32 v112, v112
    v_exp_f32 v113, v113
    v_mfma_f32_32x32x16_bf16 v[96:111], a[224:227], a[96:99], v[128:143]
    s_waitcnt lgkmcnt(3)
    ds_read_b128 a[244:247], v205 offset:0
    v_cvt_pk_bf16_f32 v144, v112, v113
    v_exp_f32 v114, v114
    v_exp_f32 v115, v115
    v_mfma_f32_32x32x16_bf16 v[96:111], a[228:231], a[100:103], v[96:111]
    s_waitcnt lgkmcnt(3)
    ds_read_b128 a[248:251], v206 offset:0
    s_add_u32 m0, s43, 81920
    s_add_u32 s46, s52, 81920
    v_cvt_pk_bf16_f32 v145, v114, v115
    v_exp_f32 v116, v116
    v_exp_f32 v117, v117
    v_mfma_f32_32x32x16_bf16 v[96:111], a[232:235], a[104:107], v[96:111]
    s_waitcnt lgkmcnt(3)
    ds_read_b128 a[252:255], v207 offset:0
    buffer_load_dwordx4 v228, s[16:19], s46 offen nt lds
    v_cvt_pk_bf16_f32 v146, v116, v117
    v_exp_f32 v118, v118
    v_exp_f32 v119, v119
    v_mfma_f32_32x32x16_bf16 v[96:111], a[236:239], a[108:111], v[96:111]
    s_waitcnt lgkmcnt(3)
    ds_read_b64_tr_b16 a[208:209], v216 offset:32768
    ds_read_b64_tr_b16 a[210:211], v216 offset:36864
    ds_read_b64_tr_b16 a[212:213], v217 offset:32768
    ds_read_b64_tr_b16 a[214:215], v217 offset:36864
    v_cvt_pk_bf16_f32 v147, v118, v119
    v_exp_f32 v120, v120
    v_add_f32 v232, v232, v112
    v_mfma_f32_32x32x16_bf16 v[96:111], a[240:243], a[112:115], v[96:111]
    s_waitcnt lgkmcnt(6)
    ds_read_b64_tr_b16 a[216:217], v218 offset:32768
    ds_read_b64_tr_b16 a[218:219], v218 offset:36864
    ds_read_b64_tr_b16 a[220:221], v219 offset:32768
    ds_read_b64_tr_b16 a[222:223], v219 offset:36864
    buffer_load_dwordx4 v229, s[16:19], s46 offen offset:1024 nt lds
    v_exp_f32 v121, v121
    v_add_f32 v232, v232, v113
    v_mfma_f32_32x32x16_bf16 v[96:111], a[244:247], a[116:119], v[96:111]
    s_waitcnt lgkmcnt(9)
    ds_read_b64_tr_b16 a[224:225], v220 offset:32768
    ds_read_b64_tr_b16 a[226:227], v220 offset:36864
    ds_read_b64_tr_b16 a[228:229], v221 offset:32768
    ds_read_b64_tr_b16 a[230:231], v221 offset:36864
    v_cvt_pk_bf16_f32 v148, v120, v121
    v_exp_f32 v122, v122
    v_add_f32 v232, v232, v114
    v_mfma_f32_32x32x16_bf16 v[96:111], a[248:251], a[120:123], v[96:111]
    s_waitcnt lgkmcnt(12)
    ds_read_b64_tr_b16 a[232:233], v222 offset:32768
    ds_read_b64_tr_b16 a[234:235], v222 offset:36864
    ds_read_b64_tr_b16 a[236:237], v223 offset:32768
    ds_read_b64_tr_b16 a[238:239], v223 offset:36864
    buffer_load_dwordx4 v228, s[16:19], s46 offen offset:2048 nt lds
    v_exp_f32 v123, v123
    v_add_f32 v232, v232, v115
    v_add_f32 v232, v232, v116
    v_exp_f32 v155, v155
    v_exp_f32 v156, v156
    v_exp_f32 v157, v157
    v_exp_f32 v158, v158
    v_exp_f32 v159, v159
    v_mfma_f32_32x32x16_bf16 v[96:111], a[252:255], a[124:127], v[96:111]
    s_waitcnt lgkmcnt(14)
    ds_read_b64_tr_b16 a[240:241], v208 offset:57344
    ds_read_b64_tr_b16 a[242:243], v208 offset:59392
    v_cvt_pk_bf16_f32 v149, v122, v123
    v_exp_f32 v124, v124
    v_add_f32 v232, v232, v117
    v_cvt_pk_bf16_f32 v164, v152, v153
    v_cvt_pk_bf16_f32 v165, v154, v155
    v_cvt_pk_bf16_f32 v166, v156, v157
    v_cvt_pk_bf16_f32 v167, v158, v159
    s_nop 1
    v_mfma_f32_16x16x32_bf16 v[64:67], a[208:211], v[164:167], v[64:67]
    s_waitcnt lgkmcnt(14)
    ds_read_b64_tr_b16 a[244:245], v209 offset:57344
    ds_read_b64_tr_b16 a[246:247], v209 offset:59392
    v_mfma_f32_16x16x32_bf16 v[68:71], a[212:215], v[164:167], v[68:71]
    s_waitcnt lgkmcnt(14)
    v_add_f32 v233, v233, v153
    v_add_f32 v233, v233, v154
    v_mfma_f32_16x16x32_bf16 v[72:75], a[216:219], v[164:167], v[72:75]
    s_waitcnt lgkmcnt(12)
    ds_read_b64_tr_b16 a[248:249], v210 offset:57344
    ds_read_b64_tr_b16 a[250:251], v210 offset:59392
    v_mfma_f32_16x16x32_bf16 v[76:79], a[220:223], v[164:167], v[76:79]
    s_waitcnt lgkmcnt(12)
    v_add_f32 v233, v233, v155
    v_add_f32 v233, v233, v156
    v_mfma_f32_16x16x32_bf16 v[80:83], a[224:227], v[164:167], v[80:83]
    s_waitcnt lgkmcnt(10)
    ds_read_b64_tr_b16 a[252:253], v211 offset:57344
    ds_read_b64_tr_b16 a[254:255], v211 offset:59392
    v_mfma_f32_16x16x32_bf16 v[84:87], a[228:231], v[164:167], v[84:87]
    s_waitcnt lgkmcnt(10)
    v_add_f32 v233, v233, v157
    v_add_f32 v233, v233, v158
    v_mfma_f32_16x16x32_bf16 v[88:91], a[232:235], v[164:167], v[88:91]
    s_waitcnt lgkmcnt(8)
    ds_read_b64_tr_b16 a[208:209], v208 offset:61440
    ds_read_b64_tr_b16 a[210:211], v208 offset:63488
    v_mfma_f32_16x16x32_bf16 v[92:95], a[236:239], v[164:167], v[92:95]
    s_waitcnt lgkmcnt(8)
    v_add_f32 v233, v233, v159
    v_mfma_f32_32x32x16_bf16 v[0:15], a[240:243], v[144:147], v[0:15]
    s_waitcnt lgkmcnt(6)
    ds_read_b64_tr_b16 a[212:213], v209 offset:61440
    ds_read_b64_tr_b16 a[214:215], v209 offset:63488
    buffer_load_dwordx4 v229, s[16:19], s46 offen offset:3072 nt lds
    v_exp_f32 v125, v125
    v_add_f32 v232, v232, v118
    v_mfma_f32_32x32x16_bf16 v[16:31], a[244:247], v[144:147], v[16:31]
    s_waitcnt lgkmcnt(6)
    ds_read_b64_tr_b16 a[216:217], v210 offset:61440
    ds_read_b64_tr_b16 a[218:219], v210 offset:63488
    v_cvt_pk_bf16_f32 v150, v124, v125
    v_exp_f32 v126, v126
    v_add_f32 v232, v232, v119
    v_mfma_f32_32x32x16_bf16 v[32:47], a[248:251], v[144:147], v[32:47]
    s_waitcnt lgkmcnt(6)
    ds_read_b64_tr_b16 a[220:221], v211 offset:61440
    ds_read_b64_tr_b16 a[222:223], v211 offset:63488
    v_exp_f32 v127, v127
    v_add_f32 v232, v232, v120
    v_max3_f32 v234, v96, v97, v98
    v_mfma_f32_32x32x16_bf16 v[48:63], a[252:255], v[144:147], v[48:63]
    s_waitcnt lgkmcnt(6)
    ds_read_b128 a[224:227], v200 offset:8192
    v_cvt_pk_bf16_f32 v151, v126, v127
    v_add_f32 v232, v232, v121
    v_add_f32 v232, v232, v122
    v_max3_f32 v234, v234, v99, v100
    v_max3_f32 v234, v234, v101, v102
    v_mfma_f32_32x32x16_bf16 v[0:15], a[208:211], v[148:151], v[0:15]
    s_waitcnt lgkmcnt(5)
    ds_read_b128 a[228:231], v201 offset:8192
    v_add_f32 v232, v232, v123
    v_add_f32 v232, v232, v124
    v_max3_f32 v234, v234, v103, v104
    v_max3_f32 v234, v234, v105, v106
    v_mfma_f32_32x32x16_bf16 v[16:31], a[212:215], v[148:151], v[16:31]
    s_waitcnt lgkmcnt(4)
    ds_read_b128 a[232:235], v202 offset:8192
    v_add_f32 v232, v232, v125
    v_add_f32 v232, v232, v126
    v_max3_f32 v234, v234, v107, v108
    v_max3_f32 v234, v234, v109, v110
    v_mfma_f32_32x32x16_bf16 v[32:47], a[216:219], v[148:151], v[32:47]
    s_waitcnt lgkmcnt(3)
    ds_read_b128 a[236:239], v203 offset:8192
    v_add_f32 v232, v232, v127
    v_max_f32 v234, v234, v111
    v_cmp_lt_f32 vcc, 0x41000000, v234
    v_mfma_f32_32x32x16_bf16 v[48:63], a[220:223], v[148:151], v[48:63]
    s_waitcnt lgkmcnt(3)
    ds_read_b128 a[240:243], v204 offset:8192
    s_cbranch_vccnz L_rare27
L_back27:
    v_exp_f32 v96, v96
    v_exp_f32 v97, v97
    v_mfma_f32_32x32x16_bf16 v[112:127], a[224:227], a[96:99], v[128:143]
    s_waitcnt lgkmcnt(3)
    ds_read_b128 a[244:247], v205 offset:8192
    v_cvt_pk_bf16_f32 v144, v96, v97
    v_exp_f32 v98, v98
    v_exp_f32 v99, v99
    v_mfma_f32_32x32x16_bf16 v[112:127], a[228:231], a[100:103], v[112:127]
    s_waitcnt lgkmcnt(3)
    ds_read_b128 a[248:251], v206 offset:8192
    v_cvt_pk_bf16_f32 v145, v98, v99
    v_exp_f32 v100, v100
    v_exp_f32 v101, v101
    s_waitcnt vmcnt(9)
    s_barrier
L_ih12:
    s_add_u32 m0, s43, 49152
    s_add_u32 s45, s52, 114688
    v_mfma_f32_32x32x16_bf16 v[112:127], a[232:235], a[104:107], v[112:127]
    s_waitcnt lgkmcnt(3)
    ds_read_b128 a[252:255], v207 offset:8192
    buffer_load_dwordx4 v224, s[12:15], s45 offen nt lds
    v_cvt_pk_bf16_f32 v146, v100, v101
    v_exp_f32 v102, v102
    v_exp_f32 v103, v103
    v_and_b32 v238, 112, v244
    v_lshl_add_u32 v238, v238, 3, s44
    v_mfma_f32_32x32x16_bf16 v[112:127], a[236:239], a[108:111], v[112:127]
    s_waitcnt lgkmcnt(3)
    ds_read_b64_tr_b16 a[208:209], v208 offset:0
    ds_read_b64_tr_b16 a[210:211], v208 offset:2048
    v_cvt_pk_bf16_f32 v147, v102, v103
    v_exp_f32 v104, v104
    v_add_f32 v232, v232, v96
    v_add_u32 v238, L_ih14 - L_ibase, v238
    v_min_u32 v238, L_end - L_ibase - 64, v238
    v_mfma_f32_32x32x16_bf16 v[112:127], a[240:243], a[112:115], v[112:127]
    s_waitcnt lgkmcnt(4)
    ds_read_b64_tr_b16 a[212:213], v209 offset:0
    ds_read_b64_tr_b16 a[214:215], v209 offset:2048
    buffer_load_dwordx4 v225, s[12:15], s45 offen offset:1024 nt lds
    v_exp_f32 v105, v105
    v_add_f32 v232, v232, v97
    v_mfma_f32_32x32x16_bf16 v[112:127], a[244:247], a[116:119], v[112:127]
    s_waitcnt lgkmcnt(5)
    global_load_dword a140, v238, s[90:91]
    ds_read_b64_tr_b16 a[216:217], v210 offset:0
    ds_read_b64_tr_b16 a[218:219], v210 offset:2048
    v_cvt_pk_bf16_f32 v148, v104, v105
    v_exp_f32 v106, v106
    v_add_f32 v232, v232, v98
    v_mfma_f32_32x32x16_bf16 v[112:127], a[248:251], a[120:123], v[112:127]
    s_waitcnt lgkmcnt(6)
    ds_read_b64_tr_b16 a[220:221], v211 offset:0
    ds_read_b64_tr_b16 a[222:223], v211 offset:2048
    buffer_load_dwordx4 v226, s[12:15], s45 offen offset:2048 nt lds
    v_exp_f32 v107, v107
    v_add_f32 v232, v232, v99
    v_add_f32 v232, v232, v100
    v_mfma_f32_32x32x16_bf16 v[112:127], a[252:255], a[124:127], v[112:127]
    s_waitcnt lgkmcnt(6)
    ds_read_b64_tr_b16 a[224:225], v208 offset:4096
    ds_read_b64_tr_b16 a[226:227], v208 offset:6144
    v_cvt_pk_bf16_f32 v149, v106, v107
    v_exp_f32 v108, v108
    v_add_f32 v232, v232, v101
    v_mfma_f32_32x32x16_bf16 v[0:15], a[208:211], v[144:147], v[0:15]
    s_waitcnt lgkmcnt(6)
    ds_read_b64_tr_b16 a[228:229], v209 offset:4096
    ds_read_b64_tr_b16 a[230:231], v209 offset:6144
    buffer_load_dwordx4 v227, s[12:15], s45 offen offset:3072 nt lds
    v_exp_f32 v109, v109
    v_add_f32 v232, v232, v102
    v_mfma_f32_32x32x16_bf16 v[16:31], a[212:215], v[144:147], v[16:31]
    s_waitcnt lgkmcnt(6)
    ds_read_b64_tr_b16 a[232:233], v210 offset:4096
    ds_read_b64_tr_b16 a[234:235], v210 offset:6144
    v_cvt_pk_bf16_f32 v150, v108, v109
    v_exp_f32 v110, v110
    v_add_f32 v232, v232, v103
    v_mfma_f32_32x32x16_bf16 v[32:47], a[216:219], v[144:147], v[32:47]
    s_waitcnt lgkmcnt(6)
    ds_read_b64_tr_b16 a[236:237], v211 offset:4096
    ds_read_b64_tr_b16 a[238:239], v211 offset:6144
    v_exp_f32 v111, v111
    v_add_f32 v232, v232, v104
    v_max3_f32 v234, v112, v113, v114
    v_mfma_f32_32x32x16_bf16 v[48:63], a[220:223], v[144:147], v[48:63]
    s_waitcnt lgkmcnt(6)
    ds_read_b128 a[240:243], v200 offset:16384
    v_cvt_pk_bf16_f32 v151, v110, v111
    v_add_f32 v232, v232, v105
    v_add_f32 v232, v232, v106
    v_max3_f32 v234, v234, v115, v116
    v_max3_f32 v234, v234, v117, v118
    v_mfma_f32_32x32x16_bf16 v[0:15], a[224:227], v[148:151], v[0:15]
    s_waitcnt lgkmcnt(5)
    ds_read_b128 a[244:247], v201 offset:16384
    v_add_f32 v232, v232, v107
    v_add_f32 v232, v232, v108
    v_max3_f32 v234, v234, v119, v120
    v_max3_f32 v234, v234, v121, v122
    v_mfma_f32_32x32x16_bf16 v[16:31], a[228:231], v[148:151], v[16:31]
    s_waitcnt lgkmcnt(4)
    ds_read_b128 a[248:251], v202 offset:16384
    v_add_f32 v232, v232, v109
    v_add_f32 v232, v232, v110
    v_max3_f32 v234, v234, v123, v124
    v_max3_f32 v234, v234, v125, v126
    v_mfma_f32_32x32x16_bf16 v[32:47], a[232:235], v[148:151], v[32:47]
    s_waitcnt lgkmcnt(3)
    ds_read_b128 a[252:255], v203 offset:16384
    v_add_f32 v232, v232, v111
    v_max_f32 v234, v234, v127
    v_cmp_lt_f32 vcc, 0x41000000, v234
    v_mfma_f32_32x32x16_bf16 v[48:63], a[236:239], v[148:151], v[48:63]
    s_waitcnt lgkmcnt(3)
    ds_read_b128 a[208:211], v204 offset:16384
    s_cbranch_vccnz L_rare28
L_back28:
    v_exp_f32 v112, v112
    v_exp_f32 v113, v113
    v_mfma_f32_32x32x16_bf16 v[96:111], a[240:243], a[96:99], v[128:143]
    s_waitcnt lgkmcnt(3)
    ds_read_b128 a[212:215], v205 offset:16384
    v_cvt_pk_bf16_f32 v144, v112, v113
    v_exp_f32 v114, v114
    v_exp_f32 v115, v115
    v_mfma_f32_32x32x16_bf16 v[96:111], a[244:247], a[100:103], v[96:111]
    s_waitcnt lgkmcnt(3)
    ds_read_b128 a[216:219], v206 offset:16384
    s_add_u32 m0, s43, 98304
    s_add_u32 s46, s52, 98304
    v_cvt_pk_bf16_f32 v145, v114, v115
    v_exp_f32 v116, v116
    v_exp_f32 v117, v117
    v_mfma_f32_32x32x16_bf16 v[96:111], a[248:251], a[104:107], v[96:111]
    s_waitcnt lgkmcnt(3)
    ds_read_b128 a[220:223], v207 offset:16384
    buffer_load_dwordx4 v228, s[16:19], s46 offen nt lds
    v_cvt_pk_bf16_f32 v146, v116, v117
    v_exp_f32 v118, v118
    v_exp_f32 v119, v119
    v_mfma_f32_32x32x16_bf16 v[96:111], a[252:255], a[108:111], v[96:111]
    s_waitcnt lgkmcnt(3)
    ds_read_b64_tr_b16 a[224:225], v208 offset:8192
    ds_read_b64_tr_b16 a[226:227], v208 offset:10240
    v_cvt_pk_bf16_f32 v147, v118, v119
    v_exp_f32 v120, v120
    v_add_f32 v232, v232, v112
    v_mfma_f32_32x32x16_bf16 v[96:111], a[208:211], a[112:115], v[96:111]
    s_waitcnt lgkmcnt(4)
    ds_read_b64_tr_b16 a[228:229], v209 offset:8192
    ds_read_b64_tr_b16 a[230:231], v209 offset:10240
    buffer_load_dwordx4 v229, s[16:19], s46 offen offset:1024 nt lds
    v_exp_f32 v121, v121
    v_add_f32 v232, v232, v113
    v_mfma_f32_32x32x16_bf16 v[96:111], a[212:215], a[116:119], v[96:111]
    s_waitcnt lgkmcnt(5)
    ds_read_b64_tr_b16 a[232:233], v210 offset:8192
    ds_read_b64_tr_b16 a[234:235], v210 offset:10240
    v_cvt_pk_bf16_f32 v148, v120, v121
    v_exp_f32 v122, v122
    v_add_f32 v232, v232, v114
    v_mfma_f32_32x32x16_bf16 v[96:111], a[216:219], a[120:123], v[96:111]
    s_waitcnt lgkmcnt(6)
    ds_read_b64_tr_b16 a[236:237], v211 offset:8192
    ds_read_b64_tr_b16 a[238:239], v211 offset:10240
    buffer_load_dwordx4 v228, s[16:19], s46 offen offset:2048 nt lds
    v_exp_f32 v123, v123
    v_add_f32 v232, v232, v115
    v_add_f32 v232, v232, v116
    v_mfma_f32_32x32x16_bf16 v[96:111], a[220:223], a[124:127], v[96:111]
    s_waitcnt lgkmcnt(6)
    ds_read_b64_tr_b16 a[240:241], v208 offset:12288
    ds_read_b64_tr_b16 a[242:243], v208 offset:14336
    v_cvt_pk_bf16_f32 v149, v122, v123
    v_exp_f32 v124, v124
    v_add_f32 v232, v232, v117
    v_mfma_f32_32x32x16_bf16 v[0:15], a[224:227], v[144:147], v[0:15]
    s_waitcnt lgkmcnt(6)
    ds_read_b64_tr_b16 a[244:245], v209 offset:12288
    ds_read_b64_tr_b16 a[246:247], v209 offset:14336
    buffer_load_dwordx4 v229, s[16:19], s46 offen offset:3072 nt lds
    v_exp_f32 v125, v125
    v_add_f32 v232, v232, v118
    v_mfma_f32_32x32x16_bf16 v[16:31], a[228:231], v[144:147], v[16:31]
    s_waitcnt lgkmcnt(6)
    ds_read_b64_tr_b16 a[248:249], v210 offset:12288
    ds_read_b64_tr_b16 a[250:251], v210 offset:14336
    v_cvt_pk_bf16_f32 v150, v124, v125
    v_exp_f32 v126, v126
    v_add_f32 v232, v232, v119
    v_mfma_f32_32x32x16_bf16 v[32:47], a[232:235], v[144:147], v[32:47]
    s_waitcnt lgkmcnt(6)
    ds_read_b64_tr_b16 a[252:253], v211 offset:12288
    ds_read_b64_tr_b16 a[254:255], v211 offset:14336
    v_exp_f32 v127, v127
    v_add_f32 v232, v232, v120
    v_max3_f32 v234, v96, v97, v98
    v_mfma_f32_32x32x16_bf16 v[48:63], a[236:239], v[144:147], v[48:63]
    s_waitcnt lgkmcnt(6)
    ds_read_b128 a[208:211], v212 offset:0
    ds_read_b128 a[212:215], v213 offset:0
    v_cvt_pk_bf16_f32 v151, v126, v127
    v_add_f32 v232, v232, v121
    v_add_f32 v232, v232, v122
    v_max3_f32 v234, v234, v99, v100
    v_max3_f32 v234, v234, v101, v102
    v_mfma_f32_32x32x16_bf16 v[0:15], a[240:243], v[148:151], v[0:15]
    s_waitcnt lgkmcnt(6)
    ds_read_b128 a[216:219], v214 offset:0
    ds_read_b128 a[220:223], v215 offset:0
    v_add_f32 v232, v232, v123
    v_add_f32 v232, v232, v124
    v_max3_f32 v234, v234, v103, v104
    v_max3_f32 v234, v234, v105, v106
    v_mfma_f32_32x32x16_bf16 v[16:31], a[244:247], v[148:151], v[16:31]
    s_waitcnt lgkmcnt(6)
    ds_read_b128 a[224:227], v212 offset:4096
    ds_read_b128 a[228:231], v213 offset:4096
    v_add_f32 v232, v232, v125
    v_add_f32 v232, v232, v126
    v_max3_f32 v234, v234, v107, v108
    v_max3_f32 v234, v234, v109, v110
    v_mfma_f32_32x32x16_bf16 v[32:47], a[248:251], v[148:151], v[32:47]
    s_waitcnt lgkmcnt(6)
    ds_read_b128 a[232:235], v214 offset:4096
    ds_read_b128 a[236:239], v215 offset:4096
    v_add_f32 v232, v232, v127
    v_max_f32 v234, v234, v111
    v_cmp_lt_f32 vcc, 0x41000000, v234
    v_mfma_f32_32x32x16_bf16 v[48:63], a[252:255], v[148:151], v[48:63]
    s_waitcnt lgkmcnt(7)
    ds_read_b128 a[240:243], v200 offset:24576
    s_cbranch_vccnz L_rare29
L_back29:
    v_mfma_f32_16x16x32_bf16 v[152:155], a[208:211], a[176:179], v[160:163]
    s_waitcnt lgkmcnt(7)
    ds_read_b128 a[244:247], v201 offset:24576
    v_mfma_f32_16x16x32_bf16 v[152:155], a[212:215], a[180:183], v[152:155]
    s_waitcnt lgkmcnt(7)
    v_mfma_f32_16x16x32_bf16 v[152:155], a[216:219], a[184:187], v[152:155]
    s_waitcnt lgkmcnt(6)
    ds_read_b128 a[248:251], v202 offset:24576
    v_mfma_f32_16x16x32_bf16 v[152:155], a[220:223], a[188:191], v[152:155]
    s_waitcnt lgkmcnt(6)
    v_mfma_f32_16x16x32_bf16 v[156:159], a[224:227], a[176:179], v[160:163]
    s_waitcnt lgkmcnt(5)
    ds_read_b128 a[252:255], v203 offset:24576
    v_mfma_f32_16x16x32_bf16 v[156:159], a[228:231], a[180:183], v[156:159]
    s_waitcnt lgkmcnt(5)
    v_mfma_f32_16x16x32_bf16 v[156:159], a[232:235], a[184:187], v[156:159]
    s_waitcnt lgkmcnt(4)
    ds_read_b128 a[208:211], v204 offset:24576
    v_mfma_f32_16x16x32_bf16 v[156:159], a[236:239], a[188:191], v[156:159]
    s_waitcnt lgkmcnt(4)
    v_exp_f32 v96, v96
    v_exp_f32 v97, v97
    v_mfma_f32_32x32x16_bf16 v[112:127], a[240:243], a[96:99], v[128:143]
    s_waitcnt lgkmcnt(3)
    ds_read_b128 a[212:215], v205 offset:24576
    v_cvt_pk_bf16_f32 v144, v96, v97
    v_exp_f32 v98, v98
    v_exp_f32 v99, v99
    v_mfma_f32_32x32x16_bf16 v[112:127], a[244:247], a[100:103], v[112:127]
    s_waitcnt lgkmcnt(3)
    ds_read_b128 a[216:219], v206 offset:24576
    v_cvt_pk_bf16_f32 v145, v98, v99
    v_exp_f32 v100, v100
    v_exp_f32 v101, v101
    s_waitcnt vmcnt(9)
    s_barrier
L_ih13:
    v_mfma_f32_32x32x16_bf16 v[112:127], a[248:251], a[104:107], v[112:127]
    s_waitcnt lgkmcnt(3)
    ds_read_b128 a[220:223], v207 offset:24576
    s_add_u32 m0, s44, 0
    s_add_u32 s55, s64, 0
    buffer_load_dwordx4 v230, s[28:31], s55 offen lds
    v_cvt_pk_bf16_f32 v146, v100, v101
    v_exp_f32 v102, v102
    v_exp_f32 v103, v103
    v_and_b32 v238, 112, v244
    v_lshl_add_u32 v238, v238, 3, s44
    v_mfma_f32_32x32x16_bf16 v[112:127], a[252:255], a[108:111], v[112:127]
    s_waitcnt lgkmcnt(3)
    ds_read_b64_tr_b16 a[224:225], v208 offset:16384
    ds_read_b64_tr_b16 a[226:227], v208 offset:18432
    v_cvt_pk_bf16_f32 v147, v102, v103
    v_exp_f32 v104, v104
    v_add_f32 v232, v232, v96
    v_add_u32 v238, L_ih15 - L_ibase, v238
    v_min_u32 v238, L_end - L_ibase - 64, v238
    v_mfma_f32_32x32x16_bf16 v[112:127], a[208:211], a[112:115], v[112:127]
    s_waitcnt lgkmcnt(4)
    ds_read_b64_tr_b16 a[228:229], v209 offset:16384
    ds_read_b64_tr_b16 a[230:231], v209 offset:18432
    v_exp_f32 v105, v105
    v_add_f32 v232, v232, v97
    v_max3_f32 v235, v152, v153, v154
    v_mfma_f32_32x32x16_bf16 v[112:127], a[212:215], a[116:119], v[112:127]
    s_waitcnt lgkmcnt(5)
    global_load_dword a140, v238, s[90:91]
    ds_read_b64_tr_b16 a[232:233], v210 offset:16384
    ds_read_b64_tr_b16 a[234:235], v210 offset:18432
    v_cvt_pk_bf16_f32 v148, v104, v105
    v_exp_f32 v106, v106
    v_add_f32 v232, v232, v98
    v_mfma_f32_32x32x16_bf16 v[112:127], a[216:219], a[120:123], v[112:127]
    s_waitcnt lgkmcnt(6)
    ds_read_b64_tr_b16 a[236:237], v211 offset:16384
    ds_read_b64_tr_b16 a[238:239], v211 offset:18432
    s_add_u32 m0, s44, 4096
    s_add_u32 s55, s64, 16384
    buffer_load_dwordx4 v230, s[28:31], s55 offen lds
    v_exp_f32 v107, v107
    v_add_f32 v232, v232, v99
    v_add_f32 v232, v232, v100
    v_mfma_f32_32x32x16_bf16 v[112:127], a[220:223], a[124:127], v[112:127]
    s_waitcnt lgkmcnt(6)
    ds_read_b64_tr_b16 a[240:241], v208 offset:20480
    ds_read_b64_tr_b16 a[242:243], v208 offset:22528
    v_cvt_pk_bf16_f32 v149, v106, v107
    v_exp_f32 v108, v108
    v_add_f32 v232, v232, v101
    v_max3_f32 v235, v235, v155, v156
    v_max3_f32 v235, v235, v157, v158
    v_max_f32 v235, v235, v159
    v_cmp_lt_f32 vcc, 0x41000000, v235
    s_nop 1
    s_cbranch_vccnz L_rare30
L_back30:
    v_mfma_f32_32x32x16_bf16 v[0:15], a[224:227], v[144:147], v[0:15]
    s_waitcnt lgkmcnt(6)
    ds_read_b64_tr_b16 a[244:245], v209 offset:20480
    ds_read_b64_tr_b16 a[246:247], v209 offset:22528
    v_exp_f32 v109, v109
    v_add_f32 v232, v232, v102
    v_mfma_f32_32x32x16_bf16 v[16:31], a[228:231], v[144:147], v[16:31]
    s_waitcnt lgkmcnt(6)
    ds_read_b64_tr_b16 a[248:249], v210 offset:20480
    ds_read_b64_tr_b16 a[250:251], v210 offset:22528
    s_add_u32 s74, s56, 0
    buffer_store_dwordx4 a[0:3], v252, s[24:27], s74 offen sc1
    v_cvt_pk_bf16_f32 v150, v108, v109
    v_exp_f32 v110, v110
    v_add_f32 v232, v232, v103
    v_mfma_f32_32x32x16_bf16 v[32:47], a[232:235], v[144:147], v[32:47]
    s_waitcnt lgkmcnt(6)
    ds_read_b64_tr_b16 a[252:253], v211 offset:20480
    ds_read_b64_tr_b16 a[254:255], v211 offset:22528
    s_add_u32 m0, s44, 8192
    s_add_u32 s55, s64, 32768
    buffer_load_dwordx4 v230, s[28:31], s55 offen lds
    v_exp_f32 v111, v111
    v_add_f32 v232, v232, v104
    v_max3_f32 v234, v112, v113, v114
    v_mfma_f32_32x32x16_bf16 v[48:63], a[236:239], v[144:147], v[48:63]
    s_waitcnt lgkmcnt(6)
    buffer_store_dwordx4 a[4:7], v252, s[24:27], s74 offen offset:1024 sc1
    ds_read_b128 a[208:211], v200 offset:32768
    v_cvt_pk_bf16_f32 v151, v110, v111
    v_add_f32 v232, v232, v105
    v_add_f32 v232, v232, v106
    v_max3_f32 v234, v234, v115, v116
    v_max3_f32 v234, v234, v117, v118
    v_mfma_f32_32x32x16_bf16 v[0:15], a[240:243], v[148:151], v[0:15]
    s_waitcnt lgkmcnt(5)
    ds_read_b128 a[212:215], v201 offset:32768
    v_add_f32 v232, v232, v107
    v_add_f32 v232, v232, v108
    v_max3_f32 v234, v234, v119, v120
    v_max3_f32 v234, v234, v121, v122
    v_mfma_f32_32x32x16_bf16 v[16:31], a[244:247], v[148:151], v[16:31]
    s_waitcnt lgkmcnt(4)
    buffer_store_dwordx4 a[8:11], v252, s[24:27], s74 offen offset:2048 sc1
    ds_read_b128 a[216:219], v202 offset:32768
    v_add_f32 v232, v232, v109
    v_add_f32 v232, v232, v110
    v_max3_f32 v234, v234, v123, v124
    v_max3_f32 v234, v234, v125, v126
    v_mfma_f32_32x32x16_bf16 v[32:47], a[248:251], v[148:151], v[32:47]
    s_waitcnt lgkmcnt(3)
    s_add_u32 m0, s44, 12288
    s_add_u32 s55, s64, 49152
    buffer_load_dwordx4 v230, s[28:31], s55 offen lds
    ds_read_b128 a[220:223], v203 offset:32768
    v_add_f32 v232, v232, v111
    v_max_f32 v234, v234, v127
    v_cmp_lt_f32 vcc, 0x41000000, v234
    v_mfma_f32_32x32x16_bf16 v[48:63], a[252:255], v[148:151], v[48:63]
    s_waitcnt lgkmcnt(3)
    buffer_store_dwordx4 a[12:15], v252, s[24:27], s74 offen offset:3072 sc1
    ds_read_b128 a[224:227], v204 offset:32768
    v_exp_f32 v152, v152
    v_exp_f32 v153, v153
    s_cbranch_vccnz L_rare31
L_back31:
    v_exp_f32 v112, v112
    v_exp_f32 v113, v113
    v_mfma_f32_32x32x16_bf16 v[96:111], a[208:211], a[96:99], v[128:143]
    s_waitcnt lgkmcnt(3)
    ds_read_b128 a[228:231], v205 offset:32768
    v_cvt_pk_bf16_f32 v144, v112, v113
    v_exp_f32 v114, v114
    v_exp_f32 v115, v115
    v_mfma_f32_32x32x16_bf16 v[96:111], a[212:215], a[100:103], v[96:111]
    s_waitcnt lgkmcnt(3)
    ds_read_b128 a[232:235], v206 offset:32768
    s_add_u32 m0, s43, 114688
    s_add_u32 s46, s52, 114688
    v_cvt_pk_bf16_f32 v145, v114, v115
    v_exp_f32 v116, v116
    v_exp_f32 v117, v117
    v_mfma_f32_32x32x16_bf16 v[96:111], a[216:219], a[104:107], v[96:111]
    s_waitcnt lgkmcnt(3)
    ds_read_b128 a[236:239], v207 offset:32768
    buffer_load_dwordx4 v228, s[16:19], s46 offen nt lds
    v_cvt_pk_bf16_f32 v146, v116, v117
    v_exp_f32 v118, v118
    v_exp_f32 v119, v119
    v_mfma_f32_32x32x16_bf16 v[96:111], a[220:223], a[108:111], v[96:111]
    s_waitcnt lgkmcnt(3)
    ds_read_b64_tr_b16 a[240:241], v216 offset:0
    ds_read_b64_tr_b16 a[242:243], v216 offset:4096
    ds_read_b64_tr_b16 a[244:245], v217 offset:0
    ds_read_b64_tr_b16 a[246:247], v217 offset:4096
    v_cvt_pk_bf16_f32 v147, v118, v119
    v_exp_f32 v120, v120
    v_add_f32 v232, v232, v112
    v_mfma_f32_32x32x16_bf16 v[96:111], a[224:227], a[112:115], v[96:111]
    s_waitcnt lgkmcnt(6)
    ds_read_b64_tr_b16 a[248:249], v218 offset:0
    ds_read_b64_tr_b16 a[250:251], v218 offset:4096
    ds_read_b64_tr_b16 a[252:253], v219 offset:0
    ds_read_b64_tr_b16 a[254:255], v219 offset:4096
    buffer_load_dwordx4 v229, s[16:19], s46 offen offset:1024 nt lds
    v_exp_f32 v121, v121
    v_add_f32 v232, v232, v113
    v_mfma_f32_32x32x16_bf16 v[96:111], a[228:231], a[116:119], v[96:111]
    s_waitcnt lgkmcnt(9)
    ds_read_b64_tr_b16 a[208:209], v220 offset:0
    ds_read_b64_tr_b16 a[210:211], v220 offset:4096
    ds_read_b64_tr_b16 a[212:213], v221 offset:0
    ds_read_b64_tr_b16 a[214:215], v221 offset:4096
    v_cvt_pk_bf16_f32 v148, v120, v121
    v_exp_f32 v122, v122
    v_add_f32 v232, v232, v114
    v_mfma_f32_32x32x16_bf16 v[96:111], a[232:235], a[120:123], v[96:111]
    s_waitcnt lgkmcnt(12)
    ds_read_b64_tr_b16 a[216:217], v222 offset:0
    ds_read_b64_tr_b16 a[218:219], v222 offset:4096
    ds_read_b64_tr_b16 a[220:221], v223 offset:0
    ds_read_b64_tr_b16 a[222:223], v223 offset:4096
    buffer_load_dwordx4 v228, s[16:19], s46 offen offset:2048 nt lds
    v_exp_f32 v123, v123
    v_add_f32 v232, v232, v115
    v_add_f32 v232, v232, v116
    v_exp_f32 v154, v154
    v_exp_f32 v155, v155
    v_exp_f32 v156, v156
    v_exp_f32 v157, v157
    v_exp_f32 v158, v158
    v_exp_f32 v159, v159
    v_mfma_f32_32x32x16_bf16 v[96:111], a[236:239], a[124:127], v[96:111]
    s_waitcnt lgkmcnt(14)
    ds_read_b64_tr_b16 a[224:225], v208 offset:24576
    ds_read_b64_tr_b16 a[226:227], v208 offset:26624
    v_cvt_pk_bf16_f32 v149, v122, v123
    v_exp_f32 v124, v124
    v_add_f32 v232, v232, v117
    v_cvt_pk_bf16_f32 v164, v152, v153
    v_cvt_pk_bf16_f32 v165, v154, v155
    v_cvt_pk_bf16_f32 v166, v156, v157
    v_cvt_pk_bf16_f32 v167, v158, v159
    s_nop 1
    v_mfma_f32_16x16x32_bf16 v[64:67], a[240:243], v[164:167], v[64:67]
    s_waitcnt lgkmcnt(14)
    ds_read_b64_tr_b16 a[228:229], v209 offset:24576
    ds_read_b64_tr_b16 a[230:231], v209 offset:26624
    v_mfma_f32_16x16x32_bf16 v[68:71], a[244:247], v[164:167], v[68:71]
    s_waitcnt lgkmcnt(14)
    v_add_f32 v233, v233, v152
    v_add_f32 v233, v233, v153
    v_mfma_f32_16x16x32_bf16 v[72:75], a[248:251], v[164:167], v[72:75]
    s_waitcnt lgkmcnt(12)
    ds_read_b64_tr_b16 a[232:233], v210 offset:24576
    ds_read_b64_tr_b16 a[234:235], v210 offset:26624
    v_mfma_f32_16x16x32_bf16 v[76:79], a[252:255], v[164:167], v[76:79]
    s_waitcnt lgkmcnt(12)
    v_add_f32 v233, v233, v154
    v_add_f32 v233, v233, v155
    v_mfma_f32_16x16x32_bf16 v[80:83], a[208:211], v[164:167], v[80:83]
    s_waitcnt lgkmcnt(10)
    ds_read_b64_tr_b16 a[236:237], v211 offset:24576
    ds_read_b64_tr_b16 a[238:239], v211 offset:26624
    v_mfma_f32_16x16x32_bf16 v[84:87], a[212:215], v[164:167], v[84:87]
    s_waitcnt lgkmcnt(10)
    v_add_f32 v233, v233, v156
    v_add_f32 v233, v233, v157
    v_mfma_f32_16x16x32_bf16 v[88:91], a[216:219], v[164:167], v[88:91]
    s_waitcnt lgkmcnt(8)
    ds_read_b64_tr_b16 a[240:241], v208 offset:28672
    ds_read_b64_tr_b16 a[242:243], v208 offset:30720
    v_mfma_f32_16x16x32_bf16 v[92:95], a[220:223], v[164:167], v[92:95]
    s_waitcnt lgkmcnt(8)
    v_add_f32 v233, v233, v158
    v_add_f32 v233, v233, v159
    v_mfma_f32_32x32x16_bf16 v[0:15], a[224:227], v[144:147], v[0:15]
    s_waitcnt lgkmcnt(6)
    ds_read_b64_tr_b16 a[244:245], v209 offset:28672
    ds_read_b64_tr_b16 a[246:247], v209 offset:30720
    buffer_load_dwordx4 v229, s[16:19], s46 offen offset:3072 nt lds
    v_exp_f32 v125, v125
    v_add_f32 v232, v232, v118
    v_mfma_f32_32x32x16_bf16 v[16:31], a[228:231], v[144:147], v[16:31]
    s_waitcnt lgkmcnt(6)
    ds_read_b64_tr_b16 a[248:249], v210 offset:28672
    ds_read_b64_tr_b16 a[250:251], v210 offset:30720
    s_add_u32 s74, s56, 4096
    buffer_store_dwordx4 a[16:19], v252, s[24:27], s74 offen sc1
    v_cvt_pk_bf16_f32 v150, v124, v125
    v_exp_f32 v126, v126
    v_add_f32 v232, v232, v119
    v_add_u32 v224, 65536, v246
    v_add_u32 v225, 65536, v247
    v_add_u32 v226, 65536, v248
    v_add_u32 v227, 65536, v249
    v_mfma_f32_32x32x16_bf16 v[32:47], a[232:235], v[144:147], v[32:47]
    s_waitcnt lgkmcnt(6)
    ds_read_b64_tr_b16 a[252:253], v211 offset:28672
    ds_read_b64_tr_b16 a[254:255], v211 offset:30720
    v_exp_f32 v127, v127
    v_add_f32 v232, v232, v120
    v_max3_f32 v234, v96, v97, v98
    v_add_u32 v228, 65536, v250
    v_add_u32 v229, 65536, v251
    v_mfma_f32_32x32x16_bf16 v[48:63], a[236:239], v[144:147], v[48:63]
    s_waitcnt lgkmcnt(6)
    buffer_store_dwordx4 a[20:23], v252, s[24:27], s74 offen offset:1024 sc1
    ds_read_b128 a[208:211], v200 offset:40960
    v_cvt_pk_bf16_f32 v151, v126, v127
    v_add_f32 v232, v232, v121
    v_add_f32 v232, v232, v122
    v_max3_f32 v234, v234, v99, v100
    v_max3_f32 v234, v234, v101, v102
    v_mfma_f32_32x32x16_bf16 v[0:15], a[240:243], v[148:151], v[0:15]
    s_waitcnt lgkmcnt(5)
    ds_read_b128 a[212:215], v201 offset:40960
    v_add_f32 v232, v232, v123
    v_add_f32 v232, v232, v124
    v_max3_f32 v234, v234, v103, v104
    v_max3_f32 v234, v234, v105, v106
    v_mfma_f32_32x32x16_bf16 v[16:31], a[244:247], v[148:151], v[16:31]
    s_waitcnt lgkmcnt(4)
    buffer_store_dwordx4 a[24:27], v252, s[24:27], s74 offen offset:2048 sc1
    ds_read_b128 a[216:219], v202 offset:40960
    v_add_f32 v232, v232, v125
    v_add_f32 v232, v232, v126
    v_max3_f32 v234, v234, v107, v108
    v_max3_f32 v234, v234, v109, v110
    v_mfma_f32_32x32x16_bf16 v[32:47], a[248:251], v[148:151], v[32:47]
    s_waitcnt lgkmcnt(3)
    s_add_u32 s75, s56, 32768
    buffer_store_dwordx2 a[136:137], v245, s[24:27], s75 offen sc1
    ds_read_b128 a[220:223], v203 offset:40960
    v_add_f32 v232, v232, v127
    v_max_f32 v234, v234, v111
    v_cmp_lt_f32 vcc, 0x41000000, v234
    v_mfma_f32_32x32x16_bf16 v[48:63], a[252:255], v[148:151], v[48:63]
    s_waitcnt lgkmcnt(3)
    buffer_store_dwordx4 a[28:31], v252, s[24:27], s74 offen offset:3072 sc1
    buffer_store_dwordx2 a[138:139], v245, s[24:27], s75 offen offset:512 sc1
    ds_read_b128 a[224:227], v204 offset:40960
    s_cbranch_vccnz L_rare32
L_back32:
    v_exp_f32 v96, v96
    v_exp_f32 v97, v97
    v_mfma_f32_32x32x16_bf16 v[112:127], a[208:211], a[96:99], v[128:143]
    s_waitcnt lgkmcnt(3)
    ds_read_b128 a[228:231], v205 offset:40960
    v_cvt_pk_bf16_f32 v144, v96, v97
    v_exp_f32 v98, v98
    v_exp_f32 v99, v99
    v_mfma_f32_32x32x16_bf16 v[112:127], a[212:215], a[100:103], v[112:127]
    s_waitcnt lgkmcnt(3)
    ds_read_b128 a[232:235], v206 offset:40960
    v_cvt_pk_bf16_f32 v145, v98, v99
    v_exp_f32 v100, v100
    v_exp_f32 v101, v101
    s_waitcnt vmcnt(19)
    s_barrier
L_ih14:
    v_mfma_f32_32x32x16_bf16 v[112:127], a[216:219], a[104:107], v[112:127]
    s_waitcnt lgkmcnt(3)
    ds_read_b128 a[236:239], v207 offset:40960
    v_cvt_pk_bf16_f32 v146, v100, v101
    v_exp_f32 v102, v102
    v_exp_f32 v103, v103
    v_and_b32 v238, 112, v244
    v_lshl_add_u32 v238, v238, 3, s44
    v_mfma_f32_32x32x16_bf16 v[112:127], a[220:223], a[108:111], v[112:127]
    s_waitcnt lgkmcnt(3)
    ds_read_b64_tr_b16 a[240:241], v208 offset:32768
    ds_read_b64_tr_b16 a[242:243], v208 offset:34816
    v_cvt_pk_bf16_f32 v147, v102, v103
    v_exp_f32 v104, v104
    v_add_f32 v232, v232, v96
    v_add_u32 v238, L_ip0 - L_ibase, v238
    v_min_u32 v238, L_end - L_ibase - 64, v238
    v_mfma_f32_32x32x16_bf16 v[112:127], a[224:227], a[112:115], v[112:127]
    s_waitcnt lgkmcnt(4)
    ds_read_b64_tr_b16 a[244:245], v209 offset:32768
    ds_read_b64_tr_b16 a[246:247], v209 offset:34816
    v_exp_f32 v105, v105
    v_add_f32 v232, v232, v97
    v_mfma_f32_32x32x16_bf16 v[112:127], a[228:231], a[116:119], v[112:127]
    s_waitcnt lgkmcnt(5)
    global_load_dword a140, v238, s[90:91]
    ds_read_b64_tr_b16 a[248:249], v210 offset:32768
    ds_read_b64_tr_b16 a[250:251], v210 offset:34816
    v_cvt_pk_bf16_f32 v148, v104, v105
    v_exp_f32 v106, v106
    v_add_f32 v232, v232, v98
    v_mfma_f32_32x32x16_bf16 v[112:127], a[232:235], a[120:123], v[112:127]
    s_waitcnt lgkmcnt(6)
    ds_read_b64_tr_b16 a[252:253], v211 offset:32768
    ds_read_b64_tr_b16 a[254:255], v211 offset:34816
    v_exp_f32 v107, v107
    v_add_f32 v232, v232, v99
    v_add_f32 v232, v232, v100
    v_mfma_f32_32x32x16_bf16 v[112:127], a[236:239], a[124:127], v[112:127]
    s_waitcnt lgkmcnt(6)
    ds_read_b64_tr_b16 a[208:209], v208 offset:36864
    ds_read_b64_tr_b16 a[210:211], v208 offset:38912
    v_cvt_pk_bf16_f32 v149, v106, v107
    v_exp_f32 v108, v108
    v_add_f32 v232, v232, v101
    v_mfma_f32_32x32x16_bf16 v[0:15], a[240:243], v[144:147], v[0:15]
    s_waitcnt lgkmcnt(6)
    ds_read_b64_tr_b16 a[212:213], v209 offset:36864
    ds_read_b64_tr_b16 a[214:215], v209 offset:38912
    v_exp_f32 v109, v109
    v_add_f32 v232, v232, v102
    v_mfma_f32_32x32x16_bf16 v[16:31], a[244:247], v[144:147], v[16:31]
    s_waitcnt lgkmcnt(6)
    ds_read_b64_tr_b16 a[216:217], v210 offset:36864
    ds_read_b64_tr_b16 a[218:219], v210 offset:38912
    s_add_u32 m0, s44, 16384
    s_add_u32 s55, s64, 65536
    buffer_load_dwordx4 v230, s[28:31], s55 offen lds
    v_cvt_pk_bf16_f32 v150, v108, v109
    v_exp_f32 v110, v110
    v_add_f32 v232, v232, v103
    v_mfma_f32_32x32x16_bf16 v[32:47], a[248:251], v[144:147], v[32:47]
    s_waitcnt lgkmcnt(6)
    ds_read_b64_tr_b16 a[220:221], v211 offset:36864
    ds_read_b64_tr_b16 a[222:223], v211 offset:38912
    v_exp_f32 v111, v111
    v_add_f32 v232, v232, v104
    v_max3_f32 v234, v112, v113, v114
    v_mfma_f32_32x32x16_bf16 v[48:63], a[252:255], v[144:147], v[48:63]
    s_waitcnt lgkmcnt(6)
    s_add_u32 m0, s44, 20480
    s_add_u32 s55, s64, 81920
    buffer_load_dwordx4 v230, s[28:31], s55 offen lds
    ds_read_b128 a[224:227], v200 offset:49152
    v_cvt_pk_bf16_f32 v151, v110, v111
    v_add_f32 v232, v232, v105
    v_add_f32 v232, v232, v106
    v_max3_f32 v234, v234, v115, v116
    v_max3_f32 v234, v234, v117, v118
    v_mfma_f32_32x32x16_bf16 v[0:15], a[208:211], v[148:151], v[0:15]
    s_waitcnt lgkmcnt(5)
    ds_read_b128 a[228:231], v201 offset:49152
    v_add_f32 v232, v232, v107
    v_add_f32 v232, v232, v108
    v_max3_f32 v234, v234, v119, v120
    v_max3_f32 v234, v234, v121, v122
    v_mfma_f32_32x32x16_bf16 v[16:31], a[212:215], v[148:151], v[16:31]
    s_waitcnt lgkmcnt(4)
    s_add_u32 m0, s44, 24576
    s_add_u32 s55, s64, 98304
    buffer_load_dwordx4 v230, s[28:31], s55 offen lds
    ds_read_b128 a[232:235], v202 offset:49152
    v_add_f32 v232, v232, v109
    v_add_f32 v232, v232, v110
    v_max3_f32 v234, v234, v123, v124
    v_max3_f32 v234, v234, v125, v126
    v_mfma_f32_32x32x16_bf16 v[32:47], a[216:219], v[148:151], v[32:47]
    s_waitcnt lgkmcnt(3)
    ds_read_b128 a[236:239], v203 offset:49152
    v_add_f32 v232, v232, v111
    v_max_f32 v234, v234, v127
    v_cmp_lt_f32 vcc, 0x41000000, v234
    v_mfma_f32_32x32x16_bf16 v[48:63], a[220:223], v[148:151], v[48:63]
    s_waitcnt lgkmcnt(3)
    s_add_u32 m0, s44, 28672
    s_add_u32 s55, s64, 114688
    buffer_load_dwordx4 v230, s[28:31], s55 offen lds
    ds_read_b128 a[240:243], v204 offset:49152
    s_cbranch_vccnz L_rare33
L_back33:
    v_exp_f32 v112, v112
    v_exp_f32 v113, v113
    v_mfma_f32_32x32x16_bf16 v[96:111], a[224:227], a[96:99], v[128:143]
    s_waitcnt lgkmcnt(3)
    ds_read_b128 a[244:247], v205 offset:49152
    v_cvt_pk_bf16_f32 v144, v112, v113
    v_exp_f32 v114, v114
    v_exp_f32 v115, v115
    v_mfma_f32_32x32x16_bf16 v[96:111], a[228:231], a[100:103], v[96:111]
    s_waitcnt lgkmcnt(3)
    ds_read_b128 a[248:251], v206 offset:49152
    v_cvt_pk_bf16_f32 v145, v114, v115
    v_exp_f32 v116, v116
    v_exp_f32 v117, v117
    v_mfma_f32_32x32x16_bf16 v[96:111], a[232:235], a[104:107], v[96:111]
    s_waitcnt lgkmcnt(3)
    ds_read_b128 a[252:255], v207 offset:49152
    s_add_u32 m0, s44, 65536
    s_add_u32 s55, s65, 65536
    buffer_load_dwordx4 v230, s[28:31], s55 offen lds
    v_cvt_pk_bf16_f32 v146, v116, v117
    v_exp_f32 v118, v118
    v_exp_f32 v119, v119
    v_mfma_f32_32x32x16_bf16 v[96:111], a[236:239], a[108:111], v[96:111]
    s_waitcnt lgkmcnt(3)
    ds_read_b64_tr_b16 a[208:209], v208 offset:40960
    ds_read_b64_tr_b16 a[210:211], v208 offset:43008
    v_cvt_pk_bf16_f32 v147, v118, v119
    v_exp_f32 v120, v120
    v_add_f32 v232, v232, v112
    v_mfma_f32_32x32x16_bf16 v[96:111], a[240:243], a[112:115], v[96:111]
    s_waitcnt lgkmcnt(4)
    ds_read_b64_tr_b16 a[212:213], v209 offset:40960
    ds_read_b64_tr_b16 a[214:215], v209 offset:43008
    v_exp_f32 v121, v121
    v_add_f32 v232, v232, v113
    v_mfma_f32_32x32x16_bf16 v[96:111], a[244:247], a[116:119], v[96:111]
    s_waitcnt lgkmcnt(5)
    ds_read_b64_tr_b16 a[216:217], v210 offset:40960
    ds_read_b64_tr_b16 a[218:219], v210 offset:43008
    v_cvt_pk_bf16_f32 v148, v120, v121
    v_exp_f32 v122, v122
    v_add_f32 v232, v232, v114
    v_mfma_f32_32x32x16_bf16 v[96:111], a[248:251], a[120:123], v[96:111]
    s_waitcnt lgkmcnt(6)
    ds_read_b64_tr_b16 a[220:221], v211 offset:40960
    ds_read_b64_tr_b16 a[222:223], v211 offset:43008
    s_add_u32 m0, s44, 69632
    s_add_u32 s55, s65, 81920
    buffer_load_dwordx4 v230, s[28:31], s55 offen lds
    v_exp_f32 v123, v123
    v_add_f32 v232, v232, v115
    v_add_f32 v232, v232, v116
    v_mfma_f32_32x32x16_bf16 v[96:111], a[252:255], a[124:127], v[96:111]
    s_waitcnt lgkmcnt(6)
    ds_read_b64_tr_b16 a[224:225], v208 offset:45056
    ds_read_b64_tr_b16 a[226:227], v208 offset:47104
    v_cvt_pk_bf16_f32 v149, v122, v123
    v_exp_f32 v124, v124
    v_add_f32 v232, v232, v117
    v_mfma_f32_32x32x16_bf16 v[0:15], a[208:211], v[144:147], v[0:15]
    s_waitcnt lgkmcnt(6)
    ds_read_b64_tr_b16 a[228:229], v209 offset:45056
    ds_read_b64_tr_b16 a[230:231], v209 offset:47104
    v_exp_f32 v125, v125
    v_add_f32 v232, v232, v118
    v_mfma_f32_32x32x16_bf16 v[16:31], a[212:215], v[144:147], v[16:31]
    s_waitcnt lgkmcnt(6)
    ds_read_b64_tr_b16 a[232:233], v210 offset:45056
    ds_read_b64_tr_b16 a[234:235], v210 offset:47104
    v_cvt_pk_bf16_f32 v150, v124, v125
    v_exp_f32 v126, v126
    v_add_f32 v232, v232, v119
    v_mfma_f32_32x32x16_bf16 v[32:47], a[216:219], v[144:147], v[32:47]
    s_waitcnt lgkmcnt(6)
    ds_read_b64_tr_b16 a[236:237], v211 offset:45056
    ds_read_b64_tr_b16 a[238:239], v211 offset:47104
    s_add_u32 m0, s44, 73728
    s_add_u32 s55, s65, 98304
    buffer_load_dwordx4 v230, s[28:31], s55 offen lds
    v_exp_f32 v127, v127
    v_add_f32 v232, v232, v120
    v_max3_f32 v234, v96, v97, v98
    v_mfma_f32_32x32x16_bf16 v[48:63], a[220:223], v[144:147], v[48:63]
    s_waitcnt lgkmcnt(6)
    ds_read_b128 a[240:243], v212 offset:32768
    ds_read_b128 a[244:247], v213 offset:32768
    v_cvt_pk_bf16_f32 v151, v126, v127
    v_add_f32 v232, v232, v121
    v_add_f32 v232, v232, v122
    v_max3_f32 v234, v234, v99, v100
    v_max3_f32 v234, v234, v101, v102
    v_mfma_f32_32x32x16_bf16 v[0:15], a[224:227], v[148:151], v[0:15]
    s_waitcnt lgkmcnt(6)
    ds_read_b128 a[248:251], v214 offset:32768
    ds_read_b128 a[252:255], v215 offset:32768
    v_add_f32 v232, v232, v123
    v_add_f32 v232, v232, v124
    v_max3_f32 v234, v234, v103, v104
    v_max3_f32 v234, v234, v105, v106
    v_add_u32 v231, s44, v244
    v_add_u32 v231, 32768, v231
    v_mfma_f32_32x32x16_bf16 v[16:31], a[228:231], v[148:151], v[16:31]
    s_waitcnt lgkmcnt(6)
    ds_read_b128 a[208:211], v212 offset:36864
    ds_read_b128 a[212:215], v213 offset:36864
    v_add_f32 v232, v232, v125
    v_add_f32 v232, v232, v126
    v_max3_f32 v234, v234, v107, v108
    v_max3_f32 v234, v234, v109, v110
    v_mfma_f32_32x32x16_bf16 v[32:47], a[232:235], v[148:151], v[32:47]
    s_waitcnt lgkmcnt(6)
    s_add_u32 m0, s44, 77824
    s_add_u32 s55, s65, 114688
    buffer_load_dwordx4 v230, s[28:31], s55 offen lds
    ds_read_b128 a[216:219], v214 offset:36864
    ds_read_b128 a[220:223], v215 offset:36864
    v_add_f32 v232, v232, v127
    v_max_f32 v234, v234, v111
    v_cmp_lt_f32 vcc, 0x41000000, v234
    v_mfma_f32_32x32x16_bf16 v[48:63], a[236:239], v[148:151], v[48:63]
    s_waitcnt lgkmcnt(7)
    ds_read_b128 a[224:227], v200 offset:57344
    s_cbranch_vccnz L_rare34
L_back34:
    v_mfma_f32_16x16x32_bf16 v[152:155], a[240:243], a[176:179], v[160:163]
    s_waitcnt lgkmcnt(7)
    ds_read_b128 a[228:231], v201 offset:57344
    v_mfma_f32_16x16x32_bf16 v[152:155], a[244:247], a[180:183], v[152:155]
    s_waitcnt lgkmcnt(7)
    v_mfma_f32_16x16x32_bf16 v[152:155], a[248:251], a[184:187], v[152:155]
    s_waitcnt lgkmcnt(6)
    ds_read_b128 a[232:235], v202 offset:57344
    v_mfma_f32_16x16x32_bf16 v[152:155], a[252:255], a[188:191], v[152:155]
    s_waitcnt lgkmcnt(6)
    v_mfma_f32_16x16x32_bf16 v[156:159], a[208:211], a[176:179], v[160:163]
    s_waitcnt lgkmcnt(5)
    ds_read_b128 a[236:239], v203 offset:57344
    v_mfma_f32_16x16x32_bf16 v[156:159], a[212:215], a[180:183], v[156:159]
    s_waitcnt lgkmcnt(5)
    v_mfma_f32_16x16x32_bf16 v[156:159], a[216:219], a[184:187], v[156:159]
    s_waitcnt lgkmcnt(4)
    ds_read_b128 a[240:243], v204 offset:57344
    v_mfma_f32_16x16x32_bf16 v[156:159], a[220:223], a[188:191], v[156:159]
    s_waitcnt lgkmcnt(4)
    v_exp_f32 v96, v96
    v_exp_f32 v97, v97
    v_mfma_f32_32x32x16_bf16 v[112:127], a[224:227], a[96:99], v[128:143]
    s_waitcnt lgkmcnt(3)
    ds_read_b128 a[244:247], v205 offset:57344
    v_cvt_pk_bf16_f32 v144, v96, v97
    v_exp_f32 v98, v98
    v_exp_f32 v99, v99
    v_mfma_f32_32x32x16_bf16 v[112:127], a[228:231], a[100:103], v[112:127]
    s_waitcnt lgkmcnt(3)
    ds_read_b128 a[248:251], v206 offset:57344
    v_cvt_pk_bf16_f32 v145, v98, v99
    v_exp_f32 v100, v100
    v_exp_f32 v101, v101
    s_waitcnt vmcnt(9)
    s_barrier
L_ih15:
    v_mfma_f32_32x32x16_bf16 v[112:127], a[232:235], a[104:107], v[112:127]
    s_waitcnt lgkmcnt(3)
    ds_read_b128 a[252:255], v207 offset:57344
    s_lshl_b32 s7, s39, 7
    s_add_u32 m0, s44, 32768
    s_add_u32 s55, s65, 0
    buffer_load_dwordx4 v230, s[28:31], s55 offen lds
    v_cvt_pk_bf16_f32 v146, v100, v101
    v_exp_f32 v102, v102
    v_exp_f32 v103, v103
    v_and_b32 v238, 112, v244
    v_lshl_add_u32 v238, v238, 3, s44
    v_lshrrev_b32 v241, 4, v244
    v_or_b32 v241, s36, v241
    v_cmp_eq_u32 s[0:1], 0, v241
    v_mov_b32 v242, 2147483647
    v_mov_b32 v240, s7
    v_cndmask_b32 v241, v242, v240, s[0:1]
    v_mfma_f32_32x32x16_bf16 v[112:127], a[236:239], a[108:111], v[112:127]
    s_waitcnt lgkmcnt(3)
    ds_read_b64_tr_b16 a[208:209], v208 offset:49152
    ds_read_b64_tr_b16 a[210:211], v208 offset:51200
    buffer_store_dword v255, v241, s[24:27], s3 offen sc1
    v_cvt_pk_bf16_f32 v147, v102, v103
    v_exp_f32 v104, v104
    v_add_f32 v232, v232, v96
    v_add_u32 v238, L_ip1 - L_ibase, v238
    v_min_u32 v238, L_end - L_ibase - 64, v238
    v_mfma_f32_32x32x16_bf16 v[112:127], a[240:243], a[112:115], v[112:127]
    s_waitcnt lgkmcnt(4)
    ds_read_b64_tr_b16 a[212:213], v209 offset:49152
    ds_read_b64_tr_b16 a[214:215], v209 offset:51200
    v_exp_f32 v105, v105
    v_add_f32 v232, v232, v97
    v_max3_f32 v235, v152, v153, v154
    v_mfma_f32_32x32x16_bf16 v[112:127], a[244:247], a[116:119], v[112:127]
    s_waitcnt lgkmcnt(5)
    global_load_dword a140, v238, s[90:91]
    ds_read_b64_tr_b16 a[216:217], v210 offset:49152
    ds_read_b64_tr_b16 a[218:219], v210 offset:51200
    s_add_u32 m0, s44, 36864
    s_add_u32 s55, s65, 16384
    buffer_load_dwordx4 v230, s[28:31], s55 offen lds
    v_cvt_pk_bf16_f32 v148, v104, v105
    v_exp_f32 v106, v106
    v_add_f32 v232, v232, v98
    v_mfma_f32_32x32x16_bf16 v[112:127], a[248:251], a[120:123], v[112:127]
    s_waitcnt lgkmcnt(6)
    ds_read_b64_tr_b16 a[220:221], v211 offset:49152
    ds_read_b64_tr_b16 a[222:223], v211 offset:51200
    v_exp_f32 v107, v107
    v_add_f32 v232, v232, v99
    v_add_f32 v232, v232, v100
    v_mfma_f32_32x32x16_bf16 v[112:127], a[252:255], a[124:127], v[112:127]
    s_waitcnt lgkmcnt(6)
    ds_read_b64_tr_b16 a[224:225], v208 offset:53248
    ds_read_b64_tr_b16 a[226:227], v208 offset:55296
    v_cvt_pk_bf16_f32 v149, v106, v107
    v_exp_f32 v108, v108
    v_add_f32 v232, v232, v101
    v_max3_f32 v235, v235, v155, v156
    v_max3_f32 v235, v235, v157, v158
    v_max_f32 v235, v235, v159
    v_cmp_lt_f32 vcc, 0x41000000, v235
    s_nop 1
    s_cbranch_vccnz L_rare35
L_back35:
    v_mfma_f32_32x32x16_bf16 v[0:15], a[208:211], v[144:147], v[0:15]
    s_waitcnt lgkmcnt(6)
    ds_read_b64_tr_b16 a[228:229], v209 offset:53248
    ds_read_b64_tr_b16 a[230:231], v209 offset:55296
    s_add_u32 m0, s44, 40960
    s_add_u32 s55, s65, 32768
    buffer_load_dwordx4 v230, s[28:31], s55 offen lds
    v_exp_f32 v109, v109
    v_add_f32 v232, v232, v102
    v_mfma_f32_32x32x16_bf16 v[16:31], a[212:215], v[144:147], v[16:31]
    s_waitcnt lgkmcnt(6)
    ds_read_b64_tr_b16 a[232:233], v210 offset:53248
    ds_read_b64_tr_b16 a[234:235], v210 offset:55296
    v_cvt_pk_bf16_f32 v150, v108, v109
    v_exp_f32 v110, v110
    v_add_f32 v232, v232, v103
    v_mfma_f32_32x32x16_bf16 v[32:47], a[216:219], v[144:147], v[32:47]
    s_waitcnt lgkmcnt(6)
    ds_read_b64_tr_b16 a[236:237], v211 offset:53248
    ds_read_b64_tr_b16 a[238:239], v211 offset:55296
    v_exp_f32 v111, v111
    v_add_f32 v232, v232, v104
    v_max3_f32 v234, v112, v113, v114
    v_mfma_f32_32x32x16_bf16 v[48:63], a[220:223], v[144:147], v[48:63]
    s_waitcnt lgkmcnt(6)
    s_add_u32 m0, s44, 45056
    s_add_u32 s55, s65, 49152
    buffer_load_dwordx4 v230, s[28:31], s55 offen lds
    ds_read_b64_tr_b16 a[240:241], v216 offset:32768
    ds_read_b64_tr_b16 a[242:243], v216 offset:36864
    ds_read_b64_tr_b16 a[244:245], v217 offset:32768
    ds_read_b64_tr_b16 a[246:247], v217 offset:36864
    v_cvt_pk_bf16_f32 v151, v110, v111
    v_add_f32 v232, v232, v105
    v_add_f32 v232, v232, v106
    v_max3_f32 v234, v234, v115, v116
    v_max3_f32 v234, v234, v117, v118
    v_mfma_f32_32x32x16_bf16 v[0:15], a[224:227], v[148:151], v[0:15]
    s_waitcnt lgkmcnt(8)
    s_add_u32 m0, s44, 81920
    s_add_u32 s55, s66, 0
    buffer_load_dwordx4 v230, s[28:31], s55 offen lds
    ds_read_b64_tr_b16 a[248:249], v218 offset:32768
    ds_read_b64_tr_b16 a[250:251], v218 offset:36864
    ds_read_b64_tr_b16 a[252:253], v219 offset:32768
    ds_read_b64_tr_b16 a[254:255], v219 offset:36864
    v_add_f32 v232, v232, v107
    v_add_f32 v232, v232, v108
    v_max3_f32 v234, v234, v119, v120
    v_max3_f32 v234, v234, v121, v122
    v_mfma_f32_32x32x16_bf16 v[16:31], a[228:231], v[148:151], v[16:31]
    s_waitcnt lgkmcnt(10)
    s_add_u32 m0, s44, 86016
    s_add_u32 s55, s66, 16384
    buffer_load_dwordx4 v230, s[28:31], s55 offen lds
    ds_read_b64_tr_b16 a[208:209], v220 offset:32768
    ds_read_b64_tr_b16 a[210:211], v220 offset:36864
    ds_read_b64_tr_b16 a[212:213], v221 offset:32768
    ds_read_b64_tr_b16 a[214:215], v221 offset:36864
    v_add_f32 v232, v232, v109
    v_add_f32 v232, v232, v110
    v_max3_f32 v234, v234, v123, v124
    v_max3_f32 v234, v234, v125, v126
    v_mfma_f32_32x32x16_bf16 v[32:47], a[232:235], v[148:151], v[32:47]
    s_waitcnt lgkmcnt(12)
    s_add_u32 m0, s44, 90112
    s_add_u32 s55, s66, 32768
    buffer_load_dwordx4 v230, s[28:31], s55 offen lds
    ds_read_b64_tr_b16 a[216:217], v222 offset:32768
    ds_read_b64_tr_b16 a[218:219], v222 offset:36864
    ds_read_b64_tr_b16 a[220:221], v223 offset:32768
    ds_read_b64_tr_b16 a[222:223], v223 offset:36864
    v_add_f32 v232, v232, v111
    v_max_f32 v234, v234, v127
    v_cmp_lt_f32 vcc, 0x41000000, v234
    v_mfma_f32_32x32x16_bf16 v[48:63], a[236:239], v[148:151], v[48:63]
    s_waitcnt lgkmcnt(14)
    s_add_u32 m0, s44, 94208
    s_add_u32 s55, s66, 49152
    buffer_load_dwordx4 v230, s[28:31], s55 offen lds
    ds_read_b64_tr_b16 a[224:225], v208 offset:57344
    ds_read_b64_tr_b16 a[226:227], v208 offset:59392
    v_exp_f32 v152, v152
    v_exp_f32 v153, v153
    v_exp_f32 v154, v154
    v_exp_f32 v155, v155
    v_exp_f32 v156, v156
    v_exp_f32 v157, v157
    v_exp_f32 v158, v158
    v_exp_f32 v159, v159
    s_cbranch_vccnz L_rare36
L_back36:
    v_cvt_pk_bf16_f32 v164, v152, v153
    v_cvt_pk_bf16_f32 v165, v154, v155
    v_cvt_pk_bf16_f32 v166, v156, v157
    v_cvt_pk_bf16_f32 v167, v158, v159
    s_nop 1
    v_mfma_f32_16x16x32_bf16 v[64:67], a[240:243], v[164:167], v[64:67]
    s_waitcnt lgkmcnt(14)
    ds_read_b64_tr_b16 a[228:229], v209 offset:57344
    ds_read_b64_tr_b16 a[230:231], v209 offset:59392
    v_mfma_f32_16x16x32_bf16 v[68:71], a[244:247], v[164:167], v[68:71]
    s_waitcnt lgkmcnt(14)
    v_add_f32 v233, v233, v152
    v_add_f32 v233, v233, v153
    v_mfma_f32_16x16x32_bf16 v[72:75], a[248:251], v[164:167], v[72:75]
    s_waitcnt lgkmcnt(12)
    ds_read_b64_tr_b16 a[232:233], v210 offset:57344
    ds_read_b64_tr_b16 a[234:235], v210 offset:59392
    v_mfma_f32_16x16x32_bf16 v[76:79], a[252:255], v[164:167], v[76:79]
    s_waitcnt lgkmcnt(12)
    v_add_f32 v233, v233, v154
    v_add_f32 v233, v233, v155
    v_mfma_f32_16x16x32_bf16 v[80:83], a[208:211], v[164:167], v[80:83]
    s_waitcnt lgkmcnt(10)
    ds_read_b64_tr_b16 a[236:237], v211 offset:57344
    ds_read_b64_tr_b16 a[238:239], v211 offset:59392
    v_mfma_f32_16x16x32_bf16 v[84:87], a[212:215], v[164:167], v[84:87]
    s_waitcnt lgkmcnt(10)
    v_exp_f32 v112, v112
    v_mfma_f32_16x16x32_bf16 v[88:91], a[216:219], v[164:167], v[88:91]
    s_waitcnt lgkmcnt(8)
    ds_read_b64_tr_b16 a[240:241], v208 offset:61440
    ds_read_b64_tr_b16 a[242:243], v208 offset:63488
    v_exp_f32 v113, v113
    v_exp_f32 v114, v114
    v_exp_f32 v115, v115
    v_exp_f32 v116, v116
    v_exp_f32 v117, v117
    v_exp_f32 v118, v118
    v_exp_f32 v119, v119
    v_mfma_f32_16x16x32_bf16 v[92:95], a[220:223], v[164:167], v[92:95]
    s_waitcnt lgkmcnt(8)
    v_cvt_pk_bf16_f32 v144, v112, v113
    v_cvt_pk_bf16_f32 v145, v114, v115
    v_cvt_pk_bf16_f32 v146, v116, v117
    v_cvt_pk_bf16_f32 v147, v118, v119
    s_nop 1
    v_mfma_f32_32x32x16_bf16 v[0:15], a[224:227], v[144:147], v[0:15]
    s_waitcnt lgkmcnt(6)
    ds_read_b64_tr_b16 a[244:245], v209 offset:61440
    ds_read_b64_tr_b16 a[246:247], v209 offset:63488
    v_add_f32 v233, v233, v156
    v_add_f32 v233, v233, v157
    v_add_f32 v233, v233, v158
    v_add_f32 v233, v233, v159
    v_mfma_f32_32x32x16_bf16 v[16:31], a[228:231], v[144:147], v[16:31]
    s_waitcnt lgkmcnt(6)
    ds_read_b64_tr_b16 a[248:249], v210 offset:61440
    ds_read_b64_tr_b16 a[250:251], v210 offset:63488
    v_exp_f32 v120, v120
    v_exp_f32 v121, v121
    v_mfma_f32_32x32x16_bf16 v[32:47], a[232:235], v[144:147], v[32:47]
    s_waitcnt lgkmcnt(6)
    ds_read_b64_tr_b16 a[252:253], v211 offset:61440
    ds_read_b64_tr_b16 a[254:255], v211 offset:63488
    v_exp_f32 v122, v122
    v_exp_f32 v123, v123
    v_exp_f32 v124, v124
    v_exp_f32 v125, v125
    v_exp_f32 v126, v126
    v_exp_f32 v127, v127
    v_mfma_f32_32x32x16_bf16 v[48:63], a[236:239], v[144:147], v[48:63]
    s_waitcnt lgkmcnt(6)
    v_add_f32 v232, v232, v112
    v_add_f32 v232, v232, v113
    v_cvt_pk_bf16_f32 v148, v120, v121
    v_cvt_pk_bf16_f32 v149, v122, v123
    v_cvt_pk_bf16_f32 v150, v124, v125
    v_cvt_pk_bf16_f32 v151, v126, v127
    s_nop 1
    v_mfma_f32_32x32x16_bf16 v[0:15], a[240:243], v[148:151], v[0:15]
    s_waitcnt lgkmcnt(4)
    v_add_f32 v232, v232, v114
    v_add_f32 v232, v232, v115
    v_add_f32 v232, v232, v116
    v_add_f32 v232, v232, v117
    v_add_f32 v232, v232, v118
    v_add_f32 v232, v232, v119
    v_mfma_f32_32x32x16_bf16 v[16:31], a[244:247], v[148:151], v[16:31]
    s_waitcnt lgkmcnt(2)
    v_add_f32 v232, v232, v120
    v_add_f32 v232, v232, v121
    v_add_f32 v232, v232, v122
    v_add_f32 v232, v232, v123
    v_add_f32 v232, v232, v124
    v_add_f32 v232, v232, v125
    v_add_f32 v232, v232, v126
    v_add_f32 v232, v232, v127
    v_mov_b32 v236, v232
    v_mfma_f32_32x32x16_bf16 v[32:47], a[248:251], v[148:151], v[32:47]
    s_waitcnt lgkmcnt(0)
    s_add_u32 s75, s57, 0
    s_add_u32 s76, s57, 4096
    v_permlane32_swap_b32 v236, v232
    v_add_f32 v243, v236, v232
    v_rcp_f32 v243, v243
    v_mfma_f32_32x32x16_bf16 v[48:63], a[252:255], v[148:151], v[48:63]
    v_mul_f32 v0, v243, v0
    v_mul_f32 v1, v243, v1
    v_cvt_pk_bf16_f32 v168, v0, v1
    v_mul_f32 v2, v243, v2
    v_mul_f32 v3, v243, v3
    v_cvt_pk_bf16_f32 v169, v2, v3
    v_mul_f32 v4, v243, v4
    v_mul_f32 v5, v243, v5
    v_cvt_pk_bf16_f32 v170, v4, v5
    v_mul_f32 v6, v243, v6
    v_mul_f32 v7, v243, v7
    v_cvt_pk_bf16_f32 v171, v6, v7
    v_mul_f32 v8, v243, v8
    v_mul_f32 v9, v243, v9
    v_cvt_pk_bf16_f32 v172, v8, v9
    v_mul_f32 v10, v243, v10
    v_mul_f32 v11, v243, v11
    v_cvt_pk_bf16_f32 v173, v10, v11
    v_mul_f32 v12, v243, v12
    v_mul_f32 v13, v243, v13
    v_cvt_pk_bf16_f32 v174, v12, v13
    v_mul_f32 v14, v243, v14
    v_mul_f32 v15, v243, v15
    v_cvt_pk_bf16_f32 v175, v14, v15
    v_mul_f32 v16, v243, v16
    v_mul_f32 v17, v243, v17
    v_cvt_pk_bf16_f32 v176, v16, v17
    v_mul_f32 v18, v243, v18
    v_mul_f32 v19, v243, v19
    v_cvt_pk_bf16_f32 v177, v18, v19
    v_mul_f32 v20, v243, v20
    v_mul_f32 v21, v243, v21
    v_cvt_pk_bf16_f32 v178, v20, v21
    v_mul_f32 v22, v243, v22
    v_mul_f32 v23, v243, v23
    v_cvt_pk_bf16_f32 v179, v22, v23
    v_mul_f32 v24, v243, v24
    v_mul_f32 v25, v243, v25
    v_cvt_pk_bf16_f32 v180, v24, v25
    v_mul_f32 v26, v243, v26
    v_mul_f32 v27, v243, v27
    v_cvt_pk_bf16_f32 v181, v26, v27
    v_mul_f32 v28, v243, v28
    v_mul_f32 v29, v243, v29
    v_cvt_pk_bf16_f32 v182, v28, v29
    v_mul_f32 v30, v243, v30
    v_mul_f32 v31, v243, v31
    v_cvt_pk_bf16_f32 v183, v30, v31
    v_mul_f32 v32, v243, v32
    v_mul_f32 v33, v243, v33
    v_cvt_pk_bf16_f32 v184, v32, v33
    v_mul_f32 v34, v243, v34
    v_mul_f32 v35, v243, v35
    v_cvt_pk_bf16_f32 v185, v34, v35
    v_mul_f32 v36, v243, v36
    v_mul_f32 v37, v243, v37
    v_cvt_pk_bf16_f32 v186, v36, v37
    v_mul_f32 v38, v243, v38
    v_mul_f32 v39, v243, v39
    v_cvt_pk_bf16_f32 v187, v38, v39
    v_mul_f32 v40, v243, v40
    v_mul_f32 v41, v243, v41
    v_cvt_pk_bf16_f32 v188, v40, v41
    v_mul_f32 v42, v243, v42
    v_mul_f32 v43, v243, v43
    v_cvt_pk_bf16_f32 v189, v42, v43
    v_mul_f32 v44, v243, v44
    v_mul_f32 v45, v243, v45
    v_cvt_pk_bf16_f32 v190, v44, v45
    v_mul_f32 v46, v243, v46
    v_mul_f32 v47, v243, v47
    v_cvt_pk_bf16_f32 v191, v46, v47
    v_mul_f32 v48, v243, v48
    v_mul_f32 v49, v243, v49
    v_cvt_pk_bf16_f32 v192, v48, v49
    v_mul_f32 v50, v243, v50
    v_mul_f32 v51, v243, v51
    v_cvt_pk_bf16_f32 v193, v50, v51
    v_mul_f32 v52, v243, v52
    v_mul_f32 v53, v243, v53
    v_cvt_pk_bf16_f32 v194, v52, v53
    v_mul_f32 v54, v243, v54
    v_mul_f32 v55, v243, v55
    v_cvt_pk_bf16_f32 v195, v54, v55
    v_mul_f32 v56, v243, v56
    v_mul_f32 v57, v243, v57
    v_cvt_pk_bf16_f32 v196, v56, v57
    v_mul_f32 v58, v243, v58
    v_mul_f32 v59, v243, v59
    v_cvt_pk_bf16_f32 v197, v58, v59
    v_mul_f32 v60, v243, v60
    v_mul_f32 v61, v243, v61
    v_cvt_pk_bf16_f32 v198, v60, v61
    v_mul_f32 v62, v243, v62
    v_mul_f32 v63, v243, v63
    v_cvt_pk_bf16_f32 v199, v62, v63
    s_barrier
L_ip0:
    buffer_store_dwordx4 v[168:171], v252, s[24:27], s75 offen sc1
    ds_read_b64_tr_b16 a[208:209], v246 offset:0
    ds_read_b64_tr_b16 a[210:211], v246 offset:1024
    ds_read_b64_tr_b16 a[212:213], v247 offset:0
    ds_read_b64_tr_b16 a[214:215], v247 offset:1024
    ds_read_b64_tr_b16 a[216:217], v248 offset:0
    ds_read_b64_tr_b16 a[218:219], v248 offset:1024
    ds_read_b64_tr_b16 a[220:221], v249 offset:0
    ds_read_b64_tr_b16 a[222:223], v249 offset:1024
    ds_read_b64_tr_b16 a[224:225], v246 offset:4096
    ds_read_b64_tr_b16 a[226:227], v246 offset:5120
    s_waitcnt lgkmcnt(8)
    v_mfma_f32_32x32x16_bf16 v[96:111], a[208:211], a[0:3], 0
    s_waitcnt lgkmcnt(6)
    buffer_store_dwordx4 v[172:175], v252, s[24:27], s75 offen offset:1024 sc1
    ds_read_b64_tr_b16 a[228:229], v247 offset:4096
    ds_read_b64_tr_b16 a[230:231], v247 offset:5120
    v_mov_b32 v238, v233
    v_mov_b32 v218, v160
    v_and_b32 v242, 240, v244
    v_mfma_f32_32x32x16_bf16 v[112:127], a[212:215], a[0:3], 0
    s_waitcnt lgkmcnt(6)
    buffer_store_dwordx4 v[176:179], v252, s[24:27], s75 offen offset:2048 sc1
    ds_read_b64_tr_b16 a[232:233], v248 offset:4096
    ds_read_b64_tr_b16 a[234:235], v248 offset:5120
    v_permlane16_swap_b32 v238, v233
    v_add_f32 v233, v238, v233
    v_mov_b32 v238, v233
    v_mfma_f32_32x32x16_bf16 v[128:143], a[216:219], a[0:3], 0
    s_waitcnt lgkmcnt(6)
    buffer_store_dwordx4 v[180:183], v252, s[24:27], s75 offen offset:3072 sc1
    ds_read_b64_tr_b16 a[236:237], v249 offset:4096
    ds_read_b64_tr_b16 a[238:239], v249 offset:5120
    v_permlane32_swap_b32 v238, v233
    v_add_f32 v219, v238, v233
    v_and_b32 v238, 112, v244
    v_lshl_add_u32 v238, v238, 3, s44
    v_add_u32 v238, L_ip6 - L_ibase, v238
    v_min_u32 v238, L_end - L_ibase - 64, v238
    v_mfma_f32_32x32x16_bf16 v[144:159], a[220:223], a[0:3], 0
    s_waitcnt lgkmcnt(6)
    buffer_store_dwordx4 v[184:187], v252, s[24:27], s76 offen sc1
    ds_read_b128 a[144:147], v254 offset:0
    ds_read_b64_tr_b16 a[240:241], v250 offset:0
    ds_read_b64_tr_b16 a[242:243], v250 offset:1024
    ds_read_b64_tr_b16 a[244:245], v251 offset:0
    ds_read_b64_tr_b16 a[246:247], v251 offset:1024
    v_mfma_f32_32x32x16_bf16 v[96:111], a[224:227], a[4:7], v[96:111]
    s_waitcnt lgkmcnt(9)
    buffer_store_dwordx4 v[188:191], v252, s[24:27], s76 offen offset:1024 sc1
    global_load_dword a140, v238, s[90:91]
    ds_read_b64_tr_b16 a[248:249], v246 offset:8192
    ds_read_b64_tr_b16 a[250:251], v246 offset:9216
    v_lshrrev_b32 v242, 1, v242
    v_add_u32 v242, 147456, v242
    v_mfma_f32_32x32x16_bf16 v[112:127], a[228:231], a[4:7], v[112:127]
    s_waitcnt lgkmcnt(9)
    buffer_store_dwordx4 v[192:195], v252, s[24:27], s76 offen offset:2048 sc1
    s_mul_i32 s77, s36, 6144
    ds_read_b64_tr_b16 a[252:253], v247 offset:8192
    ds_read_b64_tr_b16 a[254:255], v247 offset:9216
    ds_read_b64_tr_b16 a[216:217], v246 offset:12288
    ds_read_b64_tr_b16 a[218:219], v246 offset:13312
    v_lshrrev_b32 v240, 5, s43
    v_add_u32 v240, v240, v242
    v_add_u32 v241, s77, v244
    v_add_u32 v241, 98304, v241
    v_mfma_f32_32x32x16_bf16 v[128:143], a[232:235], a[4:7], v[128:143]
    s_waitcnt lgkmcnt(11)
    buffer_store_dwordx4 v[196:199], v252, s[24:27], s76 offen offset:3072 sc1
    ds_write_b64 v240, v[218:219] offset:0
    ds_write_b128 v241, v[72:75] offset:0
    ds_write_b128 v241, v[76:79] offset:1024
    ds_write_b128 v241, v[80:83] offset:2048
    ds_write_b128 v241, v[84:87] offset:3072
    ds_write_b128 v241, v[88:91] offset:4096
    ds_write_b128 v241, v[92:95] offset:5120
    ds_read_b64_tr_b16 a[208:209], v248 offset:8192
    ds_read_b64_tr_b16 a[210:211], v248 offset:9216
    ds_read_b64_tr_b16 a[220:221], v247 offset:12288
    ds_read_b64_tr_b16 a[222:223], v247 offset:13312
    s_waitcnt lgkmcnt(4)
    s_barrier
    ds_read_b64_tr_b16 a[224:225], v248 offset:12288
    ds_read_b64_tr_b16 a[226:227], v248 offset:13312
    v_mfma_f32_32x32x16_bf16 v[144:159], a[236:239], a[4:7], v[144:159]
    s_add_u32 s77, s36, 0
    s_and_b32 s77, s77, 3
    ds_read_b64_tr_b16 a[212:213], v249 offset:8192
    ds_read_b64_tr_b16 a[214:215], v249 offset:9216
    ds_read_b64_tr_b16 a[228:229], v249 offset:12288
    ds_read_b64_tr_b16 a[230:231], v249 offset:13312
    v_mfma_f32_16x16x32_bf16 v[160:163], a[240:243], a[144:147], 0
    s_add_u32 m0, s44, 49152
    s_add_u32 s55, s66, 65536
    buffer_load_dwordx4 v230, s[28:31], s55 offen lds
    ds_read_b64_tr_b16 a[232:233], v250 offset:8192
    ds_read_b64_tr_b16 a[234:235], v250 offset:9216
    v_mfma_f32_16x16x32_bf16 v[164:167], a[244:247], a[144:147], 0
    ds_read_b64_tr_b16 a[236:237], v251 offset:8192
    ds_read_b64_tr_b16 a[238:239], v251 offset:9216
    v_mfma_f32_32x32x16_bf16 v[96:111], a[248:251], a[8:11], v[96:111]
    s_add_u32 m0, s44, 53248
    s_add_u32 s55, s66, 81920
    buffer_load_dwordx4 v230, s[28:31], s55 offen lds
    s_lshl_b32 s74, s77, 7
    s_add_u32 s77, s36, 1
    v_add_u32 v214, s74, v242
    v_mfma_f32_32x32x16_bf16 v[112:127], a[252:255], a[8:11], v[112:127]
    s_waitcnt lgkmcnt(12)
    ds_read_b64 v[200:201], v214 offset:0
    s_and_b32 s77, s77, 3
    s_lshl_b32 s74, s77, 7
    v_add_u32 v214, s74, v242
    v_mfma_f32_32x32x16_bf16 v[128:143], a[208:211], a[8:11], v[128:143]
    s_waitcnt lgkmcnt(7)
    s_add_u32 m0, s44, 57344
    s_add_u32 s55, s66, 98304
    buffer_load_dwordx4 v230, s[28:31], s55 offen lds
    ds_read_b64 v[202:203], v214 offset:0
    s_mul_i32 s74, s77, 6144
    v_add_u32 v215, s74, v244
    v_add_u32 v215, 98304, v215
    v_mfma_f32_32x32x16_bf16 v[144:159], a[212:215], a[8:11], v[144:159]
    s_waitcnt lgkmcnt(0)
    ds_read_b128 a[148:151], v254 offset:1024
    ds_read_b128 v[72:75], v215 offset:4096
    ds_read_b128 v[76:79], v215 offset:5120
    s_add_u32 s77, s36, 2
    s_and_b32 s77, s77, 3
    s_lshl_b32 s74, s77, 7
    v_add_u32 v214, s74, v242
    s_waitcnt vmcnt(26)
    s_barrier
L_ip1:
    s_add_u32 m0, s44, 61440
    s_add_u32 s55, s66, 114688
    buffer_load_dwordx4 v230, s[28:31], s55 offen lds
    v_min_f32 v208, v200, v202
    v_mfma_f32_32x32x16_bf16 v[96:111], a[216:219], a[12:15], v[96:111]
    ds_read_b64 v[204:205], v214 offset:0
    s_mul_i32 s74, s77, 6144
    ds_read_b64_tr_b16 a[240:241], v246 offset:16384
    ds_read_b64_tr_b16 a[242:243], v246 offset:17408
    v_add_u32 v215, s74, v244
    v_add_u32 v215, 98304, v215
    v_mfma_f32_32x32x16_bf16 v[112:127], a[220:223], a[12:15], v[112:127]
    ds_read_b128 v[80:83], v215 offset:2048
    ds_read_b128 v[84:87], v215 offset:3072
    s_add_u32 s77, s36, 3
    s_and_b32 s77, s77, 3
    ds_read_b64_tr_b16 a[244:245], v247 offset:16384
    ds_read_b64_tr_b16 a[246:247], v247 offset:17408
    v_mfma_f32_32x32x16_bf16 v[128:143], a[224:227], a[12:15], v[128:143]
    s_lshl_b32 s74, s77, 7
    ds_read_b64_tr_b16 a[248:249], v248 offset:16384
    ds_read_b64_tr_b16 a[250:251], v248 offset:17408
    v_add_u32 v214, s74, v242
    v_mfma_f32_32x32x16_bf16 v[144:159], a[228:231], a[12:15], v[144:159]
    s_waitcnt lgkmcnt(11)
    ds_read_b64 v[206:207], v214 offset:0
    s_mul_i32 s74, s77, 6144
    ds_read_b64_tr_b16 a[252:253], v249 offset:16384
    ds_read_b64_tr_b16 a[254:255], v249 offset:17408
    v_add_u32 v215, s74, v244
    v_add_u32 v215, 98304, v215
    v_mfma_f32_16x16x32_bf16 v[160:163], a[232:235], a[148:151], v[160:163]
    ds_read_b64_tr_b16 a[208:209], v246 offset:20480
    ds_read_b64_tr_b16 a[210:211], v246 offset:21504
    v_mfma_f32_16x16x32_bf16 v[164:167], a[236:239], a[148:151], v[164:167]
    s_waitcnt lgkmcnt(4)
    v_min3_f32 v208, v208, v204, v206
    v_sub_f32 v200, v208, v200
    v_exp_f32 v200, v200
    v_sub_f32 v202, v208, v202
    v_exp_f32 v202, v202
    v_sub_f32 v204, v208, v204
    v_exp_f32 v204, v204
    v_sub_f32 v206, v208, v206
    v_exp_f32 v206, v206
    v_mfma_f32_32x32x16_bf16 v[96:111], a[240:243], a[16:19], v[96:111]
    ds_read_b64_tr_b16 a[212:213], v247 offset:20480
    ds_read_b64_tr_b16 a[214:215], v247 offset:21504
    v_mul_f32 v209, v200, v201
    v_fma_f32 v209, v202, v203, v209
    v_fma_f32 v209, v204, v205, v209
    v_fma_f32 v209, v206, v207, v209
    v_rcp_f32 v209, v209
    v_mfma_f32_32x32x16_bf16 v[112:127], a[244:247], a[16:19], v[112:127]
    ds_read_b64_tr_b16 a[216:217], v248 offset:20480
    ds_read_b64_tr_b16 a[218:219], v248 offset:21504
    v_mul_f32 v200, v200, v209
    v_mul_f32 v202, v202, v209
    v_mul_f32 v204, v204, v209
    v_mul_f32 v206, v206, v209
    v_mul_f32 v64, v200, v64
    v_fma_f32 v64, v202, v72, v64
    v_fma_f32 v64, v204, v80, v64
    v_mul_f32 v65, v200, v65
    v_fma_f32 v65, v202, v73, v65
    v_fma_f32 v65, v204, v81, v65
    v_mul_f32 v66, v200, v66
    v_fma_f32 v66, v202, v74, v66
    v_mfma_f32_32x32x16_bf16 v[128:143], a[248:251], a[16:19], v[128:143]
    s_waitcnt lgkmcnt(6)
    ds_read_b128 v[88:91], v215 offset:0
    ds_read_b128 v[92:95], v215 offset:1024
    ds_read_b64_tr_b16 a[220:221], v249 offset:20480
    ds_read_b64_tr_b16 a[222:223], v249 offset:21504
    v_fma_f32 v66, v204, v82, v66
    v_mul_f32 v67, v200, v67
    v_mfma_f32_32x32x16_bf16 v[144:159], a[252:255], a[16:19], v[144:159]
    s_waitcnt lgkmcnt(8)
    ds_read_b128 a[152:155], v254 offset:2048
    ds_read_b64_tr_b16 a[224:225], v250 offset:16384
    ds_read_b64_tr_b16 a[226:227], v250 offset:17408
    ds_read_b64_tr_b16 a[228:229], v251 offset:16384
    ds_read_b64_tr_b16 a[230:231], v251 offset:17408
    v_fma_f32 v67, v202, v75, v67
    v_fma_f32 v67, v204, v83, v67
    v_mfma_f32_32x32x16_bf16 v[96:111], a[208:211], a[20:23], v[96:111]
    s_waitcnt lgkmcnt(8)
    ds_read_b64_tr_b16 a[232:233], v246 offset:24576
    ds_read_b64_tr_b16 a[234:235], v246 offset:25600
    v_fma_f32 v64, v206, v88, v64
    v_fma_f32 v65, v206, v89, v65
    v_fma_f32 v66, v206, v90, v66
    v_fma_f32 v67, v206, v91, v67
    v_cvt_pk_bf16_f32 v210, v64, v65
    v_cvt_pk_bf16_f32 v211, v66, v67
    v_add_u32 v239, 143360, v245
    v_mfma_f32_32x32x16_bf16 v[112:127], a[212:215], a[20:23], v[112:127]
    ds_read_b64_tr_b16 a[236:237], v247 offset:24576
    ds_read_b64_tr_b16 a[238:239], v247 offset:25600
    ds_read_b64_tr_b16 a[248:249], v246 offset:28672
    ds_read_b64_tr_b16 a[250:251], v246 offset:29696
    v_mul_f32 v68, v200, v68
    v_fma_f32 v68, v202, v76, v68
    v_fma_f32 v68, v204, v84, v68
    v_mfma_f32_32x32x16_bf16 v[128:143], a[216:219], a[20:23], v[128:143]
    s_waitcnt lgkmcnt(11)
    s_mul_i32 s77, s36, 1073741824
    ds_read_b64_tr_b16 a[240:241], v248 offset:24576
    ds_read_b64_tr_b16 a[242:243], v248 offset:25600
    ds_read_b64_tr_b16 a[252:253], v247 offset:28672
    ds_read_b64_tr_b16 a[254:255], v247 offset:29696
    v_fma_f32 v68, v206, v92, v68
    v_mul_f32 v69, v200, v69
    v_fma_f32 v69, v202, v77, v69
    v_lshlrev_b32 v220, 3, v244
    v_and_b32 v220, 384, v220
    v_or_b32 v220, s77, v220
    v_mfma_f32_32x32x16_bf16 v[144:159], a[220:223], a[20:23], v[144:159]
    s_waitcnt lgkmcnt(12)
    ds_read_b64_tr_b16 a[244:245], v249 offset:24576
    ds_read_b64_tr_b16 a[246:247], v249 offset:25600
    ds_read_b64_tr_b16 a[208:209], v248 offset:28672
    ds_read_b64_tr_b16 a[210:211], v248 offset:29696
    v_fma_f32 v69, v204, v85, v69
    v_fma_f32 v69, v206, v93, v69
    v_mul_f32 v70, v200, v70
    v_mfma_f32_16x16x32_bf16 v[160:163], a[224:227], a[152:155], v[160:163]
    s_waitcnt lgkmcnt(14)
    buffer_load_dword v217, v220, s[24:27], s3 offen sc1
    ds_read_b64_tr_b16 a[212:213], v249 offset:28672
    ds_read_b64_tr_b16 a[214:215], v249 offset:29696
    v_fma_f32 v70, v202, v78, v70
    v_fma_f32 v70, v204, v86, v70
    v_fma_f32 v70, v206, v94, v70
    v_mfma_f32_16x16x32_bf16 v[164:167], a[228:231], a[152:155], v[164:167]
    s_waitcnt lgkmcnt(14)
    ds_read_b64_tr_b16 a[216:217], v250 offset:24576
    ds_read_b64_tr_b16 a[218:219], v250 offset:25600
    v_mul_f32 v71, v200, v71
    v_fma_f32 v71, v202, v79, v71
    v_fma_f32 v71, v204, v87, v71
    v_mfma_f32_32x32x16_bf16 v[96:111], a[232:235], a[24:27], v[96:111]
    s_waitcnt lgkmcnt(14)
    ds_write_b64 v239, v[210:211] offset:0
    ds_read_b64_tr_b16 a[220:221], v251 offset:24576
    ds_read_b64_tr_b16 a[222:223], v251 offset:25600
    v_fma_f32 v71, v206, v95, v71
    v_cvt_pk_bf16_f32 v212, v68, v69
    v_cvt_pk_bf16_f32 v213, v70, v71
    v_mfma_f32_32x32x16_bf16 v[112:127], a[236:239], a[24:27], v[112:127]
    s_waitcnt lgkmcnt(13)
    s_add_u32 s74, s57, 32768
    buffer_store_dwordx2 v[210:211], v245, s[24:27], s74 offen sc1
    buffer_store_dwordx2 v[212:213], v245, s[24:27], s74 offen offset:512 sc1
    ds_write_b64 v239, v[212:213] offset:512
    v_mfma_f32_32x32x16_bf16 v[128:143], a[240:243], a[24:27], v[128:143]
    s_waitcnt lgkmcnt(10)
    v_mfma_f32_32x32x16_bf16 v[144:159], a[244:247], a[24:27], v[144:159]
    s_waitcnt vmcnt(2)
    v_cmp_ne_u32 s[0:1], v217, v255
    s_nop 1
    s_cmp_eq_u32 s36, 0
    s_cselect_b64 s[0:1], s[0:1], 0
    s_cmp_lg_u64 s[0:1], 0
    s_cbranch_scc1 L_poll1
L_pback1:
    ds_read_b128 a[156:159], v254 offset:3072
    s_waitcnt lgkmcnt(1)
    s_barrier
L_ip2:
    s_add_u32 s78, s58, 0
    v_mfma_f32_32x32x16_bf16 v[96:111], a[248:251], a[28:31], v[96:111]
    buffer_load_dwordx4 a[64:67], v252, s[24:27], s78 offen sc1
    ds_read_b64_tr_b16 a[224:225], v246 offset:32768
    ds_read_b64_tr_b16 a[226:227], v246 offset:33792
    v_mfma_f32_32x32x16_bf16 v[112:127], a[252:255], a[28:31], v[112:127]
    buffer_load_dwordx4 a[128:131], v231, s[24:27], s58 offen sc1
    ds_read_b64_tr_b16 a[228:229], v247 offset:32768
    ds_read_b64_tr_b16 a[230:231], v247 offset:33792
    v_mfma_f32_32x32x16_bf16 v[128:143], a[208:211], a[28:31], v[128:143]
    buffer_load_dwordx4 a[68:71], v252, s[24:27], s78 offen offset:1024 sc1
    ds_read_b64_tr_b16 a[232:233], v248 offset:32768
    ds_read_b64_tr_b16 a[234:235], v248 offset:33792
    v_mfma_f32_32x32x16_bf16 v[144:159], a[212:215], a[28:31], v[144:159]
    s_waitcnt lgkmcnt(6)
    ds_read_b64_tr_b16 a[236:237], v249 offset:32768
    ds_read_b64_tr_b16 a[238:239], v249 offset:33792
    v_mfma_f32_16x16x32_bf16 v[160:163], a[216:219], a[156:159], v[160:163]
    buffer_load_dwordx4 a[72:75], v252, s[24:27], s78 offen offset:2048 sc1
    ds_read_b64_tr_b16 a[240:241], v246 offset:36864
    ds_read_b64_tr_b16 a[242:243], v246 offset:37888
    v_mfma_f32_16x16x32_bf16 v[164:167], a[220:223], a[156:159], v[164:167]
    s_waitcnt lgkmcnt(8)
    v_mfma_f32_32x32x16_bf16 v[96:111], a[224:227], v[168:171], v[96:111]
    s_waitcnt lgkmcnt(6)
    buffer_load_dwordx4 a[76:79], v252, s[24:27], s78 offen offset:3072 sc1
    ds_read_b64_tr_b16 a[244:245], v247 offset:36864
    ds_read_b64_tr_b16 a[246:247], v247 offset:37888
    v_mfma_f32_32x32x16_bf16 v[112:127], a[228:231], v[168:171], v[112:127]
    s_waitcnt lgkmcnt(6)
    ds_read_b64_tr_b16 a[248:249], v248 offset:36864
    ds_read_b64_tr_b16 a[250:251], v248 offset:37888
    v_mfma_f32_32x32x16_bf16 v[128:143], a[232:235], v[168:171], v[128:143]
    s_waitcnt lgkmcnt(6)
    s_add_u32 s79, s58, 4096
    ds_read_b64_tr_b16 a[252:253], v249 offset:36864
    ds_read_b64_tr_b16 a[254:255], v249 offset:37888
    v_mfma_f32_32x32x16_bf16 v[144:159], a[236:239], v[168:171], v[144:159]
    s_waitcnt lgkmcnt(6)
    ds_read_b128 a[160:163], v254 offset:12288
    buffer_load_dwordx4 a[80:83], v252, s[24:27], s79 offen sc1
    ds_read_b64_tr_b16 a[208:209], v250 offset:32768
    ds_read_b64_tr_b16 a[210:211], v250 offset:33792
    ds_read_b64_tr_b16 a[212:213], v251 offset:32768
    ds_read_b64_tr_b16 a[214:215], v251 offset:33792
    v_mfma_f32_32x32x16_bf16 v[96:111], a[240:243], v[172:175], v[96:111]
    s_waitcnt lgkmcnt(9)
    ds_read_b64_tr_b16 a[216:217], v246 offset:40960
    ds_read_b64_tr_b16 a[218:219], v246 offset:41984
    ds_read_b64_tr_b16 a[232:233], v246 offset:45056
    ds_read_b64_tr_b16 a[234:235], v246 offset:46080
    v_mfma_f32_32x32x16_bf16 v[112:127], a[244:247], v[172:175], v[112:127]
    s_waitcnt lgkmcnt(11)
    buffer_load_dwordx4 a[84:87], v252, s[24:27], s79 offen offset:1024 sc1
    ds_read_b64_tr_b16 a[220:221], v247 offset:40960
    ds_read_b64_tr_b16 a[222:223], v247 offset:41984
    ds_read_b64_tr_b16 a[236:237], v247 offset:45056
    ds_read_b64_tr_b16 a[238:239], v247 offset:46080
    v_mfma_f32_32x32x16_bf16 v[128:143], a[248:251], v[172:175], v[128:143]
    s_waitcnt lgkmcnt(13)
    ds_read_b64_tr_b16 a[224:225], v248 offset:40960
    ds_read_b64_tr_b16 a[226:227], v248 offset:41984
    ds_read_b64_tr_b16 a[240:241], v248 offset:45056
    ds_read_b64_tr_b16 a[242:243], v248 offset:46080
    v_mfma_f32_32x32x16_bf16 v[144:159], a[252:255], v[172:175], v[144:159]
    s_waitcnt lgkmcnt(14)
    buffer_load_dwordx4 a[88:91], v252, s[24:27], s79 offen offset:2048 sc1
    ds_read_b64_tr_b16 a[228:229], v249 offset:40960
    ds_read_b64_tr_b16 a[230:231], v249 offset:41984
    ds_read_b64_tr_b16 a[244:245], v249 offset:45056
    ds_read_b64_tr_b16 a[246:247], v249 offset:46080
    v_mfma_f32_16x16x32_bf16 v[160:163], a[208:211], a[160:163], v[160:163]
    s_waitcnt lgkmcnt(15)
    ds_read_b64_tr_b16 a[248:249], v250 offset:40960
    ds_read_b64_tr_b16 a[250:251], v250 offset:41984
    v_mfma_f32_16x16x32_bf16 v[164:167], a[212:215], a[160:163], v[164:167]
    s_waitcnt lgkmcnt(15)
    buffer_load_dwordx4 a[92:95], v252, s[24:27], s79 offen offset:3072 sc1
    ds_read_b64_tr_b16 a[252:253], v251 offset:40960
    ds_read_b64_tr_b16 a[254:255], v251 offset:41984
    v_mfma_f32_32x32x16_bf16 v[96:111], a[216:219], v[176:179], v[96:111]
    s_waitcnt lgkmcnt(14)
    v_mfma_f32_32x32x16_bf16 v[112:127], a[220:223], v[176:179], v[112:127]
    s_waitcnt lgkmcnt(10)
    v_mfma_f32_32x32x16_bf16 v[128:143], a[224:227], v[176:179], v[128:143]
    s_waitcnt lgkmcnt(6)
    v_mfma_f32_32x32x16_bf16 v[144:159], a[228:231], v[176:179], v[144:159]
    ds_read_b128 a[164:167], v254 offset:13312
    s_waitcnt lgkmcnt(1)
    s_barrier
L_ip3:
    v_mfma_f32_32x32x16_bf16 v[96:111], a[232:235], v[180:183], v[96:111]
    ds_read_b64_tr_b16 a[208:209], v224 offset:0
    ds_read_b64_tr_b16 a[210:211], v224 offset:1024
    v_mfma_f32_32x32x16_bf16 v[112:127], a[236:239], v[180:183], v[112:127]
    s_add_u32 s80, s59, 0
    s_add_u32 m0, s44, 98304
    s_add_u32 s55, s67, 0
    buffer_load_dwordx4 v230, s[28:31], s55 offen lds
    ds_read_b64_tr_b16 a[212:213], v225 offset:0
    ds_read_b64_tr_b16 a[214:215], v225 offset:1024
    v_mfma_f32_32x32x16_bf16 v[128:143], a[240:243], v[180:183], v[128:143]
    buffer_load_dwordx4 a[96:99], v252, s[24:27], s80 offen sc1
    ds_read_b64_tr_b16 a[216:217], v226 offset:0
    ds_read_b64_tr_b16 a[218:219], v226 offset:1024
    v_mfma_f32_32x32x16_bf16 v[144:159], a[244:247], v[180:183], v[144:159]
    s_waitcnt lgkmcnt(6)
    buffer_load_dwordx4 a[132:135], v231, s[24:27], s59 offen sc1
    s_add_u32 m0, s44, 102400
    s_add_u32 s55, s67, 16384
    buffer_load_dwordx4 v230, s[28:31], s55 offen lds
    ds_read_b64_tr_b16 a[220:221], v227 offset:0
    ds_read_b64_tr_b16 a[222:223], v227 offset:1024
    v_mfma_f32_16x16x32_bf16 v[160:163], a[248:251], a[164:167], v[160:163]
    buffer_load_dwordx4 a[100:103], v252, s[24:27], s80 offen offset:1024 sc1
    ds_read_b64_tr_b16 a[224:225], v224 offset:4096
    ds_read_b64_tr_b16 a[226:227], v224 offset:5120
    v_mfma_f32_16x16x32_bf16 v[164:167], a[252:255], a[164:167], v[164:167]
    s_waitcnt lgkmcnt(8)
    s_add_u32 m0, s44, 106496
    s_add_u32 s55, s67, 32768
    buffer_load_dwordx4 v230, s[28:31], s55 offen lds
    v_mfma_f32_32x32x16_bf16 v[96:111], a[208:211], v[184:187], v[96:111]
    s_waitcnt lgkmcnt(6)
    buffer_load_dwordx4 a[104:107], v252, s[24:27], s80 offen offset:2048 sc1
    ds_read_b64_tr_b16 a[228:229], v225 offset:4096
    ds_read_b64_tr_b16 a[230:231], v225 offset:5120
    v_mfma_f32_32x32x16_bf16 v[112:127], a[212:215], v[184:187], v[112:127]
    s_waitcnt lgkmcnt(6)
    s_add_u32 m0, s44, 110592
    s_add_u32 s55, s67, 49152
    buffer_load_dwordx4 v230, s[28:31], s55 offen lds
    ds_read_b64_tr_b16 a[232:233], v226 offset:4096
    ds_read_b64_tr_b16 a[234:235], v226 offset:5120
    v_mfma_f32_32x32x16_bf16 v[128:143], a[216:219], v[184:187], v[128:143]
    s_waitcnt lgkmcnt(6)
    buffer_load_dwordx4 a[108:111], v252, s[24:27], s80 offen offset:3072 sc1
    ds_read_b64_tr_b16 a[236:237], v227 offset:4096
    ds_read_b64_tr_b16 a[238:239], v227 offset:5120
    v_mfma_f32_32x32x16_bf16 v[144:159], a[220:223], v[184:187], v[144:159]
    s_waitcnt lgkmcnt(6)
    ds_read_b128 a[168:171], v254 offset:14336
    ds_read_b64_tr_b16 a[240:241], v228 offset:0
    ds_read_b64_tr_b16 a[242:243], v228 offset:1024
    ds_read_b64_tr_b16 a[244:245], v229 offset:0
    ds_read_b64_tr_b16 a[246:247], v229 offset:1024
    v_mfma_f32_32x32x16_bf16 v[96:111], a[224:227], v[188:191], v[96:111]
    s_waitcnt lgkmcnt(9)
    s_add_u32 s81, s59, 4096
    s_add_u32 m0, s44, 114688
    s_add_u32 s55, s67, 65536
    buffer_load_dwordx4 v230, s[28:31], s55 offen lds
    ds_read_b64_tr_b16 a[248:249], v224 offset:8192
    ds_read_b64_tr_b16 a[250:251], v224 offset:9216
    ds_read_b64_tr_b16 a[216:217], v224 offset:12288
    ds_read_b64_tr_b16 a[218:219], v224 offset:13312
    v_mfma_f32_32x32x16_bf16 v[112:127], a[228:231], v[188:191], v[112:127]
    s_waitcnt lgkmcnt(11)
    buffer_load_dwordx4 a[112:115], v252, s[24:27], s81 offen sc1
    ds_read_b64_tr_b16 a[252:253], v225 offset:8192
    ds_read_b64_tr_b16 a[254:255], v225 offset:9216
    ds_read_b64_tr_b16 a[220:221], v225 offset:12288
    ds_read_b64_tr_b16 a[222:223], v225 offset:13312
    v_mfma_f32_32x32x16_bf16 v[128:143], a[232:235], v[188:191], v[128:143]
    s_waitcnt lgkmcnt(13)
    s_add_u32 m0, s44, 118784
    s_add_u32 s55, s67, 81920
    buffer_load_dwordx4 v230, s[28:31], s55 offen lds
    ds_read_b64_tr_b16 a[208:209], v226 offset:8192
    ds_read_b64_tr_b16 a[210:211], v226 offset:9216
    ds_read_b64_tr_b16 a[224:225], v226 offset:12288
    ds_read_b64_tr_b16 a[226:227], v226 offset:13312
    v_mfma_f32_32x32x16_bf16 v[144:159], a[236:239], v[188:191], v[144:159]
    s_waitcnt lgkmcnt(14)
    buffer_load_dwordx4 a[116:119], v252, s[24:27], s81 offen offset:1024 sc1
    ds_read_b64_tr_b16 a[212:213], v227 offset:8192
    ds_read_b64_tr_b16 a[214:215], v227 offset:9216
    ds_read_b64_tr_b16 a[228:229], v227 offset:12288
    ds_read_b64_tr_b16 a[230:231], v227 offset:13312
    v_mfma_f32_16x16x32_bf16 v[160:163], a[240:243], a[168:171], v[160:163]
    s_waitcnt lgkmcnt(15)
    s_add_u32 m0, s44, 122880
    s_add_u32 s55, s67, 98304
    buffer_load_dwordx4 v230, s[28:31], s55 offen lds
    ds_read_b64_tr_b16 a[232:233], v228 offset:8192
    ds_read_b64_tr_b16 a[234:235], v228 offset:9216
    v_mfma_f32_16x16x32_bf16 v[164:167], a[244:247], a[168:171], v[164:167]
    s_waitcnt lgkmcnt(15)
    buffer_load_dwordx4 a[120:123], v252, s[24:27], s81 offen offset:2048 sc1
    ds_read_b64_tr_b16 a[236:237], v229 offset:8192
    ds_read_b64_tr_b16 a[238:239], v229 offset:9216
    v_mfma_f32_32x32x16_bf16 v[96:111], a[248:251], v[192:195], v[96:111]
    s_waitcnt lgkmcnt(14)
    s_add_u32 m0, s44, 126976
    s_add_u32 s55, s67, 114688
    buffer_load_dwordx4 v230, s[28:31], s55 offen lds
    v_add_u32 v237, s44, v254
    v_mfma_f32_32x32x16_bf16 v[112:127], a[252:255], v[192:195], v[112:127]
    s_waitcnt vmcnt(23) lgkmcnt(10)
    buffer_load_dwordx4 a[124:127], v252, s[24:27], s81 offen offset:3072 sc1
    ds_write_b128 v237, a[128:131] offset:8192
    v_lshrrev_b32 v221, 4, v244
    v_or_b32 v221, s36, v221
    v_mfma_f32_32x32x16_bf16 v[128:143], a[208:211], v[192:195], v[128:143]
    s_waitcnt lgkmcnt(7)
    v_cmp_eq_u32 s[0:1], 0, v221
    v_mov_b32 v222, 2147483647
    v_mfma_f32_32x32x16_bf16 v[144:159], a[212:215], v[192:195], v[144:159]
    ds_read_b128 a[172:175], v254 offset:15360
    s_lshl_b32 s7, s39, 7
    v_mov_b32 v220, s7
    s_waitcnt lgkmcnt(1)
    s_barrier
L_ip4:
    v_cndmask_b32 v221, v222, v220, s[0:1]
    v_mfma_f32_32x32x16_bf16 v[96:111], a[216:219], v[196:199], v[96:111]
    buffer_store_dword v255, v221, s[24:27], s3 offen offset:4 sc1
    ds_read_b64_tr_b16 a[240:241], v224 offset:16384
    ds_read_b64_tr_b16 a[242:243], v224 offset:17408
    v_mfma_f32_32x32x16_bf16 v[112:127], a[220:223], v[196:199], v[112:127]
    ds_read_b64_tr_b16 a[244:245], v225 offset:16384
    ds_read_b64_tr_b16 a[246:247], v225 offset:17408
    v_and_b32 v238, 112, v244
    v_lshl_add_u32 v238, v238, 3, s44
    v_mfma_f32_32x32x16_bf16 v[128:143], a[224:227], v[196:199], v[128:143]
    s_add_u32 s78, s60, 0
    s_add_u32 m0, s44, 0
    s_add_u32 s55, s68, 0
    buffer_load_dwordx4 v230, s[28:31], s55 offen lds
    ds_read_b64_tr_b16 a[248:249], v226 offset:16384
    ds_read_b64_tr_b16 a[250:251], v226 offset:17408
    v_add_u32 v238, L_ip10 - L_ibase, v238
    v_min_u32 v238, L_end - L_ibase - 64, v238
    v_mfma_f32_32x32x16_bf16 v[144:159], a[228:231], v[196:199], v[144:159]
    s_waitcnt lgkmcnt(6)
    buffer_load_dwordx4 a[0:3], v252, s[24:27], s78 offen sc1
    ds_read_b64_tr_b16 a[252:253], v227 offset:16384
    ds_read_b64_tr_b16 a[254:255], v227 offset:17408
    v_mfma_f32_16x16x32_bf16 v[160:163], a[232:235], a[172:175], v[160:163]
    global_load_dword a140, v238, s[90:91]
    ds_read_b64_tr_b16 a[208:209], v224 offset:20480
    ds_read_b64_tr_b16 a[210:211], v224 offset:21504
    v_mfma_f32_16x16x32_bf16 v[164:167], a[236:239], a[172:175], v[164:167]
    s_waitcnt lgkmcnt(8)
    buffer_load_dwordx4 a[4:7], v252, s[24:27], s78 offen offset:1024 sc1
    s_add_u32 m0, s44, 4096
    s_add_u32 s55, s68, 16384
    buffer_load_dwordx4 v230, s[28:31], s55 offen lds
    v_mfma_f32_32x32x16_bf16 v[96:111], a[240:243], a[64:67], v[96:111]
    s_waitcnt lgkmcnt(6)
    ds_read_b64_tr_b16 a[212:213], v225 offset:20480
    ds_read_b64_tr_b16 a[214:215], v225 offset:21504
    v_mfma_f32_32x32x16_bf16 v[112:127], a[244:247], a[64:67], v[112:127]
    s_waitcnt lgkmcnt(6)
    buffer_load_dwordx4 a[8:11], v252, s[24:27], s78 offen offset:2048 sc1
    ds_read_b64_tr_b16 a[216:217], v226 offset:20480
    ds_read_b64_tr_b16 a[218:219], v226 offset:21504
    v_mfma_f32_32x32x16_bf16 v[128:143], a[248:251], a[64:67], v[128:143]
    s_waitcnt lgkmcnt(6)
    s_add_u32 m0, s44, 8192
    s_add_u32 s55, s68, 32768
    buffer_load_dwordx4 v230, s[28:31], s55 offen lds
    ds_read_b64_tr_b16 a[220:221], v227 offset:20480
    ds_read_b64_tr_b16 a[222:223], v227 offset:21504
    v_mfma_f32_32x32x16_bf16 v[144:159], a[252:255], a[64:67], v[144:159]
    s_waitcnt vmcnt(31) lgkmcnt(6)
    ds_read_b128 a[176:179], v254 offset:8192
    buffer_load_dwordx4 a[12:15], v252, s[24:27], s78 offen offset:3072 sc1
    ds_read_b64_tr_b16 a[224:225], v228 offset:16384
    ds_read_b64_tr_b16 a[226:227], v228 offset:17408
    ds_read_b64_tr_b16 a[228:229], v229 offset:16384
    ds_read_b64_tr_b16 a[230:231], v229 offset:17408
    v_mfma_f32_32x32x16_bf16 v[96:111], a[208:211], a[68:71], v[96:111]
    s_waitcnt lgkmcnt(9)
    ds_read_b64_tr_b16 a[232:233], v224 offset:24576
    ds_read_b64_tr_b16 a[234:235], v224 offset:25600
    ds_read_b64_tr_b16 a[248:249], v224 offset:28672
    ds_read_b64_tr_b16 a[250:251], v224 offset:29696
    v_mfma_f32_32x32x16_bf16 v[112:127], a[212:215], a[68:71], v[112:127]
    s_waitcnt lgkmcnt(11)
    s_add_u32 m0, s44, 12288
    s_add_u32 s55, s68, 49152
    buffer_load_dwordx4 v230, s[28:31], s55 offen lds
    ds_read_b64_tr_b16 a[236:237], v225 offset:24576
    ds_read_b64_tr_b16 a[238:239], v225 offset:25600
    ds_read_b64_tr_b16 a[252:253], v225 offset:28672
    ds_read_b64_tr_b16 a[254:255], v225 offset:29696
    v_mfma_f32_32x32x16_bf16 v[128:143], a[216:219], a[68:71], v[128:143]
    s_waitcnt lgkmcnt(13)
    ds_read_b64_tr_b16 a[240:241], v226 offset:24576
    ds_read_b64_tr_b16 a[242:243], v226 offset:25600
    ds_read_b64_tr_b16 a[208:209], v226 offset:28672
    ds_read_b64_tr_b16 a[210:211], v226 offset:29696
    v_mfma_f32_32x32x16_bf16 v[144:159], a[220:223], a[68:71], v[144:159]
    s_waitcnt lgkmcnt(14)
    ds_read_b64_tr_b16 a[244:245], v227 offset:24576
    ds_read_b64_tr_b16 a[246:247], v227 offset:25600
    ds_read_b64_tr_b16 a[212:213], v227 offset:28672
    ds_read_b64_tr_b16 a[214:215], v227 offset:29696
    v_mfma_f32_16x16x32_bf16 v[160:163], a[224:227], a[176:179], v[160:163]
    s_waitcnt lgkmcnt(15)
    ds_read_b64_tr_b16 a[216:217], v228 offset:24576
    ds_read_b64_tr_b16 a[218:219], v228 offset:25600
    v_mfma_f32_16x16x32_bf16 v[164:167], a[228:231], a[176:179], v[164:167]
    s_waitcnt vmcnt(32) lgkmcnt(15)
    ds_read_b64_tr_b16 a[220:221], v229 offset:24576
    ds_read_b64_tr_b16 a[222:223], v229 offset:25600
    v_mfma_f32_32x32x16_bf16 v[96:111], a[232:235], a[72:75], v[96:111]
    s_waitcnt lgkmcnt(14)
    v_mfma_f32_32x32x16_bf16 v[112:127], a[236:239], a[72:75], v[112:127]
    s_waitcnt lgkmcnt(10)
    v_mfma_f32_32x32x16_bf16 v[128:143], a[240:243], a[72:75], v[128:143]
    s_waitcnt lgkmcnt(6)
    v_mfma_f32_32x32x16_bf16 v[144:159], a[244:247], a[72:75], v[144:159]
    s_waitcnt vmcnt(31)
    ds_read_b128 a[180:183], v254 offset:9216
    s_waitcnt lgkmcnt(1)
    s_barrier
L_ip5:
    v_mfma_f32_32x32x16_bf16 v[96:111], a[248:251], a[76:79], v[96:111]
    ds_read_b64_tr_b16 a[224:225], v246 offset:49152
    ds_read_b64_tr_b16 a[226:227], v246 offset:50176
    v_mfma_f32_32x32x16_bf16 v[112:127], a[252:255], a[76:79], v[112:127]
    ds_read_b64_tr_b16 a[228:229], v247 offset:49152
    ds_read_b64_tr_b16 a[230:231], v247 offset:50176
    v_mfma_f32_32x32x16_bf16 v[128:143], a[208:211], a[76:79], v[128:143]
    s_add_u32 s79, s60, 4096
    s_add_u32 m0, s44, 16384
    s_add_u32 s55, s68, 65536
    buffer_load_dwordx4 v230, s[28:31], s55 offen lds
    ds_read_b64_tr_b16 a[232:233], v248 offset:49152
    ds_read_b64_tr_b16 a[234:235], v248 offset:50176
    v_mfma_f32_32x32x16_bf16 v[144:159], a[212:215], a[76:79], v[144:159]
    s_waitcnt lgkmcnt(6)
    buffer_load_dwordx4 a[16:19], v252, s[24:27], s79 offen sc1
    ds_read_b64_tr_b16 a[236:237], v249 offset:49152
    ds_read_b64_tr_b16 a[238:239], v249 offset:50176
    v_mfma_f32_16x16x32_bf16 v[160:163], a[216:219], a[180:183], v[160:163]
    ds_read_b64_tr_b16 a[240:241], v246 offset:53248
    ds_read_b64_tr_b16 a[242:243], v246 offset:54272
    v_mfma_f32_16x16x32_bf16 v[164:167], a[220:223], a[180:183], v[164:167]
    s_waitcnt vmcnt(32) lgkmcnt(8)
    buffer_load_dwordx4 a[20:23], v252, s[24:27], s79 offen offset:1024 sc1
    s_add_u32 m0, s44, 20480
    s_add_u32 s55, s68, 81920
    buffer_load_dwordx4 v230, s[28:31], s55 offen lds
    v_mfma_f32_32x32x16_bf16 v[96:111], a[224:227], a[80:83], v[96:111]
    s_waitcnt lgkmcnt(6)
    ds_read_b64_tr_b16 a[244:245], v247 offset:53248
    ds_read_b64_tr_b16 a[246:247], v247 offset:54272
    v_mfma_f32_32x32x16_bf16 v[112:127], a[228:231], a[80:83], v[112:127]
    s_waitcnt lgkmcnt(6)
    buffer_load_dwordx4 a[24:27], v252, s[24:27], s79 offen offset:2048 sc1
    ds_read_b64_tr_b16 a[248:249], v248 offset:53248
    ds_read_b64_tr_b16 a[250:251], v248 offset:54272
    v_mfma_f32_32x32x16_bf16 v[128:143], a[232:235], a[80:83], v[128:143]
    s_waitcnt lgkmcnt(6)
    s_add_u32 m0, s44, 24576
    s_add_u32 s55, s68, 98304
    buffer_load_dwordx4 v230, s[28:31], s55 offen lds
    s_mul_i32 s77, s36, 1073741824
    ds_read_b64_tr_b16 a[252:253], v249 offset:53248
    ds_read_b64_tr_b16 a[254:255], v249 offset:54272
    v_lshlrev_b32 v220, 3, v244
    v_and_b32 v220, 384, v220
    v_or_b32 v220, s77, v220
    v_mfma_f32_32x32x16_bf16 v[144:159], a[236:239], a[80:83], v[144:159]
    s_waitcnt vmcnt(35) lgkmcnt(6)
    ds_read_b128 a[184:187], v254 offset:10240
    buffer_load_dwordx4 a[28:31], v252, s[24:27], s79 offen offset:3072 sc1
    ds_read_b64_tr_b16 a[208:209], v250 offset:49152
    ds_read_b64_tr_b16 a[210:211], v250 offset:50176
    ds_read_b64_tr_b16 a[212:213], v251 offset:49152
    ds_read_b64_tr_b16 a[214:215], v251 offset:50176
    v_mfma_f32_32x32x16_bf16 v[96:111], a[240:243], a[84:87], v[96:111]
    s_waitcnt lgkmcnt(9)
    buffer_load_dwordx4 a[128:131], v231, s[24:27], s60 offen sc1
    buffer_load_dword v216, v220, s[24:27], s3 offen offset:4 sc1
    ds_read_b64_tr_b16 a[216:217], v246 offset:57344
    ds_read_b64_tr_b16 a[218:219], v246 offset:58368
    ds_read_b64_tr_b16 a[232:233], v246 offset:61440
    ds_read_b64_tr_b16 a[234:235], v246 offset:62464
    v_mfma_f32_32x32x16_bf16 v[112:127], a[244:247], a[84:87], v[112:127]
    s_waitcnt lgkmcnt(11)
    s_add_u32 m0, s44, 28672
    s_add_u32 s55, s68, 114688
    buffer_load_dwordx4 v230, s[28:31], s55 offen lds
    ds_read_b64_tr_b16 a[220:221], v247 offset:57344
    ds_read_b64_tr_b16 a[222:223], v247 offset:58368
    ds_read_b64_tr_b16 a[236:237], v247 offset:61440
    ds_read_b64_tr_b16 a[238:239], v247 offset:62464
    v_mfma_f32_32x32x16_bf16 v[128:143], a[248:251], a[84:87], v[128:143]
    s_waitcnt lgkmcnt(13)
    ds_read_b64_tr_b16 a[224:225], v248 offset:57344
    ds_read_b64_tr_b16 a[226:227], v248 offset:58368
    ds_read_b64_tr_b16 a[240:241], v248 offset:61440
    ds_read_b64_tr_b16 a[242:243], v248 offset:62464
    v_add_u32 v237, s44, v254
    v_mfma_f32_32x32x16_bf16 v[144:159], a[252:255], a[84:87], v[144:159]
    s_waitcnt vmcnt(34) lgkmcnt(14)
    ds_write_b128 v237, a[132:135] offset:0
    ds_read_b64_tr_b16 a[228:229], v249 offset:57344
    ds_read_b64_tr_b16 a[230:231], v249 offset:58368
    ds_read_b64_tr_b16 a[244:245], v249 offset:61440
    ds_read_b64_tr_b16 a[246:247], v249 offset:62464
    v_mfma_f32_16x16x32_bf16 v[160:163], a[208:211], a[184:187], v[160:163]
    s_waitcnt lgkmcnt(15)
    ds_read_b64_tr_b16 a[248:249], v250 offset:57344
    ds_read_b64_tr_b16 a[250:251], v250 offset:58368
    v_mfma_f32_16x16x32_bf16 v[164:167], a[212:215], a[184:187], v[164:167]
    ds_read_b64_tr_b16 a[252:253], v251 offset:57344
    ds_read_b64_tr_b16 a[254:255], v251 offset:58368
    v_mfma_f32_32x32x16_bf16 v[96:111], a[216:219], a[88:91], v[96:111]
    s_waitcnt lgkmcnt(15)
    v_mfma_f32_32x32x16_bf16 v[112:127], a[220:223], a[88:91], v[112:127]
    s_waitcnt lgkmcnt(11)
    v_mfma_f32_32x32x16_bf16 v[128:143], a[224:227], a[88:91], v[128:143]
    s_waitcnt lgkmcnt(6)
    v_mfma_f32_32x32x16_bf16 v[144:159], a[228:231], a[88:91], v[144:159]
    ds_read_b128 a[188:191], v254 offset:11264
    s_waitcnt vmcnt(29) lgkmcnt(1)
    s_barrier
L_ip6:
    v_mfma_f32_32x32x16_bf16 v[96:111], a[232:235], a[92:95], v[96:111]
    ds_read_b64_tr_b16 a[208:209], v224 offset:32768
    ds_read_b64_tr_b16 a[210:211], v224 offset:33792
    v_mfma_f32_32x32x16_bf16 v[112:127], a[236:239], a[92:95], v[112:127]
    ds_read_b64_tr_b16 a[212:213], v225 offset:32768
    ds_read_b64_tr_b16 a[214:215], v225 offset:33792
    v_mfma_f32_32x32x16_bf16 v[128:143], a[240:243], a[92:95], v[128:143]
    s_add_u32 m0, s44, 32768
    s_add_u32 s55, s69, 0
    buffer_load_dwordx4 v230, s[28:31], s55 offen lds
    ds_read_b64_tr_b16 a[216:217], v226 offset:32768
    ds_read_b64_tr_b16 a[218:219], v226 offset:33792
    v_mfma_f32_32x32x16_bf16 v[144:159], a[244:247], a[92:95], v[144:159]
    s_waitcnt lgkmcnt(6)
    ds_read_b64_tr_b16 a[220:221], v227 offset:32768
    ds_read_b64_tr_b16 a[222:223], v227 offset:33792
    v_mfma_f32_16x16x32_bf16 v[160:163], a[248:251], a[188:191], v[160:163]
    ds_read_b64_tr_b16 a[224:225], v224 offset:36864
    ds_read_b64_tr_b16 a[226:227], v224 offset:37888
    v_mfma_f32_16x16x32_bf16 v[164:167], a[252:255], a[188:191], v[164:167]
    s_waitcnt lgkmcnt(8)
    s_add_u32 m0, s44, 36864
    s_add_u32 s55, s69, 16384
    buffer_load_dwordx4 v230, s[28:31], s55 offen lds
    v_mfma_f32_32x32x16_bf16 v[96:111], a[208:211], a[96:99], v[96:111]
    s_waitcnt lgkmcnt(6)
    ds_read_b64_tr_b16 a[228:229], v225 offset:36864
    ds_read_b64_tr_b16 a[230:231], v225 offset:37888
    v_mfma_f32_32x32x16_bf16 v[112:127], a[212:215], a[96:99], v[112:127]
    s_waitcnt lgkmcnt(6)
    ds_read_b64_tr_b16 a[232:233], v226 offset:36864
    ds_read_b64_tr_b16 a[234:235], v226 offset:37888
    v_mfma_f32_32x32x16_bf16 v[128:143], a[216:219], a[96:99], v[128:143]
    s_waitcnt lgkmcnt(6)
    s_add_u32 m0, s44, 40960
    s_add_u32 s55, s69, 32768
    buffer_load_dwordx4 v230, s[28:31], s55 offen lds
    ds_read_b64_tr_b16 a[236:237], v227 offset:36864
    ds_read_b64_tr_b16 a[238:239], v227 offset:37888
    v_mfma_f32_32x32x16_bf16 v[144:159], a[220:223], a[96:99], v[144:159]
    s_waitcnt lgkmcnt(6)
    ds_read_b128 a[144:147], v254 offset:0
    ds_read_b64_tr_b16 a[240:241], v228 offset:32768
    ds_read_b64_tr_b16 a[242:243], v228 offset:33792
    ds_read_b64_tr_b16 a[244:245], v229 offset:32768
    ds_read_b64_tr_b16 a[246:247], v229 offset:33792
    v_mfma_f32_32x32x16_bf16 v[96:111], a[224:227], a[100:103], v[96:111]
    s_waitcnt lgkmcnt(9)
    ds_read_b64_tr_b16 a[248:249], v224 offset:40960
    ds_read_b64_tr_b16 a[250:251], v224 offset:41984
    v_mfma_f32_32x32x16_bf16 v[112:127], a[228:231], a[100:103], v[112:127]
    s_waitcnt lgkmcnt(9)
    s_add_u32 m0, s44, 45056
    s_add_u32 s55, s69, 49152
    buffer_load_dwordx4 v230, s[28:31], s55 offen lds
    ds_read_b64_tr_b16 a[252:253], v225 offset:40960
    ds_read_b64_tr_b16 a[254:255], v225 offset:41984
    ds_read_b64_tr_b16 a[216:217], v224 offset:45056
    ds_read_b64_tr_b16 a[218:219], v224 offset:46080
    v_mfma_f32_32x32x16_bf16 v[128:143], a[232:235], a[100:103], v[128:143]
    s_waitcnt lgkmcnt(11)
    ds_read_b64_tr_b16 a[208:209], v226 offset:40960
    ds_read_b64_tr_b16 a[210:211], v226 offset:41984
    ds_read_b64_tr_b16 a[220:221], v225 offset:45056
    ds_read_b64_tr_b16 a[222:223], v225 offset:46080
    v_mfma_f32_32x32x16_bf16 v[144:159], a[236:239], a[100:103], v[144:159]
    s_waitcnt lgkmcnt(12)
    ds_read_b64_tr_b16 a[212:213], v227 offset:40960
    ds_read_b64_tr_b16 a[214:215], v227 offset:41984
    ds_read_b64_tr_b16 a[224:225], v226 offset:45056
    ds_read_b64_tr_b16 a[226:227], v226 offset:46080
    v_mfma_f32_16x16x32_bf16 v[160:163], a[240:243], a[144:147], v[160:163]
    s_waitcnt lgkmcnt(14)
    ds_read_b64_tr_b16 a[228:229], v227 offset:45056
    ds_read_b64_tr_b16 a[230:231], v227 offset:46080
    v_mfma_f32_16x16x32_bf16 v[164:167], a[244:247], a[144:147], v[164:167]
    s_waitcnt lgkmcnt(14)
    ds_read_b64_tr_b16 a[232:233], v228 offset:40960
    ds_read_b64_tr_b16 a[234:235], v228 offset:41984
    v_mfma_f32_32x32x16_bf16 v[96:111], a[248:251], a[104:107], v[96:111]
    s_waitcnt lgkmcnt(14)
    ds_read_b64_tr_b16 a[236:237], v229 offset:40960
    ds_read_b64_tr_b16 a[238:239], v229 offset:41984
    v_mfma_f32_32x32x16_bf16 v[112:127], a[252:255], a[104:107], v[112:127]
    s_waitcnt lgkmcnt(12)
    v_mfma_f32_32x32x16_bf16 v[128:143], a[208:211], a[104:107], v[128:143]
    s_waitcnt lgkmcnt(8)
    v_mfma_f32_32x32x16_bf16 v[144:159], a[212:215], a[104:107], v[144:159]
    s_waitcnt vmcnt(5)
    v_cmp_ne_u32 s[0:1], v216, v255
    s_nop 1
    s_cmp_eq_u32 s36, 0
    s_cselect_b64 s[0:1], s[0:1], 0
    s_cmp_lg_u64 s[0:1], 0
    s_cbranch_scc1 L_poll2
L_pback2:
    ds_read_b128 a[148:151], v254 offset:1024
    s_waitcnt lgkmcnt(1)
    s_barrier
L_ip7:
    s_add_u32 s80, s61, 0
    v_mfma_f32_32x32x16_bf16 v[96:111], a[216:219], a[108:111], v[96:111]
    buffer_load_dwordx4 a[32:35], v252, s[24:27], s80 offen sc1
    ds_read_b64_tr_b16 a[240:241], v224 offset:49152
    ds_read_b64_tr_b16 a[242:243], v224 offset:50176
    v_mfma_f32_32x32x16_bf16 v[112:127], a[220:223], a[108:111], v[112:127]
    buffer_load_dwordx4 a[132:135], v231, s[24:27], s61 offen sc1
    ds_read_b64_tr_b16 a[244:245], v225 offset:49152
    ds_read_b64_tr_b16 a[246:247], v225 offset:50176
    v_mfma_f32_32x32x16_bf16 v[128:143], a[224:227], a[108:111], v[128:143]
    s_add_u32 m0, s44, 65536
    s_add_u32 s55, s69, 65536
    buffer_load_dwordx4 v230, s[28:31], s55 offen lds
    buffer_load_dwordx4 a[36:39], v252, s[24:27], s80 offen offset:1024 sc1
    ds_read_b64_tr_b16 a[248:249], v226 offset:49152
    ds_read_b64_tr_b16 a[250:251], v226 offset:50176
    v_mfma_f32_32x32x16_bf16 v[144:159], a[228:231], a[108:111], v[144:159]
    s_waitcnt lgkmcnt(6)
    ds_read_b64_tr_b16 a[252:253], v227 offset:49152
    ds_read_b64_tr_b16 a[254:255], v227 offset:50176
    v_mfma_f32_16x16x32_bf16 v[160:163], a[232:235], a[148:151], v[160:163]
    buffer_load_dwordx4 a[40:43], v252, s[24:27], s80 offen offset:2048 sc1
    ds_read_b64_tr_b16 a[208:209], v224 offset:53248
    ds_read_b64_tr_b16 a[210:211], v224 offset:54272
    v_mfma_f32_16x16x32_bf16 v[164:167], a[236:239], a[148:151], v[164:167]
    s_waitcnt lgkmcnt(8)
    s_add_u32 m0, s44, 69632
    s_add_u32 s55, s69, 81920
    buffer_load_dwordx4 v230, s[28:31], s55 offen lds
    v_mfma_f32_32x32x16_bf16 v[96:111], a[240:243], a[112:115], v[96:111]
    s_waitcnt lgkmcnt(6)
    buffer_load_dwordx4 a[44:47], v252, s[24:27], s80 offen offset:3072 sc1
    ds_read_b64_tr_b16 a[212:213], v225 offset:53248
    ds_read_b64_tr_b16 a[214:215], v225 offset:54272
    v_mfma_f32_32x32x16_bf16 v[112:127], a[244:247], a[112:115], v[112:127]
    s_waitcnt lgkmcnt(6)
    ds_read_b64_tr_b16 a[216:217], v226 offset:53248
    ds_read_b64_tr_b16 a[218:219], v226 offset:54272
    v_mfma_f32_32x32x16_bf16 v[128:143], a[248:251], a[112:115], v[128:143]
    s_waitcnt lgkmcnt(6)
    s_add_u32 m0, s44, 73728
    s_add_u32 s55, s69, 98304
    buffer_load_dwordx4 v230, s[28:31], s55 offen lds
    s_add_u32 s81, s61, 4096
    ds_read_b64_tr_b16 a[220:221], v227 offset:53248
    ds_read_b64_tr_b16 a[222:223], v227 offset:54272
    v_mfma_f32_32x32x16_bf16 v[144:159], a[252:255], a[112:115], v[144:159]
    s_waitcnt lgkmcnt(6)
    ds_read_b128 a[152:155], v254 offset:2048
    buffer_load_dwordx4 a[48:51], v252, s[24:27], s81 offen sc1
    ds_read_b64_tr_b16 a[224:225], v228 offset:49152
    ds_read_b64_tr_b16 a[226:227], v228 offset:50176
    ds_read_b64_tr_b16 a[228:229], v229 offset:49152
    ds_read_b64_tr_b16 a[230:231], v229 offset:50176
    v_mfma_f32_32x32x16_bf16 v[96:111], a[208:211], a[116:119], v[96:111]
    s_waitcnt lgkmcnt(9)
    ds_read_b64_tr_b16 a[232:233], v224 offset:57344
    ds_read_b64_tr_b16 a[234:235], v224 offset:58368
    ds_read_b64_tr_b16 a[248:249], v224 offset:61440
    ds_read_b64_tr_b16 a[250:251], v224 offset:62464
    v_add_u32 v237, s44, v254
    v_mfma_f32_32x32x16_bf16 v[112:127], a[212:215], a[116:119], v[112:127]
    s_waitcnt lgkmcnt(11)
    s_add_u32 m0, s44, 77824
    s_add_u32 s55, s69, 114688
    buffer_load_dwordx4 v230, s[28:31], s55 offen lds
    buffer_load_dwordx4 a[52:55], v252, s[24:27], s81 offen offset:1024 sc1
    ds_read_b64_tr_b16 a[236:237], v225 offset:57344
    ds_read_b64_tr_b16 a[238:239], v225 offset:58368
    ds_read_b64_tr_b16 a[252:253], v225 offset:61440
    ds_read_b64_tr_b16 a[254:255], v225 offset:62464
    v_mfma_f32_32x32x16_bf16 v[128:143], a[216:219], a[116:119], v[128:143]
    s_waitcnt lgkmcnt(13)
    ds_write_b128 v237, a[128:131] offset:4096
    ds_read_b64_tr_b16 a[240:241], v226 offset:57344
    ds_read_b64_tr_b16 a[242:243], v226 offset:58368
    ds_read_b64_tr_b16 a[208:209], v226 offset:61440
    ds_read_b64_tr_b16 a[210:211], v226 offset:62464
    v_mfma_f32_32x32x16_bf16 v[144:159], a[220:223], a[116:119], v[144:159]
    s_waitcnt lgkmcnt(15)
    buffer_load_dwordx4 a[56:59], v252, s[24:27], s81 offen offset:2048 sc1
    ds_read_b64_tr_b16 a[244:245], v227 offset:57344
    ds_read_b64_tr_b16 a[246:247], v227 offset:58368
    ds_read_b64_tr_b16 a[212:213], v227 offset:61440
    ds_read_b64_tr_b16 a[214:215], v227 offset:62464
    v_mfma_f32_16x16x32_bf16 v[160:163], a[224:227], a[152:155], v[160:163]
    s_waitcnt lgkmcnt(15)
    ds_read_b64_tr_b16 a[216:217], v228 offset:57344
    ds_read_b64_tr_b16 a[218:219], v228 offset:58368
    v_mfma_f32_16x16x32_bf16 v[164:167], a[228:231], a[152:155], v[164:167]
    buffer_load_dwordx4 a[60:63], v252, s[24:27], s81 offen offset:3072 sc1
    ds_read_b64_tr_b16 a[220:221], v229 offset:57344
    ds_read_b64_tr_b16 a[222:223], v229 offset:58368
    v_mfma_f32_32x32x16_bf16 v[96:111], a[232:235], a[120:123], v[96:111]
    s_waitcnt lgkmcnt(15)
    v_mfma_f32_32x32x16_bf16 v[112:127], a[236:239], a[120:123], v[112:127]
    s_waitcnt lgkmcnt(10)
    v_mfma_f32_32x32x16_bf16 v[128:143], a[240:243], a[120:123], v[128:143]
    s_waitcnt lgkmcnt(6)
    v_mfma_f32_32x32x16_bf16 v[144:159], a[244:247], a[120:123], v[144:159]
    ds_read_b128 a[156:159], v254 offset:3072
    s_waitcnt lgkmcnt(1)
    s_barrier
L_ip8:
    v_mfma_f32_32x32x16_bf16 v[96:111], a[248:251], a[124:127], v[96:111]
    ds_read_b64_tr_b16 a[224:225], v246 offset:0
    ds_read_b64_tr_b16 a[226:227], v246 offset:1024
    v_mfma_f32_32x32x16_bf16 v[112:127], a[252:255], a[124:127], v[112:127]
    ds_read_b64_tr_b16 a[228:229], v247 offset:0
    ds_read_b64_tr_b16 a[230:231], v247 offset:1024
    v_and_b32 v238, 112, v244
    v_lshl_add_u32 v238, v238, 3, s44
    v_mfma_f32_32x32x16_bf16 v[128:143], a[208:211], a[124:127], v[128:143]
    s_add_u32 m0, s44, 81920
    s_add_u32 s55, s70, 0
    buffer_load_dwordx4 v230, s[28:31], s55 offen lds
    s_add_u32 s78, s62, 0
    ds_read_b64_tr_b16 a[232:233], v248 offset:0
    ds_read_b64_tr_b16 a[234:235], v248 offset:1024
    v_add_u32 v238, L_ip14 - L_ibase, v238
    v_min_u32 v238, L_end - L_ibase - 64, v238
    v_mfma_f32_32x32x16_bf16 v[144:159], a[212:215], a[124:127], v[144:159]
    s_waitcnt lgkmcnt(6)
    buffer_load_dwordx4 a[64:67], v252, s[24:27], s78 offen sc1
    ds_read_b64_tr_b16 a[236:237], v249 offset:0
    ds_read_b64_tr_b16 a[238:239], v249 offset:1024
    v_mfma_f32_16x16x32_bf16 v[160:163], a[216:219], a[156:159], v[160:163]
    global_load_dword a140, v238, s[90:91]
    ds_read_b64_tr_b16 a[240:241], v246 offset:4096
    ds_read_b64_tr_b16 a[242:243], v246 offset:5120
    v_mfma_f32_16x16x32_bf16 v[164:167], a[220:223], a[156:159], v[164:167]
    s_waitcnt lgkmcnt(8)
    s_add_u32 m0, s44, 86016
    s_add_u32 s55, s70, 16384
    buffer_load_dwordx4 v230, s[28:31], s55 offen lds
    buffer_load_dwordx4 a[68:71], v252, s[24:27], s78 offen offset:1024 sc1
    v_mfma_f32_32x32x16_bf16 v[96:111], a[224:227], a[0:3], v[96:111]
    s_waitcnt lgkmcnt(6)
    ds_read_b64_tr_b16 a[244:245], v247 offset:4096
    ds_read_b64_tr_b16 a[246:247], v247 offset:5120
    v_mfma_f32_32x32x16_bf16 v[112:127], a[228:231], a[0:3], v[112:127]
    s_waitcnt lgkmcnt(6)
    buffer_load_dwordx4 a[72:75], v252, s[24:27], s78 offen offset:2048 sc1
    ds_read_b64_tr_b16 a[248:249], v248 offset:4096
    ds_read_b64_tr_b16 a[250:251], v248 offset:5120
    v_mfma_f32_32x32x16_bf16 v[128:143], a[232:235], a[0:3], v[128:143]
    s_waitcnt lgkmcnt(6)
    s_add_u32 m0, s44, 90112
    s_add_u32 s55, s70, 32768
    buffer_load_dwordx4 v230, s[28:31], s55 offen lds
    ds_read_b64_tr_b16 a[252:253], v249 offset:4096
    ds_read_b64_tr_b16 a[254:255], v249 offset:5120
    v_mfma_f32_32x32x16_bf16 v[144:159], a[236:239], a[0:3], v[144:159]
    s_waitcnt lgkmcnt(6)
    ds_read_b128 a[160:163], v254 offset:4096
    buffer_load_dwordx4 a[76:79], v252, s[24:27], s78 offen offset:3072 sc1
    ds_read_b64_tr_b16 a[208:209], v250 offset:0
    ds_read_b64_tr_b16 a[210:211], v250 offset:1024
    ds_read_b64_tr_b16 a[212:213], v251 offset:0
    ds_read_b64_tr_b16 a[214:215], v251 offset:1024
    v_mfma_f32_32x32x16_bf16 v[96:111], a[240:243], a[4:7], v[96:111]
    s_waitcnt lgkmcnt(9)
    ds_read_b64_tr_b16 a[216:217], v246 offset:8192
    ds_read_b64_tr_b16 a[218:219], v246 offset:9216
    ds_read_b64_tr_b16 a[232:233], v246 offset:12288
    ds_read_b64_tr_b16 a[234:235], v246 offset:13312
    v_mfma_f32_32x32x16_bf16 v[112:127], a[244:247], a[4:7], v[112:127]
    s_waitcnt lgkmcnt(11)
    s_add_u32 m0, s44, 94208
    s_add_u32 s55, s70, 49152
    buffer_load_dwordx4 v230, s[28:31], s55 offen lds
    ds_read_b64_tr_b16 a[220:221], v247 offset:8192
    ds_read_b64_tr_b16 a[222:223], v247 offset:9216
    ds_read_b64_tr_b16 a[236:237], v247 offset:12288
    ds_read_b64_tr_b16 a[238:239], v247 offset:13312
    v_mfma_f32_32x32x16_bf16 v[128:143], a[248:251], a[4:7], v[128:143]
    s_waitcnt lgkmcnt(13)
    ds_read_b64_tr_b16 a[224:225], v248 offset:8192
    ds_read_b64_tr_b16 a[226:227], v248 offset:9216
    ds_read_b64_tr_b16 a[240:241], v248 offset:12288
    ds_read_b64_tr_b16 a[242:243], v248 offset:13312
    v_mfma_f32_32x32x16_bf16 v[144:159], a[252:255], a[4:7], v[144:159]
    s_waitcnt lgkmcnt(14)
    ds_read_b64_tr_b16 a[228:229], v249 offset:8192
    ds_read_b64_tr_b16 a[230:231], v249 offset:9216
    ds_read_b64_tr_b16 a[244:245], v249 offset:12288
    ds_read_b64_tr_b16 a[246:247], v249 offset:13312
    v_mfma_f32_16x16x32_bf16 v[160:163], a[208:211], a[160:163], v[160:163]
    s_waitcnt lgkmcnt(15)
    ds_read_b64_tr_b16 a[248:249], v250 offset:8192
    ds_read_b64_tr_b16 a[250:251], v250 offset:9216
    v_mfma_f32_16x16x32_bf16 v[164:167], a[212:215], a[160:163], v[164:167]
    s_waitcnt lgkmcnt(15)
    ds_read_b64_tr_b16 a[252:253], v251 offset:8192
    ds_read_b64_tr_b16 a[254:255], v251 offset:9216
    v_mfma_f32_32x32x16_bf16 v[96:111], a[216:219], a[8:11], v[96:111]
    s_waitcnt lgkmcnt(14)
    v_mfma_f32_32x32x16_bf16 v[112:127], a[220:223], a[8:11], v[112:127]
    s_waitcnt lgkmcnt(10)
    v_mfma_f32_32x32x16_bf16 v[128:143], a[224:227], a[8:11], v[128:143]
    s_waitcnt lgkmcnt(6)
    v_mfma_f32_32x32x16_bf16 v[144:159], a[228:231], a[8:11], v[144:159]
    ds_read_b128 a[164:167], v254 offset:5120
    s_waitcnt vmcnt(26) lgkmcnt(1)
    s_barrier
L_ip9:
    v_mfma_f32_32x32x16_bf16 v[96:111], a[232:235], a[12:15], v[96:111]
    ds_read_b64_tr_b16 a[208:209], v246 offset:16384
    ds_read_b64_tr_b16 a[210:211], v246 offset:17408
    v_mfma_f32_32x32x16_bf16 v[112:127], a[236:239], a[12:15], v[112:127]
    ds_read_b64_tr_b16 a[212:213], v247 offset:16384
    ds_read_b64_tr_b16 a[214:215], v247 offset:17408
    v_mfma_f32_32x32x16_bf16 v[128:143], a[240:243], a[12:15], v[128:143]
    s_add_u32 m0, s44, 49152
    s_add_u32 s55, s70, 65536
    buffer_load_dwordx4 v230, s[28:31], s55 offen lds
    ds_read_b64_tr_b16 a[216:217], v248 offset:16384
    ds_read_b64_tr_b16 a[218:219], v248 offset:17408
    v_mfma_f32_32x32x16_bf16 v[144:159], a[244:247], a[12:15], v[144:159]
    s_waitcnt lgkmcnt(6)
    buffer_load_dwordx4 a[128:131], v231, s[24:27], s62 offen sc1
    ds_read_b64_tr_b16 a[220:221], v249 offset:16384
    ds_read_b64_tr_b16 a[222:223], v249 offset:17408
    v_mfma_f32_16x16x32_bf16 v[160:163], a[248:251], a[164:167], v[160:163]
    ds_read_b64_tr_b16 a[224:225], v246 offset:20480
    ds_read_b64_tr_b16 a[226:227], v246 offset:21504
    v_mfma_f32_16x16x32_bf16 v[164:167], a[252:255], a[164:167], v[164:167]
    s_waitcnt lgkmcnt(8)
    s_add_u32 m0, s44, 53248
    s_add_u32 s55, s70, 81920
    buffer_load_dwordx4 v230, s[28:31], s55 offen lds
    v_mfma_f32_32x32x16_bf16 v[96:111], a[208:211], a[16:19], v[96:111]
    s_waitcnt lgkmcnt(6)
    ds_read_b64_tr_b16 a[228:229], v247 offset:20480
    ds_read_b64_tr_b16 a[230:231], v247 offset:21504
    v_mfma_f32_32x32x16_bf16 v[112:127], a[212:215], a[16:19], v[112:127]
    s_waitcnt lgkmcnt(6)
    ds_read_b64_tr_b16 a[232:233], v248 offset:20480
    ds_read_b64_tr_b16 a[234:235], v248 offset:21504
    v_mfma_f32_32x32x16_bf16 v[128:143], a[216:219], a[16:19], v[128:143]
    s_waitcnt lgkmcnt(6)
    s_add_u32 m0, s44, 57344
    s_add_u32 s55, s70, 98304
    buffer_load_dwordx4 v230, s[28:31], s55 offen lds
    ds_read_b64_tr_b16 a[236:237], v249 offset:20480
    ds_read_b64_tr_b16 a[238:239], v249 offset:21504
    v_add_u32 v237, s44, v254
    v_mfma_f32_32x32x16_bf16 v[144:159], a[220:223], a[16:19], v[144:159]
    s_waitcnt vmcnt(24) lgkmcnt(6)
    ds_read_b128 a[168:171], v254 offset:6144
    ds_write_b128 v237, a[132:135] offset:8192
    ds_read_b64_tr_b16 a[240:241], v250 offset:16384
    ds_read_b64_tr_b16 a[242:243], v250 offset:17408
    ds_read_b64_tr_b16 a[244:245], v251 offset:16384
    ds_read_b64_tr_b16 a[246:247], v251 offset:17408
    v_mfma_f32_32x32x16_bf16 v[96:111], a[224:227], a[20:23], v[96:111]
    s_waitcnt lgkmcnt(10)
    s_add_u32 s79, s62, 4096
    ds_read_b64_tr_b16 a[248:249], v246 offset:24576
    ds_read_b64_tr_b16 a[250:251], v246 offset:25600
    ds_read_b64_tr_b16 a[216:217], v246 offset:28672
    ds_read_b64_tr_b16 a[218:219], v246 offset:29696
    v_mfma_f32_32x32x16_bf16 v[112:127], a[228:231], a[20:23], v[112:127]
    s_waitcnt lgkmcnt(12)
    s_add_u32 m0, s44, 61440
    s_add_u32 s55, s70, 114688
    buffer_load_dwordx4 v230, s[28:31], s55 offen lds
    buffer_load_dwordx4 a[80:83], v252, s[24:27], s79 offen sc1
    ds_read_b64_tr_b16 a[252:253], v247 offset:24576
    ds_read_b64_tr_b16 a[254:255], v247 offset:25600
    ds_read_b64_tr_b16 a[220:221], v247 offset:28672
    ds_read_b64_tr_b16 a[222:223], v247 offset:29696
    v_mfma_f32_32x32x16_bf16 v[128:143], a[232:235], a[20:23], v[128:143]
    s_waitcnt lgkmcnt(14)
    ds_read_b64_tr_b16 a[208:209], v248 offset:24576
    ds_read_b64_tr_b16 a[210:211], v248 offset:25600
    ds_read_b64_tr_b16 a[224:225], v248 offset:28672
    ds_read_b64_tr_b16 a[226:227], v248 offset:29696
    v_mfma_f32_32x32x16_bf16 v[144:159], a[236:239], a[20:23], v[144:159]
    s_waitcnt lgkmcnt(14)
    buffer_load_dwordx4 a[84:87], v252, s[24:27], s79 offen offset:1024 sc1
    ds_read_b64_tr_b16 a[212:213], v249 offset:24576
    ds_read_b64_tr_b16 a[214:215], v249 offset:25600
    ds_read_b64_tr_b16 a[228:229], v249 offset:28672
    ds_read_b64_tr_b16 a[230:231], v249 offset:29696
    v_mfma_f32_16x16x32_bf16 v[160:163], a[240:243], a[168:171], v[160:163]
    s_waitcnt lgkmcnt(15)
    ds_read_b64_tr_b16 a[232:233], v250 offset:24576
    ds_read_b64_tr_b16 a[234:235], v250 offset:25600
    v_mfma_f32_16x16x32_bf16 v[164:167], a[244:247], a[168:171], v[164:167]
    s_waitcnt lgkmcnt(15)
    buffer_load_dwordx4 a[88:91], v252, s[24:27], s79 offen offset:2048 sc1
    ds_read_b64_tr_b16 a[236:237], v251 offset:24576
    ds_read_b64_tr_b16 a[238:239], v251 offset:25600
    v_mfma_f32_32x32x16_bf16 v[96:111], a[248:251], a[24:27], v[96:111]
    s_waitcnt lgkmcnt(14)
    v_mfma_f32_32x32x16_bf16 v[112:127], a[252:255], a[24:27], v[112:127]
    s_waitcnt lgkmcnt(10)
    buffer_load_dwordx4 a[92:95], v252, s[24:27], s79 offen offset:3072 sc1
    v_mfma_f32_32x32x16_bf16 v[128:143], a[208:211], a[24:27], v[128:143]
    s_waitcnt lgkmcnt(6)
    v_mfma_f32_32x32x16_bf16 v[144:159], a[212:215], a[24:27], v[144:159]
    ds_read_b128 a[172:175], v254 offset:7168
    s_waitcnt lgkmcnt(1)
    s_barrier
L_ip10:
    v_mfma_f32_32x32x16_bf16 v[96:111], a[216:219], a[28:31], v[96:111]
    ds_read_b64_tr_b16 a[240:241], v246 offset:32768
    ds_read_b64_tr_b16 a[242:243], v246 offset:33792
    v_mfma_f32_32x32x16_bf16 v[112:127], a[220:223], a[28:31], v[112:127]
    ds_read_b64_tr_b16 a[244:245], v247 offset:32768
    ds_read_b64_tr_b16 a[246:247], v247 offset:33792
    v_mfma_f32_32x32x16_bf16 v[128:143], a[224:227], a[28:31], v[128:143]
    s_add_u32 m0, s44, 98304
    s_add_u32 s55, s71, 0
    buffer_load_dwordx4 v230, s[28:31], s55 offen lds
    s_add_u32 s80, s63, 0
    ds_read_b64_tr_b16 a[248:249], v248 offset:32768
    ds_read_b64_tr_b16 a[250:251], v248 offset:33792
    v_mfma_f32_32x32x16_bf16 v[144:159], a[228:231], a[28:31], v[144:159]
    s_waitcnt lgkmcnt(6)
    buffer_load_dwordx4 a[96:99], v252, s[24:27], s80 offen sc1
    ds_read_b64_tr_b16 a[252:253], v246 offset:36864
    ds_read_b64_tr_b16 a[254:255], v246 offset:37888
    v_mfma_f32_16x16x32_bf16 v[160:163], a[232:235], a[172:175], v[160:163]
    ds_read_b64_tr_b16 a[208:209], v247 offset:36864
    ds_read_b64_tr_b16 a[210:211], v247 offset:37888
    v_mfma_f32_16x16x32_bf16 v[164:167], a[236:239], a[172:175], v[164:167]
    s_waitcnt lgkmcnt(8)
    s_add_u32 m0, s44, 102400
    s_add_u32 s55, s71, 16384
    buffer_load_dwordx4 v230, s[28:31], s55 offen lds
    buffer_load_dwordx4 a[100:103], v252, s[24:27], s80 offen offset:1024 sc1
    v_mfma_f32_32x32x16_bf16 v[96:111], a[240:243], a[32:35], v[96:111]
    s_waitcnt lgkmcnt(6)
    ds_read_b64_tr_b16 a[212:213], v248 offset:36864
    ds_read_b64_tr_b16 a[214:215], v248 offset:37888
    ds_read_b64_tr_b16 a[232:233], v248 offset:40960
    ds_read_b64_tr_b16 a[234:235], v248 offset:41984
    v_mfma_f32_32x32x16_bf16 v[112:127], a[244:247], a[32:35], v[112:127]
    s_waitcnt lgkmcnt(8)
    ds_read_b128 a[176:179], v254 offset:8192
    buffer_load_dwordx4 a[104:107], v252, s[24:27], s80 offen offset:2048 sc1
    ds_read_b64_tr_b16 a[216:217], v250 offset:32768
    ds_read_b64_tr_b16 a[218:219], v250 offset:33792
    ds_read_b64_tr_b16 a[220:221], v251 offset:32768
    ds_read_b64_tr_b16 a[222:223], v251 offset:33792
    ds_read_b64_tr_b16 a[236:237], v246 offset:45056
    ds_read_b64_tr_b16 a[238:239], v246 offset:46080
    v_mfma_f32_32x32x16_bf16 v[128:143], a[248:251], a[32:35], v[128:143]
    s_waitcnt vmcnt(32) lgkmcnt(13)
    s_add_u32 m0, s44, 106496
    s_add_u32 s55, s71, 32768
    buffer_load_dwordx4 v230, s[28:31], s55 offen lds
    ds_read_b64_tr_b16 a[224:225], v246 offset:40960
    ds_read_b64_tr_b16 a[226:227], v246 offset:41984
    ds_read_b64_tr_b16 a[240:241], v247 offset:45056
    ds_read_b64_tr_b16 a[242:243], v247 offset:46080
    v_mfma_f32_32x32x16_bf16 v[96:111], a[252:255], a[36:39], v[96:111]
    s_waitcnt lgkmcnt(15)
    buffer_load_dwordx4 a[108:111], v252, s[24:27], s80 offen offset:3072 sc1
    ds_read_b64_tr_b16 a[228:229], v247 offset:40960
    ds_read_b64_tr_b16 a[230:231], v247 offset:41984
    ds_read_b64_tr_b16 a[244:245], v248 offset:45056
    ds_read_b64_tr_b16 a[246:247], v248 offset:46080
    v_mfma_f32_32x32x16_bf16 v[112:127], a[208:211], a[36:39], v[112:127]
    s_waitcnt lgkmcnt(15)
    ds_read_b64_tr_b16 a[248:249], v250 offset:40960
    ds_read_b64_tr_b16 a[250:251], v250 offset:41984
    v_mfma_f32_32x32x16_bf16 v[128:143], a[212:215], a[36:39], v[128:143]
    s_waitcnt lgkmcnt(14)
    s_add_u32 m0, s44, 110592
    s_add_u32 s55, s71, 49152
    buffer_load_dwordx4 v230, s[28:31], s55 offen lds
    ds_read_b64_tr_b16 a[252:253], v251 offset:40960
    ds_read_b64_tr_b16 a[254:255], v251 offset:41984
    v_mfma_f32_16x16x32_bf16 v[160:163], a[216:219], a[176:179], v[160:163]
    s_waitcnt lgkmcnt(14)
    v_mfma_f32_16x16x32_bf16 v[164:167], a[220:223], a[176:179], v[164:167]
    s_waitcnt vmcnt(34) lgkmcnt(10)
    v_mfma_f32_32x32x16_bf16 v[96:111], a[224:227], a[40:43], v[96:111]
    s_waitcnt lgkmcnt(6)
    v_mfma_f32_32x32x16_bf16 v[112:127], a[228:231], a[40:43], v[112:127]
    ds_read_b128 a[180:183], v254 offset:9216
    s_waitcnt vmcnt(29) lgkmcnt(1)
    s_barrier
L_ip11:
    v_mfma_f32_32x32x16_bf16 v[128:143], a[232:235], a[40:43], v[128:143]
    ds_read_b64_tr_b16 a[208:209], v224 offset:0
    ds_read_b64_tr_b16 a[210:211], v224 offset:1024
    v_mfma_f32_32x32x16_bf16 v[96:111], a[236:239], a[44:47], v[96:111]
    ds_read_b64_tr_b16 a[212:213], v225 offset:0
    ds_read_b64_tr_b16 a[214:215], v225 offset:1024
    v_mfma_f32_32x32x16_bf16 v[112:127], a[240:243], a[44:47], v[112:127]
    s_add_u32 m0, s44, 114688
    s_add_u32 s55, s71, 65536
    buffer_load_dwordx4 v230, s[28:31], s55 offen lds
    s_add_u32 s81, s63, 4096
    ds_read_b64_tr_b16 a[216:217], v226 offset:0
    ds_read_b64_tr_b16 a[218:219], v226 offset:1024
    v_mfma_f32_32x32x16_bf16 v[128:143], a[244:247], a[44:47], v[128:143]
    s_waitcnt lgkmcnt(6)
    buffer_load_dwordx4 a[112:115], v252, s[24:27], s81 offen sc1
    buffer_load_dwordx4 a[132:135], v231, s[24:27], s63 offen sc1
    ds_read_b64_tr_b16 a[220:221], v224 offset:4096
    ds_read_b64_tr_b16 a[222:223], v224 offset:5120
    v_mfma_f32_16x16x32_bf16 v[160:163], a[248:251], a[180:183], v[160:163]
    ds_read_b64_tr_b16 a[224:225], v225 offset:4096
    ds_read_b64_tr_b16 a[226:227], v225 offset:5120
    v_mfma_f32_16x16x32_bf16 v[164:167], a[252:255], a[180:183], v[164:167]
    s_waitcnt lgkmcnt(8)
    s_add_u32 m0, s44, 118784
    s_add_u32 s55, s71, 81920
    buffer_load_dwordx4 v230, s[28:31], s55 offen lds
    buffer_load_dwordx4 a[116:119], v252, s[24:27], s81 offen offset:1024 sc1
    v_mfma_f32_32x32x16_bf16 v[96:111], a[208:211], a[48:51], v[96:111]
    s_waitcnt lgkmcnt(6)
    ds_read_b64_tr_b16 a[228:229], v226 offset:4096
    ds_read_b64_tr_b16 a[230:231], v226 offset:5120
    ds_read_b64_tr_b16 a[248:249], v226 offset:8192
    ds_read_b64_tr_b16 a[250:251], v226 offset:9216
    v_mfma_f32_32x32x16_bf16 v[112:127], a[212:215], a[48:51], v[112:127]
    s_waitcnt lgkmcnt(8)
    ds_read_b128 a[184:187], v254 offset:10240
    buffer_load_dwordx4 a[120:123], v252, s[24:27], s81 offen offset:2048 sc1
    ds_read_b64_tr_b16 a[232:233], v228 offset:0
    ds_read_b64_tr_b16 a[234:235], v228 offset:1024
    ds_read_b64_tr_b16 a[236:237], v229 offset:0
    ds_read_b64_tr_b16 a[238:239], v229 offset:1024
    ds_read_b64_tr_b16 a[252:253], v224 offset:12288
    ds_read_b64_tr_b16 a[254:255], v224 offset:13312
    v_mfma_f32_32x32x16_bf16 v[128:143], a[216:219], a[48:51], v[128:143]
    s_waitcnt vmcnt(34) lgkmcnt(13)
    s_add_u32 m0, s44, 122880
    s_add_u32 s55, s71, 98304
    buffer_load_dwordx4 v230, s[28:31], s55 offen lds
    ds_read_b64_tr_b16 a[240:241], v224 offset:8192
    ds_read_b64_tr_b16 a[242:243], v224 offset:9216
    ds_read_b64_tr_b16 a[208:209], v225 offset:12288
    ds_read_b64_tr_b16 a[210:211], v225 offset:13312
    v_mfma_f32_32x32x16_bf16 v[96:111], a[220:223], a[52:55], v[96:111]
    s_waitcnt lgkmcnt(15)
    buffer_load_dwordx4 a[124:127], v252, s[24:27], s81 offen offset:3072 sc1
    ds_read_b64_tr_b16 a[244:245], v225 offset:8192
    ds_read_b64_tr_b16 a[246:247], v225 offset:9216
    ds_read_b64_tr_b16 a[212:213], v226 offset:12288
    ds_read_b64_tr_b16 a[214:215], v226 offset:13312
    v_add_u32 v237, s44, v254
    v_mfma_f32_32x32x16_bf16 v[112:127], a[224:227], a[52:55], v[112:127]
    s_waitcnt vmcnt(23) lgkmcnt(15)
    ds_write_b128 v237, a[128:131] offset:0
    ds_read_b64_tr_b16 a[216:217], v228 offset:8192
    ds_read_b64_tr_b16 a[218:219], v228 offset:9216
    v_mfma_f32_32x32x16_bf16 v[128:143], a[228:231], a[52:55], v[128:143]
    s_waitcnt lgkmcnt(15)
    s_add_u32 m0, s44, 126976
    s_add_u32 s55, s71, 114688
    buffer_load_dwordx4 v230, s[28:31], s55 offen lds
    ds_read_b64_tr_b16 a[220:221], v229 offset:8192
    ds_read_b64_tr_b16 a[222:223], v229 offset:9216
    v_mfma_f32_16x16x32_bf16 v[160:163], a[232:235], a[184:187], v[160:163]
    s_waitcnt lgkmcnt(15)
    v_mfma_f32_16x16x32_bf16 v[164:167], a[236:239], a[184:187], v[164:167]
    s_waitcnt lgkmcnt(11)
    v_mfma_f32_32x32x16_bf16 v[96:111], a[240:243], a[56:59], v[96:111]
    s_waitcnt lgkmcnt(7)
    v_mfma_f32_32x32x16_bf16 v[112:127], a[244:247], a[56:59], v[112:127]
    ds_read_b128 a[188:191], v254 offset:11264
    s_waitcnt lgkmcnt(1)
    s_barrier
L_ip12:
    v_mfma_f32_32x32x16_bf16 v[128:143], a[248:251], a[56:59], v[128:143]
    ds_read_b64_tr_b16 a[224:225], v224 offset:16384
    ds_read_b64_tr_b16 a[226:227], v224 offset:17408
    v_mfma_f32_32x32x16_bf16 v[96:111], a[252:255], a[60:63], v[96:111]
    ds_read_b64_tr_b16 a[228:229], v225 offset:16384
    ds_read_b64_tr_b16 a[230:231], v225 offset:17408
    v_and_b32 v238, 112, v244
    v_lshl_add_u32 v238, v238, 3, s44
    v_mfma_f32_32x32x16_bf16 v[112:127], a[208:211], a[60:63], v[112:127]
    ds_read_b64_tr_b16 a[232:233], v226 offset:16384
    ds_read_b64_tr_b16 a[234:235], v226 offset:17408
    v_add_u32 v238, L_ifin - L_ibase, v238
    v_min_u32 v238, L_end - L_ibase - 64, v238
    v_mfma_f32_32x32x16_bf16 v[128:143], a[212:215], a[60:63], v[128:143]
    s_waitcnt lgkmcnt(6)
    ds_read_b64_tr_b16 a[236:237], v224 offset:20480
    ds_read_b64_tr_b16 a[238:239], v224 offset:21504
    v_mfma_f32_16x16x32_bf16 v[160:163], a[216:219], a[188:191], v[160:163]
    global_load_dword a140, v238, s[90:91]
    ds_read_b64_tr_b16 a[240:241], v225 offset:20480
    ds_read_b64_tr_b16 a[242:243], v225 offset:21504
    v_mfma_f32_16x16x32_bf16 v[164:167], a[220:223], a[188:191], v[164:167]
    s_waitcnt lgkmcnt(8)
    v_mfma_f32_32x32x16_bf16 v[96:111], a[224:227], a[64:67], v[96:111]
    s_waitcnt lgkmcnt(6)
    ds_read_b64_tr_b16 a[244:245], v226 offset:20480
    ds_read_b64_tr_b16 a[246:247], v226 offset:21504
    ds_read_b64_tr_b16 a[216:217], v226 offset:24576
    ds_read_b64_tr_b16 a[218:219], v226 offset:25600
    v_mfma_f32_32x32x16_bf16 v[112:127], a[228:231], a[64:67], v[112:127]
    s_waitcnt lgkmcnt(8)
    ds_read_b128 a[144:147], v254 offset:0
    ds_read_b64_tr_b16 a[248:249], v228 offset:16384
    ds_read_b64_tr_b16 a[250:251], v228 offset:17408
    ds_read_b64_tr_b16 a[252:253], v229 offset:16384
    ds_read_b64_tr_b16 a[254:255], v229 offset:17408
    ds_read_b64_tr_b16 a[220:221], v224 offset:28672
    ds_read_b64_tr_b16 a[222:223], v224 offset:29696
    v_mfma_f32_32x32x16_bf16 v[128:143], a[232:235], a[64:67], v[128:143]
    s_waitcnt lgkmcnt(13)
    ds_read_b64_tr_b16 a[208:209], v224 offset:24576
    ds_read_b64_tr_b16 a[210:211], v224 offset:25600
    ds_read_b64_tr_b16 a[224:225], v225 offset:28672
    ds_read_b64_tr_b16 a[226:227], v225 offset:29696
    v_mfma_f32_32x32x16_bf16 v[96:111], a[236:239], a[68:71], v[96:111]
    s_waitcnt lgkmcnt(15)
    ds_read_b64_tr_b16 a[212:213], v225 offset:24576
    ds_read_b64_tr_b16 a[214:215], v225 offset:25600
    ds_read_b64_tr_b16 a[228:229], v226 offset:28672
    ds_read_b64_tr_b16 a[230:231], v226 offset:29696
    v_mfma_f32_32x32x16_bf16 v[112:127], a[240:243], a[68:71], v[112:127]
    s_waitcnt lgkmcnt(15)
    ds_read_b64_tr_b16 a[232:233], v228 offset:24576
    ds_read_b64_tr_b16 a[234:235], v228 offset:25600
    v_mfma_f32_32x32x16_bf16 v[128:143], a[244:247], a[68:71], v[128:143]
    s_waitcnt lgkmcnt(14)
    ds_read_b64_tr_b16 a[236:237], v229 offset:24576
    ds_read_b64_tr_b16 a[238:239], v229 offset:25600
    v_mfma_f32_16x16x32_bf16 v[160:163], a[248:251], a[144:147], v[160:163]
    s_waitcnt lgkmcnt(14)
    v_mfma_f32_16x16x32_bf16 v[164:167], a[252:255], a[144:147], v[164:167]
    s_waitcnt lgkmcnt(10)
    v_mfma_f32_32x32x16_bf16 v[96:111], a[208:211], a[72:75], v[96:111]
    s_waitcnt lgkmcnt(6)
    v_mfma_f32_32x32x16_bf16 v[112:127], a[212:215], a[72:75], v[112:127]
    ds_read_b128 a[148:151], v254 offset:1024
    s_waitcnt vmcnt(22) lgkmcnt(1)
    s_barrier
L_ip13:
    v_mfma_f32_32x32x16_bf16 v[128:143], a[216:219], a[72:75], v[128:143]
    ds_read_b64_tr_b16 a[240:241], v246 offset:49152
    ds_read_b64_tr_b16 a[242:243], v246 offset:50176
    v_mfma_f32_32x32x16_bf16 v[96:111], a[220:223], a[76:79], v[96:111]
    ds_read_b64_tr_b16 a[244:245], v247 offset:49152
    ds_read_b64_tr_b16 a[246:247], v247 offset:50176
    v_mfma_f32_32x32x16_bf16 v[112:127], a[224:227], a[76:79], v[112:127]
    ds_read_b64_tr_b16 a[248:249], v248 offset:49152
    ds_read_b64_tr_b16 a[250:251], v248 offset:50176
    v_mfma_f32_32x32x16_bf16 v[128:143], a[228:231], a[76:79], v[128:143]
    s_waitcnt lgkmcnt(6)
    ds_read_b64_tr_b16 a[252:253], v246 offset:53248
    ds_read_b64_tr_b16 a[254:255], v246 offset:54272
    v_mfma_f32_16x16x32_bf16 v[160:163], a[232:235], a[148:151], v[160:163]
    ds_read_b64_tr_b16 a[208:209], v247 offset:53248
    ds_read_b64_tr_b16 a[210:211], v247 offset:54272
    v_mfma_f32_16x16x32_bf16 v[164:167], a[236:239], a[148:151], v[164:167]
    s_waitcnt vmcnt(21) lgkmcnt(8)
    v_mfma_f32_32x32x16_bf16 v[96:111], a[240:243], a[80:83], v[96:111]
    s_waitcnt lgkmcnt(6)
    ds_read_b64_tr_b16 a[212:213], v248 offset:53248
    ds_read_b64_tr_b16 a[214:215], v248 offset:54272
    ds_read_b64_tr_b16 a[232:233], v248 offset:57344
    ds_read_b64_tr_b16 a[234:235], v248 offset:58368
    v_mfma_f32_32x32x16_bf16 v[112:127], a[244:247], a[80:83], v[112:127]
    s_waitcnt lgkmcnt(8)
    ds_read_b128 a[152:155], v254 offset:2048
    ds_read_b64_tr_b16 a[216:217], v250 offset:49152
    ds_read_b64_tr_b16 a[218:219], v250 offset:50176
    ds_read_b64_tr_b16 a[220:221], v251 offset:49152
    ds_read_b64_tr_b16 a[222:223], v251 offset:50176
    ds_read_b64_tr_b16 a[236:237], v246 offset:61440
    ds_read_b64_tr_b16 a[238:239], v246 offset:62464
    v_mfma_f32_32x32x16_bf16 v[128:143], a[248:251], a[80:83], v[128:143]
    s_waitcnt vmcnt(20) lgkmcnt(13)
    ds_read_b64_tr_b16 a[224:225], v246 offset:57344
    ds_read_b64_tr_b16 a[226:227], v246 offset:58368
    ds_read_b64_tr_b16 a[240:241], v247 offset:61440
    ds_read_b64_tr_b16 a[242:243], v247 offset:62464
    v_add_u32 v237, s44, v254
    v_mfma_f32_32x32x16_bf16 v[96:111], a[252:255], a[84:87], v[96:111]
    s_waitcnt vmcnt(7) lgkmcnt(15)
    ds_write_b128 v237, a[132:135] offset:4096
    ds_read_b64_tr_b16 a[228:229], v247 offset:57344
    ds_read_b64_tr_b16 a[230:231], v247 offset:58368
    ds_read_b64_tr_b16 a[244:245], v248 offset:61440
    ds_read_b64_tr_b16 a[246:247], v248 offset:62464
    v_mfma_f32_32x32x16_bf16 v[112:127], a[208:211], a[84:87], v[112:127]
    s_waitcnt lgkmcnt(15)
    ds_read_b64_tr_b16 a[248:249], v250 offset:57344
    ds_read_b64_tr_b16 a[250:251], v250 offset:58368
    v_mfma_f32_32x32x16_bf16 v[128:143], a[212:215], a[84:87], v[128:143]
    s_waitcnt lgkmcnt(15)
    ds_read_b64_tr_b16 a[252:253], v251 offset:57344
    ds_read_b64_tr_b16 a[254:255], v251 offset:58368
    v_mfma_f32_16x16x32_bf16 v[160:163], a[216:219], a[152:155], v[160:163]
    s_waitcnt lgkmcnt(15)
    v_mfma_f32_16x16x32_bf16 v[164:167], a[220:223], a[152:155], v[164:167]
    s_waitcnt lgkmcnt(11)
    v_mfma_f32_32x32x16_bf16 v[96:111], a[224:227], a[88:91], v[96:111]
    s_waitcnt lgkmcnt(6)
    v_mfma_f32_32x32x16_bf16 v[112:127], a[228:231], a[88:91], v[112:127]
    ds_read_b128 a[156:159], v254 offset:3072
    s_waitcnt lgkmcnt(1)
    s_barrier
L_ip14:
    v_mfma_f32_32x32x16_bf16 v[128:143], a[232:235], a[88:91], v[128:143]
    ds_read_b64_tr_b16 a[208:209], v224 offset:32768
    ds_read_b64_tr_b16 a[210:211], v224 offset:33792
    v_mfma_f32_32x32x16_bf16 v[96:111], a[236:239], a[92:95], v[96:111]
    ds_read_b64_tr_b16 a[212:213], v225 offset:32768
    ds_read_b64_tr_b16 a[214:215], v225 offset:33792
    v_mfma_f32_32x32x16_bf16 v[112:127], a[240:243], a[92:95], v[112:127]
    ds_read_b64_tr_b16 a[216:217], v226 offset:32768
    ds_read_b64_tr_b16 a[218:219], v226 offset:33792
    v_mfma_f32_32x32x16_bf16 v[128:143], a[244:247], a[92:95], v[128:143]
    s_waitcnt lgkmcnt(6)
    ds_read_b64_tr_b16 a[220:221], v224 offset:36864
    ds_read_b64_tr_b16 a[222:223], v224 offset:37888
    v_mfma_f32_16x16x32_bf16 v[160:163], a[248:251], a[156:159], v[160:163]
    ds_read_b64_tr_b16 a[224:225], v225 offset:36864
    ds_read_b64_tr_b16 a[226:227], v225 offset:37888
    v_mfma_f32_16x16x32_bf16 v[164:167], a[252:255], a[156:159], v[164:167]
    s_waitcnt lgkmcnt(8)
    v_mfma_f32_32x32x16_bf16 v[96:111], a[208:211], a[96:99], v[96:111]
    s_waitcnt lgkmcnt(6)
    ds_read_b64_tr_b16 a[228:229], v226 offset:36864
    ds_read_b64_tr_b16 a[230:231], v226 offset:37888
    ds_read_b64_tr_b16 a[248:249], v226 offset:40960
    ds_read_b64_tr_b16 a[250:251], v226 offset:41984
    v_mfma_f32_32x32x16_bf16 v[112:127], a[212:215], a[96:99], v[112:127]
    s_waitcnt lgkmcnt(8)
    ds_read_b128 a[160:163], v254 offset:4096
    ds_read_b64_tr_b16 a[232:233], v228 offset:32768
    ds_read_b64_tr_b16 a[234:235], v228 offset:33792
    ds_read_b64_tr_b16 a[236:237], v229 offset:32768
    ds_read_b64_tr_b16 a[238:239], v229 offset:33792
    ds_read_b64_tr_b16 a[252:253], v224 offset:45056
    ds_read_b64_tr_b16 a[254:255], v224 offset:46080
    v_mfma_f32_32x32x16_bf16 v[128:143], a[216:219], a[96:99], v[128:143]
    s_waitcnt lgkmcnt(13)
    ds_read_b64_tr_b16 a[240:241], v224 offset:40960
    ds_read_b64_tr_b16 a[242:243], v224 offset:41984
    ds_read_b64_tr_b16 a[208:209], v225 offset:45056
    ds_read_b64_tr_b16 a[210:211], v225 offset:46080
    v_mfma_f32_32x32x16_bf16 v[96:111], a[220:223], a[100:103], v[96:111]
    s_waitcnt lgkmcnt(15)
    ds_read_b64_tr_b16 a[244:245], v225 offset:40960
    ds_read_b64_tr_b16 a[246:247], v225 offset:41984
    ds_read_b64_tr_b16 a[212:213], v226 offset:45056
    ds_read_b64_tr_b16 a[214:215], v226 offset:46080
    v_mfma_f32_32x32x16_bf16 v[112:127], a[224:227], a[100:103], v[112:127]
    s_waitcnt lgkmcnt(15)
    ds_read_b64_tr_b16 a[216:217], v228 offset:40960
    ds_read_b64_tr_b16 a[218:219], v228 offset:41984
    v_mfma_f32_32x32x16_bf16 v[128:143], a[228:231], a[100:103], v[128:143]
    s_waitcnt lgkmcnt(14)
    ds_read_b64_tr_b16 a[220:221], v229 offset:40960
    ds_read_b64_tr_b16 a[222:223], v229 offset:41984
    v_mfma_f32_16x16x32_bf16 v[160:163], a[232:235], a[160:163], v[160:163]
    s_waitcnt lgkmcnt(14)
    v_mfma_f32_16x16x32_bf16 v[164:167], a[236:239], a[160:163], v[164:167]
    s_waitcnt lgkmcnt(10)
    v_mfma_f32_32x32x16_bf16 v[96:111], a[240:243], a[104:107], v[96:111]
    s_waitcnt lgkmcnt(6)
    v_mfma_f32_32x32x16_bf16 v[112:127], a[244:247], a[104:107], v[112:127]
    ds_read_b128 a[164:167], v254 offset:5120
    s_waitcnt vmcnt(1) lgkmcnt(1)
    s_barrier
L_ip15:
    v_mfma_f32_32x32x16_bf16 v[128:143], a[248:251], a[104:107], v[128:143]
    ds_read_b64_tr_b16 a[224:225], v224 offset:49152
    ds_read_b64_tr_b16 a[226:227], v224 offset:50176
    v_mfma_f32_32x32x16_bf16 v[96:111], a[252:255], a[108:111], v[96:111]
    ds_read_b64_tr_b16 a[228:229], v225 offset:49152
    ds_read_b64_tr_b16 a[230:231], v225 offset:50176
    v_mfma_f32_32x32x16_bf16 v[112:127], a[208:211], a[108:111], v[112:127]
    ds_read_b64_tr_b16 a[232:233], v226 offset:49152
    ds_read_b64_tr_b16 a[234:235], v226 offset:50176
    v_mfma_f32_32x32x16_bf16 v[128:143], a[212:215], a[108:111], v[128:143]
    s_waitcnt lgkmcnt(6)
    ds_read_b64_tr_b16 a[236:237], v224 offset:53248
    ds_read_b64_tr_b16 a[238:239], v224 offset:54272
    v_mfma_f32_16x16x32_bf16 v[160:163], a[216:219], a[164:167], v[160:163]
    ds_read_b64_tr_b16 a[240:241], v225 offset:53248
    ds_read_b64_tr_b16 a[242:243], v225 offset:54272
    v_mfma_f32_16x16x32_bf16 v[164:167], a[220:223], a[164:167], v[164:167]
    s_waitcnt lgkmcnt(8)
    v_mfma_f32_32x32x16_bf16 v[96:111], a[224:227], a[112:115], v[96:111]
    s_waitcnt lgkmcnt(6)
    ds_read_b64_tr_b16 a[244:245], v226 offset:53248
    ds_read_b64_tr_b16 a[246:247], v226 offset:54272
    v_mfma_f32_32x32x16_bf16 v[112:127], a[228:231], a[112:115], v[112:127]
    s_waitcnt lgkmcnt(6)
    ds_read_b128 a[168:171], v254 offset:6144
    ds_read_b64_tr_b16 a[248:249], v228 offset:49152
    ds_read_b64_tr_b16 a[250:251], v228 offset:50176
    ds_read_b64_tr_b16 a[252:253], v229 offset:49152
    ds_read_b64_tr_b16 a[254:255], v229 offset:50176
    v_mfma_f32_32x32x16_bf16 v[128:143], a[232:235], a[112:115], v[128:143]
    s_waitcnt lgkmcnt(9)
    ds_read_b64_tr_b16 a[208:209], v224 offset:57344
    ds_read_b64_tr_b16 a[210:211], v224 offset:58368
    v_mfma_f32_32x32x16_bf16 v[96:111], a[236:239], a[116:119], v[96:111]
    s_waitcnt lgkmcnt(9)
    ds_read_b64_tr_b16 a[212:213], v225 offset:57344
    ds_read_b64_tr_b16 a[214:215], v225 offset:58368
    v_mfma_f32_32x32x16_bf16 v[112:127], a[240:243], a[116:119], v[112:127]
    s_waitcnt lgkmcnt(9)
    ds_read_b64_tr_b16 a[216:217], v226 offset:57344
    ds_read_b64_tr_b16 a[218:219], v226 offset:58368
    v_mfma_f32_32x32x16_bf16 v[128:143], a[244:247], a[116:119], v[128:143]
    s_waitcnt lgkmcnt(8)
    ds_read_b64_tr_b16 a[220:221], v224 offset:61440
    ds_read_b64_tr_b16 a[222:223], v224 offset:62464
    v_mfma_f32_16x16x32_bf16 v[160:163], a[248:251], a[168:171], v[160:163]
    s_waitcnt lgkmcnt(8)
    ds_read_b64_tr_b16 a[224:225], v225 offset:61440
    ds_read_b64_tr_b16 a[226:227], v225 offset:62464
    v_mfma_f32_16x16x32_bf16 v[164:167], a[252:255], a[168:171], v[164:167]
    s_waitcnt lgkmcnt(8)
    v_mfma_f32_32x32x16_bf16 v[96:111], a[208:211], a[120:123], v[96:111]
    s_waitcnt lgkmcnt(6)
    ds_read_b64_tr_b16 a[228:229], v226 offset:61440
    ds_read_b64_tr_b16 a[230:231], v226 offset:62464
    v_mfma_f32_32x32x16_bf16 v[112:127], a[212:215], a[120:123], v[112:127]
    s_waitcnt lgkmcnt(6)
    ds_read_b128 a[172:175], v254 offset:7168
    ds_read_b64_tr_b16 a[232:233], v228 offset:57344
    ds_read_b64_tr_b16 a[234:235], v228 offset:58368
    ds_read_b64_tr_b16 a[236:237], v229 offset:57344
    ds_read_b64_tr_b16 a[238:239], v229 offset:58368
    v_mfma_f32_32x32x16_bf16 v[128:143], a[216:219], a[120:123], v[128:143]
    s_waitcnt lgkmcnt(9)
    ds_read_b64_tr_b16 a[240:241], v249 offset:32768
    ds_read_b64_tr_b16 a[242:243], v249 offset:33792
    v_mfma_f32_32x32x16_bf16 v[96:111], a[220:223], a[124:127], v[96:111]
    s_waitcnt lgkmcnt(9)
    ds_read_b64_tr_b16 a[244:245], v249 offset:36864
    ds_read_b64_tr_b16 a[246:247], v249 offset:37888
    v_mfma_f32_32x32x16_bf16 v[112:127], a[224:227], a[124:127], v[112:127]
    s_waitcnt lgkmcnt(9)
    ds_read_b64_tr_b16 a[248:249], v249 offset:40960
    ds_read_b64_tr_b16 a[250:251], v249 offset:41984
    v_mfma_f32_32x32x16_bf16 v[128:143], a[228:231], a[124:127], v[128:143]
    s_waitcnt lgkmcnt(8)
    ds_read_b64_tr_b16 a[252:253], v249 offset:45056
    ds_read_b64_tr_b16 a[254:255], v249 offset:46080
    v_mfma_f32_16x16x32_bf16 v[160:163], a[232:235], a[172:175], v[160:163]
    s_waitcnt lgkmcnt(8)
    ds_read_b64_tr_b16 a[208:209], v227 offset:0
    ds_read_b64_tr_b16 a[210:211], v227 offset:1024
    v_mfma_f32_16x16x32_bf16 v[164:167], a[236:239], a[172:175], v[164:167]
    s_waitcnt lgkmcnt(8)
    v_mfma_f32_32x32x16_bf16 v[144:159], a[240:243], a[32:35], v[144:159]
    s_waitcnt lgkmcnt(6)
    ds_read_b64_tr_b16 a[212:213], v227 offset:4096
    ds_read_b64_tr_b16 a[214:215], v227 offset:5120
    v_mfma_f32_32x32x16_bf16 v[144:159], a[244:247], a[36:39], v[144:159]
    s_waitcnt lgkmcnt(6)
    ds_read_b64_tr_b16 a[216:217], v227 offset:8192
    ds_read_b64_tr_b16 a[218:219], v227 offset:9216
    v_lshrrev_b32 v236, 1, s43
    v_add_u32 v236, v236, v244
    v_cvt_pk_bf16_f32 v0, v96, v97
    v_cvt_pk_bf16_f32 v1, v98, v99
    v_mfma_f32_32x32x16_bf16 v[144:159], a[248:251], a[40:43], v[144:159]
    s_waitcnt lgkmcnt(6)
    ds_read_b64_tr_b16 a[220:221], v227 offset:12288
    ds_read_b64_tr_b16 a[222:223], v227 offset:13312
    v_cvt_pk_bf16_f32 v2, v100, v101
    v_cvt_pk_bf16_f32 v3, v102, v103
    v_cvt_pk_bf16_f32 v4, v104, v105
    v_cvt_pk_bf16_f32 v5, v106, v107
    v_mfma_f32_32x32x16_bf16 v[144:159], a[252:255], a[44:47], v[144:159]
    s_waitcnt lgkmcnt(6)
    s_add_u32 s7, s38, 1
    s_and_b32 s7, s7, 3
    ds_read_b64_tr_b16 a[224:225], v227 offset:16384
    ds_read_b64_tr_b16 a[226:227], v227 offset:17408
    v_cvt_pk_bf16_f32 v6, v108, v109
    v_cvt_pk_bf16_f32 v7, v110, v111
    v_mfma_f32_32x32x16_bf16 v[144:159], a[208:211], a[48:51], v[144:159]
    s_waitcnt lgkmcnt(6)
    s_lshl_b32 s7, s7, 2
    s_add_u32 s7, s7, s38
    s_mul_i32 s7, s7, 9216
    s_add_u32 s82, s7, s5
    ds_read_b64_tr_b16 a[228:229], v227 offset:20480
    ds_read_b64_tr_b16 a[230:231], v227 offset:21504
    v_mfma_f32_32x32x16_bf16 v[144:159], a[212:215], a[52:55], v[144:159]
    s_waitcnt lgkmcnt(6)
    buffer_store_dwordx4 v[0:3], v236, s[24:27], s82 offen sc1
    buffer_store_dwordx4 v[4:7], v236, s[24:27], s82 offen offset:1024 sc1
    ds_read_b64_tr_b16 a[232:233], v227 offset:24576
    ds_read_b64_tr_b16 a[234:235], v227 offset:25600
    v_cvt_pk_bf16_f32 v16, v112, v113
    v_cvt_pk_bf16_f32 v17, v114, v115
    v_mfma_f32_32x32x16_bf16 v[144:159], a[216:219], a[56:59], v[144:159]
    s_waitcnt lgkmcnt(6)
    ds_read_b64_tr_b16 a[236:237], v227 offset:28672
    ds_read_b64_tr_b16 a[238:239], v227 offset:29696
    v_cvt_pk_bf16_f32 v18, v116, v117
    v_cvt_pk_bf16_f32 v19, v118, v119
    v_cvt_pk_bf16_f32 v20, v120, v121
    v_cvt_pk_bf16_f32 v21, v122, v123
    v_mfma_f32_32x32x16_bf16 v[144:159], a[220:223], a[60:63], v[144:159]
    s_waitcnt lgkmcnt(6)
    s_add_u32 s7, s38, 2
    s_and_b32 s7, s7, 3
    ds_read_b64_tr_b16 a[240:241], v249 offset:49152
    ds_read_b64_tr_b16 a[242:243], v249 offset:50176
    v_cvt_pk_bf16_f32 v22, v124, v125
    v_cvt_pk_bf16_f32 v23, v126, v127
    v_mfma_f32_32x32x16_bf16 v[144:159], a[224:227], a[64:67], v[144:159]
    s_waitcnt lgkmcnt(6)
    s_lshl_b32 s7, s7, 2
    s_add_u32 s7, s7, s38
    s_mul_i32 s7, s7, 9216
    ds_read_b64_tr_b16 a[244:245], v249 offset:53248
    ds_read_b64_tr_b16 a[246:247], v249 offset:54272
    v_mfma_f32_32x32x16_bf16 v[144:159], a[228:231], a[68:71], v[144:159]
    s_waitcnt lgkmcnt(6)
    s_add_u32 s83, s7, s5
    buffer_store_dwordx4 v[16:19], v236, s[24:27], s83 offen sc1
    buffer_store_dwordx4 v[20:23], v236, s[24:27], s83 offen offset:1024 sc1
    ds_read_b64_tr_b16 a[248:249], v249 offset:57344
    ds_read_b64_tr_b16 a[250:251], v249 offset:58368
    v_cvt_pk_bf16_f32 v32, v128, v129
    v_mfma_f32_32x32x16_bf16 v[144:159], a[232:235], a[72:75], v[144:159]
    s_waitcnt lgkmcnt(6)
    ds_read_b64_tr_b16 a[252:253], v249 offset:61440
    ds_read_b64_tr_b16 a[254:255], v249 offset:62464
    v_cvt_pk_bf16_f32 v33, v130, v131
    v_cvt_pk_bf16_f32 v34, v132, v133
    v_cvt_pk_bf16_f32 v35, v134, v135
    v_cvt_pk_bf16_f32 v36, v136, v137
    v_mfma_f32_32x32x16_bf16 v[144:159], a[236:239], a[76:79], v[144:159]
    s_waitcnt lgkmcnt(6)
    s_add_u32 s7, s38, 3
    ds_read_b64_tr_b16 a[208:209], v227 offset:32768
    ds_read_b64_tr_b16 a[210:211], v227 offset:33792
    v_cvt_pk_bf16_f32 v37, v138, v139
    v_cvt_pk_bf16_f32 v38, v140, v141
    v_cvt_pk_bf16_f32 v39, v142, v143
    v_mfma_f32_32x32x16_bf16 v[144:159], a[240:243], a[80:83], v[144:159]
    s_waitcnt lgkmcnt(6)
    s_and_b32 s7, s7, 3
    s_lshl_b32 s7, s7, 2
    s_add_u32 s7, s7, s38
    s_mul_i32 s7, s7, 9216
    ds_read_b64_tr_b16 a[212:213], v227 offset:36864
    ds_read_b64_tr_b16 a[214:215], v227 offset:37888
    v_mfma_f32_32x32x16_bf16 v[144:159], a[244:247], a[84:87], v[144:159]
    s_waitcnt lgkmcnt(6)
    s_add_u32 s84, s7, s5
    buffer_store_dwordx4 v[32:35], v236, s[24:27], s84 offen sc1
    buffer_store_dwordx4 v[36:39], v236, s[24:27], s84 offen offset:1024 sc1
    s_lshl_b32 s7, s36, 2
    ds_read_b64_tr_b16 a[216:217], v227 offset:40960
    ds_read_b64_tr_b16 a[218:219], v227 offset:41984
    v_mfma_f32_32x32x16_bf16 v[144:159], a[248:251], a[88:91], v[144:159]
    s_waitcnt lgkmcnt(6)
    s_add_u32 s7, s7, s38
    s_mul_i32 s7, s7, 9216
    s_add_u32 s7, s7, s5
    s_add_u32 s46, s7, 8192
    ds_read_b64_tr_b16 a[220:221], v227 offset:45056
    ds_read_b64_tr_b16 a[222:223], v227 offset:46080
    v_mfma_f32_32x32x16_bf16 v[144:159], a[252:255], a[92:95], v[144:159]
    s_waitcnt lgkmcnt(6)
    ds_read_b64_tr_b16 a[224:225], v227 offset:49152
    ds_read_b64_tr_b16 a[226:227], v227 offset:50176
    v_lshrrev_b32 v237, 1, v244
    v_cvt_pk_bf16_f32 v48, v160, v161
    v_cvt_pk_bf16_f32 v49, v162, v163
    v_mfma_f32_32x32x16_bf16 v[144:159], a[208:211], a[96:99], v[144:159]
    s_waitcnt lgkmcnt(6)
    buffer_store_dwordx2 v[48:49], v237, s[24:27], s46 offen sc1
    ds_read_b64_tr_b16 a[228:229], v227 offset:53248
    ds_read_b64_tr_b16 a[230:231], v227 offset:54272
    v_cvt_pk_bf16_f32 v50, v164, v165
    v_cvt_pk_bf16_f32 v51, v166, v167
    v_mfma_f32_32x32x16_bf16 v[144:159], a[212:215], a[100:103], v[144:159]
    s_waitcnt lgkmcnt(6)
    buffer_store_dwordx2 v[50:51], v237, s[24:27], s46 offen offset:512 sc1
    ds_read_b64_tr_b16 a[232:233], v227 offset:57344
    ds_read_b64_tr_b16 a[234:235], v227 offset:58368
    v_mfma_f32_32x32x16_bf16 v[144:159], a[216:219], a[104:107], v[144:159]
    s_waitcnt lgkmcnt(6)
    ds_read_b64_tr_b16 a[236:237], v227 offset:61440
    ds_read_b64_tr_b16 a[238:239], v227 offset:62464
    v_mfma_f32_32x32x16_bf16 v[144:159], a[220:223], a[108:111], v[144:159]
    s_waitcnt lgkmcnt(6)
    v_mfma_f32_32x32x16_bf16 v[144:159], a[224:227], a[112:115], v[144:159]
    s_waitcnt lgkmcnt(4)
    v_mfma_f32_32x32x16_bf16 v[144:159], a[228:231], a[116:119], v[144:159]
    s_waitcnt lgkmcnt(2)
    v_mfma_f32_32x32x16_bf16 v[144:159], a[232:235], a[120:123], v[144:159]
    s_waitcnt lgkmcnt(0)
    v_mfma_f32_32x32x16_bf16 v[144:159], a[236:239], a[124:127], v[144:159]
L_ifin:
    s_nop 15

    v_lshrrev_b32 v1, 4, v244
    v_cmp_eq_u32 vcc, 0, v1
    s_lshl_b32 s6, s38, 7
    v_mov_b32 v2, s6
    v_mov_b32 v3, 2147483647
    v_cndmask_b32 v2, v3, v2, vcc
    v_lshlrev_b32 v3, 3, v244
    v_and_b32 v3, 0x180, v3
    s_mov_b32 s97, 0
    s_waitcnt vmcnt(0)

    s_barrier
    s_cmp_lg_u32 s36, 0
    s_cbranch_scc1 L_fgo
    buffer_store_dword v255, v2, s[24:27], s4 offen sc1
    s_sleep 16

L_fpoll:

    buffer_load_dword v56, v3, s[24:27], s4 offen sc1
    s_waitcnt vmcnt(0)
    v_cmp_ne_u32 vcc, v56, v255
    s_add_u32 s97, s97, 1
    s_cmp_ge_u32 s97, 131072
    s_cbranch_scc1 L_fgo
    s_cbranch_vccz L_fgo
    s_sleep 2
    s_branch L_fpoll

L_fgo:
    s_barrier

    s_lshl_b32 s6, s38, 2
    s_mul_i32 s6, s6, 9216
    s_add_u32 s6, s6, s5
    s_lshr_b32 s7, s43, 1
    v_add_u32 v10, s7, v244
    s_and_b32 s7, s36, 1
    s_lshl_b32 s7, s7, 9
    s_add_u32 s7, s7, 8192
    v_lshrrev_b32 v11, 1, v244
    v_add_u32 v11, s7, v11

    s_add_u32 s7, s38, 1
    s_and_b32 s7, s7, 3
    s_mul_i32 s7, s7, 9216
    s_add_u32 s45, s7, s6

    buffer_load_dwordx4 v[16:19], v10, s[24:27], s45 offen offset:0 sc1
    buffer_load_dwordx4 v[20:23], v10, s[24:27], s45 offen offset:1024 sc1

    s_add_u32 s7, s38, 2
    s_and_b32 s7, s7, 3
    s_mul_i32 s7, s7, 9216
    s_add_u32 s45, s7, s6

    buffer_load_dwordx4 v[24:27], v10, s[24:27], s45 offen offset:0 sc1
    buffer_load_dwordx4 v[28:31], v10, s[24:27], s45 offen offset:1024 sc1

    s_add_u32 s7, s38, 3
    s_and_b32 s7, s7, 3
    s_mul_i32 s7, s7, 9216
    s_add_u32 s45, s7, s6

    buffer_load_dwordx4 v[32:35], v10, s[24:27], s45 offen offset:0 sc1
    buffer_load_dwordx4 v[36:39], v10, s[24:27], s45 offen offset:1024 sc1
    s_add_u32 s45, s6, 0
    buffer_load_dwordx2 v[40:41], v11, s[24:27], s45 offen sc1
    s_add_u32 s45, s6, 9216
    buffer_load_dwordx2 v[42:43], v11, s[24:27], s45 offen sc1
    s_add_u32 s45, s6, 18432
    buffer_load_dwordx2 v[44:45], v11, s[24:27], s45 offen sc1
    s_add_u32 s45, s6, 27648
    buffer_load_dwordx2 v[46:47], v11, s[24:27], s45 offen sc1

    v_lshrrev_b32 v2, 4, v244
    v_and_b32 v3, 15, v2
    v_lshrrev_b32 v4, 4, v2
    v_and_b32 v5, 31, v2
    v_lshrrev_b32 v6, 5, v2
    s_mul_i32 s6, s37, 144
    s_lshl_b32 s7, s36, 5
    s_add_u32 s7, s7, s6
    v_add_u32 v12, s7, v5
    v_lshlrev_b32 v12, 10, v12
    s_lshl_b32 s7, s39, 8
    s_lshl_b32 s45, s38, 6
    s_add_u32 s7, s7, s45
    v_lshlrev_b32 v13, 4, v6
    v_add_u32 v12, v12, v13
    v_add_u32 v12, s7, v12
    s_add_u32 s6, s6, 128
    v_add_u32 v14, s6, v3
    v_lshlrev_b32 v14, 10, v14
    v_lshlrev_b32 v13, 3, v4
    v_add_u32 v14, v14, v13
    s_and_b32 s45, s36, 1
    s_lshl_b32 s45, s45, 5
    s_add_u32 s7, s7, s45
    v_add_u32 v14, s7, v14
    s_waitcnt vmcnt(0)

    v_lshlrev_b32 v48, 16, v16
    v_and_b32 v49, 0xffff0000, v16
    v_add_f32 v144, v144, v48
    v_add_f32 v145, v145, v49
    v_lshlrev_b32 v48, 16, v24
    v_and_b32 v49, 0xffff0000, v24
    v_add_f32 v144, v144, v48
    v_add_f32 v145, v145, v49
    v_lshlrev_b32 v48, 16, v32
    v_and_b32 v49, 0xffff0000, v32
    v_add_f32 v144, v144, v48
    v_add_f32 v145, v145, v49
    v_cvt_pk_bf16_f32 v80, v144, v145
    v_lshlrev_b32 v48, 16, v17
    v_and_b32 v49, 0xffff0000, v17
    v_add_f32 v146, v146, v48
    v_add_f32 v147, v147, v49
    v_lshlrev_b32 v48, 16, v25
    v_and_b32 v49, 0xffff0000, v25
    v_add_f32 v146, v146, v48
    v_add_f32 v147, v147, v49
    v_lshlrev_b32 v48, 16, v33
    v_and_b32 v49, 0xffff0000, v33
    v_add_f32 v146, v146, v48
    v_add_f32 v147, v147, v49
    v_cvt_pk_bf16_f32 v81, v146, v147
    v_lshlrev_b32 v48, 16, v18
    v_and_b32 v49, 0xffff0000, v18
    v_add_f32 v148, v148, v48
    v_add_f32 v149, v149, v49
    v_lshlrev_b32 v48, 16, v26
    v_and_b32 v49, 0xffff0000, v26
    v_add_f32 v148, v148, v48
    v_add_f32 v149, v149, v49
    v_lshlrev_b32 v48, 16, v34
    v_and_b32 v49, 0xffff0000, v34
    v_add_f32 v148, v148, v48
    v_add_f32 v149, v149, v49
    v_cvt_pk_bf16_f32 v82, v148, v149
    v_lshlrev_b32 v48, 16, v19
    v_and_b32 v49, 0xffff0000, v19
    v_add_f32 v150, v150, v48
    v_add_f32 v151, v151, v49
    v_lshlrev_b32 v48, 16, v27
    v_and_b32 v49, 0xffff0000, v27
    v_add_f32 v150, v150, v48
    v_add_f32 v151, v151, v49
    v_lshlrev_b32 v48, 16, v35
    v_and_b32 v49, 0xffff0000, v35
    v_add_f32 v150, v150, v48
    v_add_f32 v151, v151, v49
    v_cvt_pk_bf16_f32 v83, v150, v151
    v_lshlrev_b32 v48, 16, v20
    v_and_b32 v49, 0xffff0000, v20
    v_add_f32 v152, v152, v48
    v_add_f32 v153, v153, v49
    v_lshlrev_b32 v48, 16, v28
    v_and_b32 v49, 0xffff0000, v28
    v_add_f32 v152, v152, v48
    v_add_f32 v153, v153, v49
    v_lshlrev_b32 v48, 16, v36
    v_and_b32 v49, 0xffff0000, v36
    v_add_f32 v152, v152, v48
    v_add_f32 v153, v153, v49
    v_cvt_pk_bf16_f32 v84, v152, v153
    v_lshlrev_b32 v48, 16, v21
    v_and_b32 v49, 0xffff0000, v21
    v_add_f32 v154, v154, v48
    v_add_f32 v155, v155, v49
    v_lshlrev_b32 v48, 16, v29
    v_and_b32 v49, 0xffff0000, v29
    v_add_f32 v154, v154, v48
    v_add_f32 v155, v155, v49
    v_lshlrev_b32 v48, 16, v37
    v_and_b32 v49, 0xffff0000, v37
    v_add_f32 v154, v154, v48
    v_add_f32 v155, v155, v49
    v_cvt_pk_bf16_f32 v85, v154, v155
    v_lshlrev_b32 v48, 16, v22
    v_and_b32 v49, 0xffff0000, v22
    v_add_f32 v156, v156, v48
    v_add_f32 v157, v157, v49
    v_lshlrev_b32 v48, 16, v30
    v_and_b32 v49, 0xffff0000, v30
    v_add_f32 v156, v156, v48
    v_add_f32 v157, v157, v49
    v_lshlrev_b32 v48, 16, v38
    v_and_b32 v49, 0xffff0000, v38
    v_add_f32 v156, v156, v48
    v_add_f32 v157, v157, v49
    v_cvt_pk_bf16_f32 v86, v156, v157
    v_lshlrev_b32 v48, 16, v23
    v_and_b32 v49, 0xffff0000, v23
    v_add_f32 v158, v158, v48
    v_add_f32 v159, v159, v49
    v_lshlrev_b32 v48, 16, v31
    v_and_b32 v49, 0xffff0000, v31
    v_add_f32 v158, v158, v48
    v_add_f32 v159, v159, v49
    v_lshlrev_b32 v48, 16, v39
    v_and_b32 v49, 0xffff0000, v39
    v_add_f32 v158, v158, v48
    v_add_f32 v159, v159, v49
    v_cvt_pk_bf16_f32 v87, v158, v159
    v_lshlrev_b32 v50, 16, v40
    v_and_b32 v51, 0xffff0000, v40
    v_lshlrev_b32 v48, 16, v42
    v_and_b32 v49, 0xffff0000, v42
    v_add_f32 v50, v50, v48
    v_add_f32 v51, v51, v49
    v_lshlrev_b32 v48, 16, v44
    v_and_b32 v49, 0xffff0000, v44
    v_add_f32 v50, v50, v48
    v_add_f32 v51, v51, v49
    v_lshlrev_b32 v48, 16, v46
    v_and_b32 v49, 0xffff0000, v46
    v_add_f32 v50, v50, v48
    v_add_f32 v51, v51, v49
    v_cvt_pk_bf16_f32 v88, v50, v51
    v_lshlrev_b32 v50, 16, v41
    v_and_b32 v51, 0xffff0000, v41
    v_lshlrev_b32 v48, 16, v43
    v_and_b32 v49, 0xffff0000, v43
    v_add_f32 v50, v50, v48
    v_add_f32 v51, v51, v49
    v_lshlrev_b32 v48, 16, v45
    v_and_b32 v49, 0xffff0000, v45
    v_add_f32 v50, v50, v48
    v_add_f32 v51, v51, v49
    v_lshlrev_b32 v48, 16, v47
    v_and_b32 v49, 0xffff0000, v47
    v_add_f32 v50, v50, v48
    v_add_f32 v51, v51, v49
    v_cvt_pk_bf16_f32 v89, v50, v51
    buffer_store_dwordx4 v[80:83], v12, s[32:35], 0 offen
    buffer_store_dwordx4 v[84:87], v12, s[32:35], 0 offen offset:32
    buffer_store_dwordx2 v[88:89], v14, s[32:35], 0 offen
    s_endpgm
L_rare1:
    s_call_b64 s[40:41], RESC_S1
    s_branch L_back1
L_rare2:
    s_call_b64 s[40:41], RESC_S0
    s_branch L_back2
L_rare3:
    s_call_b64 s[40:41], RESC_S1
    s_branch L_back3
L_rare4:
    s_call_b64 s[40:41], RESC_S0
    s_branch L_back4
L_rare5:
    s_call_b64 s[40:41], RESC_S1
    s_branch L_back5
L_rare6:
    s_call_b64 s[40:41], RESC_S0
    s_branch L_back6
L_rare7:
    s_call_b64 s[40:41], RESC_L
    s_branch L_back7
L_rare8:
    s_call_b64 s[40:41], RESC_S1
    s_branch L_back8
L_rare9:
    s_call_b64 s[40:41], RESC_S0
    s_branch L_back9
L_rare10:
    s_call_b64 s[40:41], RESC_S1
    s_branch L_back10
L_rare11:
    s_call_b64 s[40:41], RESC_S0
    s_branch L_back11
L_rare12:
    s_call_b64 s[40:41], RESC_L
    s_branch L_back12
L_rare13:
    s_call_b64 s[40:41], RESC_S1
    s_branch L_back13
L_rare14:
    s_call_b64 s[40:41], RESC_S0
    s_branch L_back14
L_rare15:
    s_call_b64 s[40:41], RESC_S1
    s_branch L_back15
L_rare16:
    s_call_b64 s[40:41], RESC_S0
    s_branch L_back16
L_rare17:
    s_call_b64 s[40:41], RESC_L
    s_branch L_back17
L_rare18:
    s_call_b64 s[40:41], RESC_S1
    s_branch L_back18
L_rare19:
    s_call_b64 s[40:41], RESC_S1
    s_branch L_back19
L_rare20:
    s_call_b64 s[40:41], RESC_S0
    s_branch L_back20
L_rare21:
    s_call_b64 s[40:41], RESC_S1
    s_branch L_back21
L_rare22:
    s_call_b64 s[40:41], RESC_S0
    s_branch L_back22
L_rare23:
    s_call_b64 s[40:41], RESC_S1
    s_branch L_back23
L_rare24:
    s_call_b64 s[40:41], RESC_S0
    s_branch L_back24
L_rare25:
    s_call_b64 s[40:41], RESC_L
    s_branch L_back25
L_rare26:
    s_call_b64 s[40:41], RESC_S1
    s_branch L_back26
L_rare27:
    s_call_b64 s[40:41], RESC_S0
    s_branch L_back27
L_rare28:
    s_call_b64 s[40:41], RESC_S1
    s_branch L_back28
L_rare29:
    s_call_b64 s[40:41], RESC_S0
    s_branch L_back29
L_rare30:
    s_call_b64 s[40:41], RESC_L
    s_branch L_back30
L_rare31:
    s_call_b64 s[40:41], RESC_S1
    s_branch L_back31
L_rare32:
    s_call_b64 s[40:41], RESC_S0
    s_branch L_back32
L_rare33:
    s_call_b64 s[40:41], RESC_S1
    s_branch L_back33
L_rare34:
    s_call_b64 s[40:41], RESC_S0
    s_branch L_back34
L_rare35:
    s_call_b64 s[40:41], RESC_L
    s_branch L_back35
L_rare36:
    s_call_b64 s[40:41], RESC_S1
    s_branch L_back36
RESC_S0:
    s_nop 15
    v_mov_b32 v236, v234
    s_nop 1
    v_permlane32_swap_b32 v236, v234
    s_nop 1
    v_max_f32 v234, v236, v234
    v_max_f32 v234, 0, v234
    v_sub_f32 v237, 0, v234
    v_exp_f32 v237, v237
    s_nop 1
    v_mul_f32 v0, v237, v0
    v_mul_f32 v1, v237, v1
    v_mul_f32 v2, v237, v2
    v_mul_f32 v3, v237, v3
    v_mul_f32 v4, v237, v4
    v_mul_f32 v5, v237, v5
    v_mul_f32 v6, v237, v6
    v_mul_f32 v7, v237, v7
    v_mul_f32 v8, v237, v8
    v_mul_f32 v9, v237, v9
    v_mul_f32 v10, v237, v10
    v_mul_f32 v11, v237, v11
    v_mul_f32 v12, v237, v12
    v_mul_f32 v13, v237, v13
    v_mul_f32 v14, v237, v14
    v_mul_f32 v15, v237, v15
    v_mul_f32 v16, v237, v16
    v_mul_f32 v17, v237, v17
    v_mul_f32 v18, v237, v18
    v_mul_f32 v19, v237, v19
    v_mul_f32 v20, v237, v20
    v_mul_f32 v21, v237, v21
    v_mul_f32 v22, v237, v22
    v_mul_f32 v23, v237, v23
    v_mul_f32 v24, v237, v24
    v_mul_f32 v25, v237, v25
    v_mul_f32 v26, v237, v26
    v_mul_f32 v27, v237, v27
    v_mul_f32 v28, v237, v28
    v_mul_f32 v29, v237, v29
    v_mul_f32 v30, v237, v30
    v_mul_f32 v31, v237, v31
    v_mul_f32 v32, v237, v32
    v_mul_f32 v33, v237, v33
    v_mul_f32 v34, v237, v34
    v_mul_f32 v35, v237, v35
    v_mul_f32 v36, v237, v36
    v_mul_f32 v37, v237, v37
    v_mul_f32 v38, v237, v38
    v_mul_f32 v39, v237, v39
    v_mul_f32 v40, v237, v40
    v_mul_f32 v41, v237, v41
    v_mul_f32 v42, v237, v42
    v_mul_f32 v43, v237, v43
    v_mul_f32 v44, v237, v44
    v_mul_f32 v45, v237, v45
    v_mul_f32 v46, v237, v46
    v_mul_f32 v47, v237, v47
    v_mul_f32 v48, v237, v48
    v_mul_f32 v49, v237, v49
    v_mul_f32 v50, v237, v50
    v_mul_f32 v51, v237, v51
    v_mul_f32 v52, v237, v52
    v_mul_f32 v53, v237, v53
    v_mul_f32 v54, v237, v54
    v_mul_f32 v55, v237, v55
    v_mul_f32 v56, v237, v56
    v_mul_f32 v57, v237, v57
    v_mul_f32 v58, v237, v58
    v_mul_f32 v59, v237, v59
    v_mul_f32 v60, v237, v60
    v_mul_f32 v61, v237, v61
    v_mul_f32 v62, v237, v62
    v_mul_f32 v63, v237, v63
    v_mul_f32 v232, v237, v232
    v_sub_f32 v96, v96, v234
    v_sub_f32 v97, v97, v234
    v_sub_f32 v98, v98, v234
    v_sub_f32 v99, v99, v234
    v_sub_f32 v100, v100, v234
    v_sub_f32 v101, v101, v234
    v_sub_f32 v102, v102, v234
    v_sub_f32 v103, v103, v234
    v_sub_f32 v104, v104, v234
    v_sub_f32 v105, v105, v234
    v_sub_f32 v106, v106, v234
    v_sub_f32 v107, v107, v234
    v_sub_f32 v108, v108, v234
    v_sub_f32 v109, v109, v234
    v_sub_f32 v110, v110, v234
    v_sub_f32 v111, v111, v234
    v_sub_f32 v128, v128, v234
    v_sub_f32 v129, v129, v234
    v_sub_f32 v130, v130, v234
    v_sub_f32 v131, v131, v234
    v_sub_f32 v132, v132, v234
    v_sub_f32 v133, v133, v234
    v_sub_f32 v134, v134, v234
    v_sub_f32 v135, v135, v234
    v_sub_f32 v136, v136, v234
    v_sub_f32 v137, v137, v234
    v_sub_f32 v138, v138, v234
    v_sub_f32 v139, v139, v234
    v_sub_f32 v140, v140, v234
    v_sub_f32 v141, v141, v234
    v_sub_f32 v142, v142, v234
    v_sub_f32 v143, v143, v234
    s_nop 3
    s_setpc_b64 s[40:41]
RESC_S1:
    s_nop 15
    v_mov_b32 v236, v234
    s_nop 1
    v_permlane32_swap_b32 v236, v234
    s_nop 1
    v_max_f32 v234, v236, v234
    v_max_f32 v234, 0, v234
    v_sub_f32 v237, 0, v234
    v_exp_f32 v237, v237
    s_nop 1
    v_mul_f32 v0, v237, v0
    v_mul_f32 v1, v237, v1
    v_mul_f32 v2, v237, v2
    v_mul_f32 v3, v237, v3
    v_mul_f32 v4, v237, v4
    v_mul_f32 v5, v237, v5
    v_mul_f32 v6, v237, v6
    v_mul_f32 v7, v237, v7
    v_mul_f32 v8, v237, v8
    v_mul_f32 v9, v237, v9
    v_mul_f32 v10, v237, v10
    v_mul_f32 v11, v237, v11
    v_mul_f32 v12, v237, v12
    v_mul_f32 v13, v237, v13
    v_mul_f32 v14, v237, v14
    v_mul_f32 v15, v237, v15
    v_mul_f32 v16, v237, v16
    v_mul_f32 v17, v237, v17
    v_mul_f32 v18, v237, v18
    v_mul_f32 v19, v237, v19
    v_mul_f32 v20, v237, v20
    v_mul_f32 v21, v237, v21
    v_mul_f32 v22, v237, v22
    v_mul_f32 v23, v237, v23
    v_mul_f32 v24, v237, v24
    v_mul_f32 v25, v237, v25
    v_mul_f32 v26, v237, v26
    v_mul_f32 v27, v237, v27
    v_mul_f32 v28, v237, v28
    v_mul_f32 v29, v237, v29
    v_mul_f32 v30, v237, v30
    v_mul_f32 v31, v237, v31
    v_mul_f32 v32, v237, v32
    v_mul_f32 v33, v237, v33
    v_mul_f32 v34, v237, v34
    v_mul_f32 v35, v237, v35
    v_mul_f32 v36, v237, v36
    v_mul_f32 v37, v237, v37
    v_mul_f32 v38, v237, v38
    v_mul_f32 v39, v237, v39
    v_mul_f32 v40, v237, v40
    v_mul_f32 v41, v237, v41
    v_mul_f32 v42, v237, v42
    v_mul_f32 v43, v237, v43
    v_mul_f32 v44, v237, v44
    v_mul_f32 v45, v237, v45
    v_mul_f32 v46, v237, v46
    v_mul_f32 v47, v237, v47
    v_mul_f32 v48, v237, v48
    v_mul_f32 v49, v237, v49
    v_mul_f32 v50, v237, v50
    v_mul_f32 v51, v237, v51
    v_mul_f32 v52, v237, v52
    v_mul_f32 v53, v237, v53
    v_mul_f32 v54, v237, v54
    v_mul_f32 v55, v237, v55
    v_mul_f32 v56, v237, v56
    v_mul_f32 v57, v237, v57
    v_mul_f32 v58, v237, v58
    v_mul_f32 v59, v237, v59
    v_mul_f32 v60, v237, v60
    v_mul_f32 v61, v237, v61
    v_mul_f32 v62, v237, v62
    v_mul_f32 v63, v237, v63
    v_mul_f32 v232, v237, v232
    v_sub_f32 v112, v112, v234
    v_sub_f32 v113, v113, v234
    v_sub_f32 v114, v114, v234
    v_sub_f32 v115, v115, v234
    v_sub_f32 v116, v116, v234
    v_sub_f32 v117, v117, v234
    v_sub_f32 v118, v118, v234
    v_sub_f32 v119, v119, v234
    v_sub_f32 v120, v120, v234
    v_sub_f32 v121, v121, v234
    v_sub_f32 v122, v122, v234
    v_sub_f32 v123, v123, v234
    v_sub_f32 v124, v124, v234
    v_sub_f32 v125, v125, v234
    v_sub_f32 v126, v126, v234
    v_sub_f32 v127, v127, v234
    v_sub_f32 v128, v128, v234
    v_sub_f32 v129, v129, v234
    v_sub_f32 v130, v130, v234
    v_sub_f32 v131, v131, v234
    v_sub_f32 v132, v132, v234
    v_sub_f32 v133, v133, v234
    v_sub_f32 v134, v134, v234
    v_sub_f32 v135, v135, v234
    v_sub_f32 v136, v136, v234
    v_sub_f32 v137, v137, v234
    v_sub_f32 v138, v138, v234
    v_sub_f32 v139, v139, v234
    v_sub_f32 v140, v140, v234
    v_sub_f32 v141, v141, v234
    v_sub_f32 v142, v142, v234
    v_sub_f32 v143, v143, v234
    s_nop 3
    s_setpc_b64 s[40:41]
RESC_L:
    s_nop 15
    v_mov_b32 v238, v235
    s_nop 1
    v_permlane16_swap_b32 v238, v235
    s_nop 1
    v_max_f32 v235, v238, v235
    v_mov_b32 v238, v235
    s_nop 1
    v_permlane32_swap_b32 v238, v235
    s_nop 1
    v_max_f32 v235, v238, v235
    v_max_f32 v235, 0, v235
    v_sub_f32 v239, 0, v235
    v_exp_f32 v239, v239
    s_nop 1
    v_mul_f32 v64, v239, v64
    v_mul_f32 v65, v239, v65
    v_mul_f32 v66, v239, v66
    v_mul_f32 v67, v239, v67
    v_mul_f32 v68, v239, v68
    v_mul_f32 v69, v239, v69
    v_mul_f32 v70, v239, v70
    v_mul_f32 v71, v239, v71
    v_mul_f32 v72, v239, v72
    v_mul_f32 v73, v239, v73
    v_mul_f32 v74, v239, v74
    v_mul_f32 v75, v239, v75
    v_mul_f32 v76, v239, v76
    v_mul_f32 v77, v239, v77
    v_mul_f32 v78, v239, v78
    v_mul_f32 v79, v239, v79
    v_mul_f32 v80, v239, v80
    v_mul_f32 v81, v239, v81
    v_mul_f32 v82, v239, v82
    v_mul_f32 v83, v239, v83
    v_mul_f32 v84, v239, v84
    v_mul_f32 v85, v239, v85
    v_mul_f32 v86, v239, v86
    v_mul_f32 v87, v239, v87
    v_mul_f32 v88, v239, v88
    v_mul_f32 v89, v239, v89
    v_mul_f32 v90, v239, v90
    v_mul_f32 v91, v239, v91
    v_mul_f32 v92, v239, v92
    v_mul_f32 v93, v239, v93
    v_mul_f32 v94, v239, v94
    v_mul_f32 v95, v239, v95
    v_mul_f32 v233, v239, v233
    v_sub_f32 v152, v152, v235
    v_sub_f32 v153, v153, v235
    v_sub_f32 v154, v154, v235
    v_sub_f32 v155, v155, v235
    v_sub_f32 v156, v156, v235
    v_sub_f32 v157, v157, v235
    v_sub_f32 v158, v158, v235
    v_sub_f32 v159, v159, v235
    v_sub_f32 v160, v160, v235
    v_sub_f32 v161, v161, v235
    v_sub_f32 v162, v162, v235
    v_sub_f32 v163, v163, v235
    s_nop 3
    s_setpc_b64 s[40:41]
L_poll0:
    s_mov_b32 s97, 0
L_pl0:
    s_sleep 1
    v_mov_b32 v241, 0
    buffer_load_dword v242, v241, s[8:11], 0 offen sc1
    s_waitcnt vmcnt(0)
    v_readfirstlane_b32 s93, v242
    s_nop 3
    v_cmp_eq_u32 s[0:1], 0, v242
    s_add_u32 s97, s97, 1
    s_cmp_ge_u32 s97, 131072
    s_cbranch_scc1 L_pback0
    s_cmp_lg_u64 s[0:1], 0
    s_cbranch_scc1 L_pl0
    s_branch L_pback0
L_poll1:
    s_mov_b32 s97, 0
L_pl1:
    s_sleep 4
    v_lshlrev_b32 v220, 3, v244
    v_and_b32 v220, 0x180, v220
    buffer_load_dword v217, v220, s[24:27], s3 offen offset:0 sc1
    s_waitcnt vmcnt(0)
    v_cmp_ne_u32 s[0:1], v217, v255
    s_add_u32 s97, s97, 1
    s_cmp_ge_u32 s97, 131072
    s_cbranch_scc1 L_pback1
    s_cmp_lg_u64 s[0:1], 0
    s_cbranch_scc1 L_pl1
    s_branch L_pback1
L_poll2:
    s_mov_b32 s97, 0
L_pl2:
    s_sleep 4
    v_lshlrev_b32 v220, 3, v244
    v_and_b32 v220, 0x180, v220
    buffer_load_dword v216, v220, s[24:27], s3 offen offset:4 sc1
    s_waitcnt vmcnt(0)
    v_cmp_ne_u32 s[0:1], v216, v255
    s_add_u32 s97, s97, 1
    s_cmp_ge_u32 s97, 131072
    s_cbranch_scc1 L_pback2
    s_cmp_lg_u64 s[0:1], 0
    s_cbranch_scc1 L_pl2
    s_branch L_pback2
L_end:
    s_endpgm
.section .rodata,"a"
.p2align 6
.amdhsa_kernel standalone__gqa_block_cached__near_ridge_kernel
  .amdhsa_next_free_vgpr 512
  .amdhsa_next_free_sgpr 102
  .amdhsa_accum_offset 256
  .amdhsa_group_segment_fixed_size 0
  .amdhsa_kernarg_size 64
  .amdhsa_user_sgpr_count 2
  .amdhsa_user_sgpr_kernarg_segment_ptr 1
  .amdhsa_system_sgpr_workgroup_id_x 1
.end_amdhsa_kernel
.text
```
